```python
import torch

def _softmax(x, axis=-1):
    return torch.softmax(x, dim=axis)
def _gelu(x):
    return torch.nn.functional.gelu(x, approximate="tanh")
def _silu(x):
    return torch.nn.functional.silu(x)
def _sigmoid(x):
    return torch.sigmoid(x)
def _layernorm(x, axis=-1, eps=1e-5):
    m = x.mean(dim=axis, keepdim=True)
    v = x.var(dim=axis, keepdim=True, unbiased=False)
    return (x - m) / torch.sqrt(v + eps)
def _scatter_add(tgt, idx, src, axis=0):
    return tgt.clone().index_add_(axis, idx, src)
def _segment_sum(src, seg, n):
    out = torch.zeros((n,) + src.shape[1:], dtype=src.dtype)
    return out.index_add_(0, seg, src)
def _pad(x, pw):
    flat = tuple(v for pair in reversed(pw) for v in pair)
    return torch.nn.functional.pad(x, flat)

kernel_name = 'recurrent_scan__sliding_local_dilated__swiglu_ffn__prompt'

def setup_inputs():

    _w = (lambda a: (lambda t: t.to(torch.bfloat16) if t.is_floating_point() else t)(torch.as_tensor(a)))
    def _A_setup():
        B, S, D = 1, 2048, 640
        return {
            "x": _w((lambda *s: torch.randn(*s, dtype=torch.bfloat16) * 0.05)(B, S, D)),
            "wqkv": _w((lambda *s: torch.randn(*s, dtype=torch.bfloat16) * 0.05)(D, 3 * D)),
            "wo": _w((lambda *s: torch.randn(*s, dtype=torch.bfloat16) * 0.05)(D, D)),
        }
    _A_in = _A_setup()

    def _B_setup():
        B, S, D, F = 1, 2048, 640, 1728
        return {
            "x": _w((lambda *s: torch.randn(*s, dtype=torch.bfloat16) * 0.05)(B, S, D)),
            "w_gate": _w((lambda *s: torch.randn(*s, dtype=torch.bfloat16) * 0.05)(D, F)),
            "w_up": _w((lambda *s: torch.randn(*s, dtype=torch.bfloat16) * 0.05)(D, F)),
            "w_down": _w((lambda *s: torch.randn(*s, dtype=torch.bfloat16) * 0.05)(F, D)),
        }
    _B_in = _B_setup()

    return {
        "A_x": _A_in["x"],
        "A_wqkv": _A_in["wqkv"],
        "A_wo": _A_in["wo"],
        "B_x": _B_in["x"],
        "B_w_gate": _B_in["w_gate"],
        "B_w_up": _B_in["w_up"],
        "B_w_down": _B_in["w_down"],
    }

def reference(A_x, A_wqkv, A_wo, B_x, B_w_gate, B_w_up, B_w_down):
    def _A_ref(x, wqkv, wo):
        B, S, D = x.shape
        H = 32; Dh = D // H
        W, dil = 8, 2
        qkv = (lambda x, *d: x.permute(*d))((x @ wqkv).reshape(B, S, 3, H, Dh), 2, 0, 3, 1, 4)
        q, k, v = qkv[0], qkv[1], qkv[2]
        scale = Dh ** -0.5
        pos = torch.arange(S)
        off = torch.arange(W) * dil
        idx = pos[:, None] - off[None, :]
        mask = idx >= 0
        idx_c = torch.where(mask, idx, 0).reshape(-1)
        kg = k[:, :, idx_c, :].reshape(B, H, S, W, Dh)
        vg = v[:, :, idx_c, :].reshape(B, H, S, W, Dh)
        logits = torch.einsum("bhsd,bhswd->bhsw", q, kg) * scale
        logits = torch.where(mask[None, None, :, :], logits, -1e9)
        attn = _softmax(logits, axis=-1)
        o = torch.einsum("bhsw,bhswd->bhsd", attn, vg)
        return (lambda x, *d: x.permute(*d))(o, 0, 2, 1, 3).reshape(B, S, D) @ wo

    def _B_ref(x, w_gate, w_up, w_down):
        g = _silu(x @ w_gate)
        u = x @ w_up
        return (g * u) @ w_down

    x = A_x
    xn = _layernorm(x, axis=-1)
    s = _A_ref(xn, A_wqkv, A_wo)
    g = _silu(_B_ref(xn, B_w_gate, B_w_up, B_w_down))
    return x + s * g
```

```asm
; @launch grid=(256,1,1) block=(512,1,1) lds=163840
.amdgcn_target "amdgcn-amd-amdhsa--gfx950"
.text
.globl recurrent_scan__sliding_local_dilated__swiglu_ffn__prompt_kernel
.type recurrent_scan__sliding_local_dilated__swiglu_ffn__prompt_kernel,@function
.p2align 8
recurrent_scan__sliding_local_dilated__swiglu_ffn__prompt_kernel:
    s_cmp_ge_u32 s2, 256
    s_cbranch_scc1 L_exit
    s_load_dwordx16 s[4:19], s[0:1], 0
    s_load_dwordx4 s[20:23], s[0:1], 64
    v_lshrrev_b32 v1, 6, v0
    s_and_b32 s52, s2, 7
    v_readfirstlane_b32 s48, v1
    v_and_b32 v1, 63, v0
    s_lshr_b32 s53, s2, 3
    s_cmp_lg_u32 s48, 3
    s_cbranch_scc1 L_nopf
    s_getpc_b64 s[54:55]
L_pc:
    s_sub_u32 s54, s54, L_pc-recurrent_scan__sliding_local_dilated__swiglu_ffn__prompt_kernel
    s_subb_u32 s55, s55, 0
    s_and_b32 s56, s53, 7
    s_lshl_b32 s56, s56, 13
    v_lshl_add_u32 v2, v1, 7, s56
    v_min_u32 v2, L_text_end-recurrent_scan__sliding_local_dilated__swiglu_ffn__prompt_kernel-4, v2
    v_mov_b32 v3, s55
    v_add_co_u32 v2, vcc, s54, v2
    s_nop 1
    v_addc_co_u32 v3, vcc, 0, v3, vcc
    global_load_dword v23, v[2:3], off
L_nopf:
    s_sub_u32 s51, s48, 4
    s_cmp_lt_u32 s53, 12
    s_cbranch_scc0 L_dec_ffn
    s_mov_b32 s50, s52
    s_mov_b32 s49, s53
    s_mul_i32 s64, s49, 176
    s_max_u32 s64, s64, 16
    s_sub_u32 s64, s64, 16
    s_mov_b32 s68, 1
    s_mov_b32 s74, 10
    s_mov_b32 s73, 0
    s_cmp_lt_u32 s48, 4
    s_cbranch_scc1 L_qkv_compute
    s_branch L_qkv_lsetup
L_dec_ffn:
    s_sub_u32 s53, s53, 12
    s_mul_i32 s54, s53, 52
    s_lshr_b32 s54, s54, 8
    s_lshl_b32 s73, s54, 2
    s_mul_i32 s54, s54, 5
    s_sub_u32 s74, s53, s54
    s_lshr_b32 s54, s52, 1
    s_lshl4_add_u32 s73, s54, s73
    s_and_b32 s54, s52, 1
    s_mul_i32 s54, s54, 5
    s_add_u32 s74, s74, s54
    s_lshl3_add_u32 s54, s53, s52
    s_sub_u32 s54, s54, 1
    s_mul_i32 s52, s52, 18
    s_add_u32 s52, s52, s53
    s_cmp_eq_u32 s52, 143
    s_cselect_b32 s52, 200, s52
    s_cmp_lt_u32 s53, 18
    s_cselect_b32 s52, s52, s54
    s_mul_i32 s50, s52, 5958
    s_lshr_b32 s50, s50, 16
    s_mul_i32 s49, s50, 11
    s_sub_u32 s49, s52, s49
    s_mul_i32 s64, s49, 192
    s_mov_b32 s68, 0
    s_cmp_ge_u32 s52, 154
    s_cbranch_scc1 L_spare
    s_cmp_lt_u32 s48, 4
    s_cbranch_scc1 L_ffn_compute
    v_lshrrev_b32 v12, 3, v1
    v_and_b32 v14, 7, v1
    s_mul_i32 s52, s51, 48
    s_add_u32 s52, s52, s64
    v_add_u32 v13, s52, v12
    v_mul_u32_u24 v13, 1280, v13
    v_lshrrev_b32 v15, 4, v1
    v_xor_b32 v15, v15, v14
    v_lshl_add_u32 v2, v15, 4, v13
    v_xor_b32 v15, 4, v15
    v_lshl_add_u32 v3, v15, 4, v13
    v_add_u32 v3, 10240, v3
    v_add_u32 v4, 20480, v2
    v_add_u32 v5, 20480, v3
    v_add_u32 v6, 40960, v2
    v_add_u32 v7, 40960, v3
    s_mov_b32 s52, 0
    s_lshl_b32 s56, s52, 7
    s_mul_i32 s57, s52, 221184
    s_mov_b32 s66, 110592
    s_mov_b32 s67, 2211840
    s_mov_b32 s71, 27648
    s_mul_i32 s58, s51, 6144
    s_waitcnt lgkmcnt(0)
    s_mov_b32 s24, s4
    s_and_b32 s25, s5, 0xffff
    s_mov_b32 s26, 0x280000
    s_mov_b32 s27, 0x20000
    s_add_u32 m0, s58, 0x0
    s_nop 0
    buffer_load_dwordx4 v2, s[24:27], s56 offen  lds
    s_add_u32 m0, s58, 0x400
    s_nop 0
    buffer_load_dwordx4 v3, s[24:27], s56 offen  lds
    s_add_u32 m0, s58, 0x800
    s_nop 0
    buffer_load_dwordx4 v4, s[24:27], s56 offen  lds
    s_add_u32 m0, s58, 0xc00
    s_nop 0
    buffer_load_dwordx4 v5, s[24:27], s56 offen  lds
    s_add_u32 m0, s58, 0x1000
    s_nop 0
    buffer_load_dwordx4 v6, s[24:27], s56 offen  lds
    s_add_u32 m0, s58, 0x1400
    s_nop 0
    buffer_load_dwordx4 v7, s[24:27], s56 offen  lds
    s_lshl_b32 s52, s51, 3
    v_add_u32 v13, s52, v12
    v_and_b32 v15, 12, v13
    v_add_u32 v13, v13, v15
    s_lshr_b32 s52, s51, 1
    s_mul_i32 s52, s52, 12
    v_subrev_u32 v13, s52, v13
    v_mul_u32_u24 v13, 3456, v13
    v_lshrrev_b32 v15, 4, v1
    v_lshlrev_b32 v15, 1, v15
    v_xor_b32 v15, v15, v14
    v_lshl_add_u32 v13, v15, 4, v13
    s_lshl_b32 s52, s50, 8
    v_add_u32 v8, s52, v13
    s_cmp_eq_u32 s50, 13
    s_movk_i32 s53, 128
    s_cselect_b32 s53, 0x40000000, s53
    v_add_u32 v9, s53, v8
    v_mov_b32 v10, v8
    v_mov_b32 v11, v9
    s_mov_b32 s36, s12
    s_and_b32 s37, s13, 0xffff
    s_mov_b32 s38, 0x21c000
    s_mov_b32 s39, 0x20000
    s_mov_b32 s40, s14
    s_and_b32 s41, s15, 0xffff
    s_mov_b32 s42, 0x21c000
    s_mov_b32 s43, 0x20000
    s_branch L_loader
L_qkv_lsetup:
    v_lshrrev_b32 v12, 4, v1
    v_mul_u32_u24 v13, 6, v12
    v_bfe_u32 v14, v1, 3, 1
    s_mul_i32 s52, s51, 48
    s_add_u32 s52, s52, s64
    v_add3_u32 v13, v13, v14, s52
    v_mul_u32_u24 v13, 1280, v13
    v_and_b32 v14, 7, v1
    v_xor_b32 v14, v14, v12
    v_xor_b32 v15, 4, v14
    v_lshl_add_u32 v14, v14, 4, v13
    v_lshl_add_u32 v15, v15, 4, v13
    v_add_u32 v2, 0, v14
    v_add_u32 v3, 30720, v15
    v_add_u32 v4, 2560, v14
    v_add_u32 v5, 33280, v15
    v_add_u32 v6, 5120, v14
    v_add_u32 v7, 35840, v15
    s_mov_b32 s52, 0
    s_lshl_b32 s56, s52, 7
    s_mul_i32 s57, s52, 245760
    s_mov_b32 s66, 122880
    s_mov_b32 s67, 2457600
    s_mov_b32 s71, 30720
    s_mul_i32 s58, s51, 6144
    s_waitcnt lgkmcnt(0)
    s_mov_b32 s24, s4
    s_and_b32 s25, s5, 0xffff
    s_mov_b32 s26, 0x280000
    s_mov_b32 s27, 0x20000
    s_lshl_b32 s54, s2, 3
    s_lshl1_add_u32 s54, s51, s54
    s_add_u32 s54, s54, 0
    v_lshrrev_b32 v20, 5, v1
    v_add_u32 v20, s54, v20
    v_mul_u32_u24 v12, 1280, v20
    v_and_b32 v13, 31, v1
    v_lshl_add_u32 v16, v13, 3, v12
    v_lshl_add_u32 v12, v13, 4, v12
    buffer_load_dwordx4 v[84:87], v12, s[24:27], 0 offen
    buffer_load_dwordx4 v[88:91], v12, s[24:27], 0 offen offset:512
    buffer_load_dwordx2 v[92:93], v16, s[24:27], 0 offen offset:1024
    s_lshl_b32 s54, s2, 3
    s_lshl1_add_u32 s54, s51, s54
    s_add_u32 s54, s54, 768
    v_lshrrev_b32 v21, 5, v1
    v_add_u32 v21, s54, v21
    v_mul_u32_u24 v12, 1280, v21
    v_and_b32 v13, 31, v1
    v_lshl_add_u32 v16, v13, 3, v12
    v_lshl_add_u32 v12, v13, 4, v12
    buffer_load_dwordx4 v[94:97], v12, s[24:27], 0 offen
    buffer_load_dwordx4 v[98:101], v12, s[24:27], 0 offen offset:512
    buffer_load_dwordx2 v[102:103], v16, s[24:27], 0 offen offset:1024
    s_lshl_b32 s54, s2, 3
    s_lshl1_add_u32 s54, s51, s54
    s_add_u32 s54, s54, 1536
    v_lshrrev_b32 v22, 5, v1
    v_add_u32 v22, s54, v22
    v_mul_u32_u24 v12, 1280, v22
    v_and_b32 v13, 31, v1
    v_lshl_add_u32 v16, v13, 3, v12
    v_lshl_add_u32 v12, v13, 4, v12
    buffer_load_dwordx4 v[104:107], v12, s[24:27], 0 offen
    buffer_load_dwordx4 v[108:111], v12, s[24:27], 0 offen offset:512
    buffer_load_dwordx2 v[112:113], v16, s[24:27], 0 offen offset:1024
    s_mov_b32 s28, s22
    s_and_b32 s29, s23, 0xffff
    s_mov_b32 s30, 0xf20000
    s_mov_b32 s31, 0x20000
    s_waitcnt vmcnt(6)
    v_lshlrev_b32 v64, 16, v84
    v_and_b32 v65, 0xffff0000, v84
    v_lshlrev_b32 v66, 16, v85
    v_and_b32 v67, 0xffff0000, v85
    v_lshlrev_b32 v68, 16, v86
    v_and_b32 v69, 0xffff0000, v86
    v_lshlrev_b32 v70, 16, v87
    v_and_b32 v71, 0xffff0000, v87
    v_lshlrev_b32 v72, 16, v88
    v_and_b32 v73, 0xffff0000, v88
    v_lshlrev_b32 v74, 16, v89
    v_and_b32 v75, 0xffff0000, v89
    v_lshlrev_b32 v76, 16, v90
    v_and_b32 v77, 0xffff0000, v90
    v_lshlrev_b32 v78, 16, v91
    v_and_b32 v79, 0xffff0000, v91
    v_lshlrev_b32 v80, 16, v92
    v_and_b32 v81, 0xffff0000, v92
    v_lshlrev_b32 v82, 16, v93
    v_and_b32 v83, 0xffff0000, v93
    v_pk_add_f32 v[84:85], v[64:65], v[66:67]
    v_pk_add_f32 v[86:87], v[68:69], v[70:71]
    v_pk_add_f32 v[84:85], v[84:85], v[72:73]
    v_pk_add_f32 v[86:87], v[86:87], v[74:75]
    v_pk_add_f32 v[84:85], v[84:85], v[76:77]
    v_pk_add_f32 v[86:87], v[86:87], v[78:79]
    v_pk_add_f32 v[84:85], v[84:85], v[80:81]
    v_pk_add_f32 v[86:87], v[86:87], v[82:83]
    v_pk_add_f32 v[84:85], v[84:85], v[86:87]
    v_add_f32 v84, v84, v85
    s_nop 1
    v_add_f32_dpp v84, v84, v84 row_ror:8 row_mask:0xf bank_mask:0xf
    s_nop 1
    v_add_f32_dpp v84, v84, v84 row_ror:4 row_mask:0xf bank_mask:0xf
    s_nop 1
    v_add_f32_dpp v84, v84, v84 row_ror:2 row_mask:0xf bank_mask:0xf
    s_nop 1
    v_add_f32_dpp v84, v84, v84 row_ror:1 row_mask:0xf bank_mask:0xf
    v_mov_b32 v12, v84
    s_nop 1
    v_permlane16_swap_b32 v84, v12
    s_nop 0
    v_add_f32 v84, v84, v12
    v_mul_f32 v84, 0xbacccccd, v84
    v_pk_add_f32 v[64:65], v[64:65], v[84:85] op_sel_hi:[1,0]
    v_pk_add_f32 v[66:67], v[66:67], v[84:85] op_sel_hi:[1,0]
    v_pk_add_f32 v[68:69], v[68:69], v[84:85] op_sel_hi:[1,0]
    v_pk_add_f32 v[70:71], v[70:71], v[84:85] op_sel_hi:[1,0]
    v_pk_add_f32 v[72:73], v[72:73], v[84:85] op_sel_hi:[1,0]
    v_pk_add_f32 v[74:75], v[74:75], v[84:85] op_sel_hi:[1,0]
    v_pk_add_f32 v[76:77], v[76:77], v[84:85] op_sel_hi:[1,0]
    v_pk_add_f32 v[78:79], v[78:79], v[84:85] op_sel_hi:[1,0]
    v_pk_add_f32 v[80:81], v[80:81], v[84:85] op_sel_hi:[1,0]
    v_pk_add_f32 v[82:83], v[82:83], v[84:85] op_sel_hi:[1,0]
    v_pk_mul_f32 v[86:87], v[64:65], v[64:65]
    v_pk_mul_f32 v[88:89], v[66:67], v[66:67]
    v_pk_fma_f32 v[86:87], v[68:69], v[68:69], v[86:87]
    v_pk_fma_f32 v[88:89], v[70:71], v[70:71], v[88:89]
    v_pk_fma_f32 v[86:87], v[72:73], v[72:73], v[86:87]
    v_pk_fma_f32 v[88:89], v[74:75], v[74:75], v[88:89]
    v_pk_fma_f32 v[86:87], v[76:77], v[76:77], v[86:87]
    v_pk_fma_f32 v[88:89], v[78:79], v[78:79], v[88:89]
    v_pk_fma_f32 v[86:87], v[80:81], v[80:81], v[86:87]
    v_pk_fma_f32 v[88:89], v[82:83], v[82:83], v[88:89]
    v_pk_add_f32 v[86:87], v[86:87], v[88:89]
    v_add_f32 v86, v86, v87
    s_nop 1
    v_add_f32_dpp v86, v86, v86 row_ror:8 row_mask:0xf bank_mask:0xf
    s_nop 1
    v_add_f32_dpp v86, v86, v86 row_ror:4 row_mask:0xf bank_mask:0xf
    s_nop 1
    v_add_f32_dpp v86, v86, v86 row_ror:2 row_mask:0xf bank_mask:0xf
    s_nop 1
    v_add_f32_dpp v86, v86, v86 row_ror:1 row_mask:0xf bank_mask:0xf
    v_mov_b32 v12, v86
    s_nop 1
    v_permlane16_swap_b32 v86, v12
    s_nop 0
    v_add_f32 v86, v86, v12
    v_mul_f32 v86, 0x3acccccd, v86
    v_cvt_pk_bf16_f32 v86, v86, v86
    v_and_b32 v86, 0xffff0000, v86
    v_add_f32 v86, 0x3727c5ac, v86
    v_cvt_pk_bf16_f32 v86, v86, v86
    v_and_b32 v86, 0xffff0000, v86
    v_sqrt_f32 v86, v86
    v_lshlrev_b32 v20, 3, v20
    v_cvt_pk_bf16_f32 v86, v86, v86
    v_and_b32 v86, 0xffff0000, v86
    v_rcp_f32 v85, v86
    v_cvt_pk_bf16_f32 v84, v84, v84
    v_and_b32 v84, 0xffff0000, v84
    v_and_b32 v12, 31, v1
    v_cmp_eq_u32 vcc, 0, v12
    v_mov_b32 v12, 0x40000000
    s_mov_b32 s54, 0xa00000
    v_cndmask_b32 v20, v12, v20, vcc
    buffer_store_dwordx2 v[84:85], v20, s[28:31], s54 offen sc1
    s_waitcnt vmcnt(4)
    v_lshlrev_b32 v64, 16, v94
    v_and_b32 v65, 0xffff0000, v94
    v_lshlrev_b32 v66, 16, v95
    v_and_b32 v67, 0xffff0000, v95
    v_lshlrev_b32 v68, 16, v96
    v_and_b32 v69, 0xffff0000, v96
    v_lshlrev_b32 v70, 16, v97
    v_and_b32 v71, 0xffff0000, v97
    v_lshlrev_b32 v72, 16, v98
    v_and_b32 v73, 0xffff0000, v98
    v_lshlrev_b32 v74, 16, v99
    v_and_b32 v75, 0xffff0000, v99
    v_lshlrev_b32 v76, 16, v100
    v_and_b32 v77, 0xffff0000, v100
    v_lshlrev_b32 v78, 16, v101
    v_and_b32 v79, 0xffff0000, v101
    v_lshlrev_b32 v80, 16, v102
    v_and_b32 v81, 0xffff0000, v102
    v_lshlrev_b32 v82, 16, v103
    v_and_b32 v83, 0xffff0000, v103
    v_pk_add_f32 v[94:95], v[64:65], v[66:67]
    v_pk_add_f32 v[96:97], v[68:69], v[70:71]
    v_pk_add_f32 v[94:95], v[94:95], v[72:73]
    v_pk_add_f32 v[96:97], v[96:97], v[74:75]
    v_pk_add_f32 v[94:95], v[94:95], v[76:77]
    v_pk_add_f32 v[96:97], v[96:97], v[78:79]
    v_pk_add_f32 v[94:95], v[94:95], v[80:81]
    v_pk_add_f32 v[96:97], v[96:97], v[82:83]
    v_pk_add_f32 v[94:95], v[94:95], v[96:97]
    v_add_f32 v94, v94, v95
    s_nop 1
    v_add_f32_dpp v94, v94, v94 row_ror:8 row_mask:0xf bank_mask:0xf
    s_nop 1
    v_add_f32_dpp v94, v94, v94 row_ror:4 row_mask:0xf bank_mask:0xf
    s_nop 1
    v_add_f32_dpp v94, v94, v94 row_ror:2 row_mask:0xf bank_mask:0xf
    s_nop 1
    v_add_f32_dpp v94, v94, v94 row_ror:1 row_mask:0xf bank_mask:0xf
    v_mov_b32 v12, v94
    s_nop 1
    v_permlane16_swap_b32 v94, v12
    s_nop 0
    v_add_f32 v94, v94, v12
    v_mul_f32 v94, 0xbacccccd, v94
    v_pk_add_f32 v[64:65], v[64:65], v[94:95] op_sel_hi:[1,0]
    v_pk_add_f32 v[66:67], v[66:67], v[94:95] op_sel_hi:[1,0]
    v_pk_add_f32 v[68:69], v[68:69], v[94:95] op_sel_hi:[1,0]
    v_pk_add_f32 v[70:71], v[70:71], v[94:95] op_sel_hi:[1,0]
    v_pk_add_f32 v[72:73], v[72:73], v[94:95] op_sel_hi:[1,0]
    v_pk_add_f32 v[74:75], v[74:75], v[94:95] op_sel_hi:[1,0]
    v_pk_add_f32 v[76:77], v[76:77], v[94:95] op_sel_hi:[1,0]
    v_pk_add_f32 v[78:79], v[78:79], v[94:95] op_sel_hi:[1,0]
    v_pk_add_f32 v[80:81], v[80:81], v[94:95] op_sel_hi:[1,0]
    v_pk_add_f32 v[82:83], v[82:83], v[94:95] op_sel_hi:[1,0]
    v_pk_mul_f32 v[96:97], v[64:65], v[64:65]
    v_pk_mul_f32 v[98:99], v[66:67], v[66:67]
    v_pk_fma_f32 v[96:97], v[68:69], v[68:69], v[96:97]
    v_pk_fma_f32 v[98:99], v[70:71], v[70:71], v[98:99]
    v_pk_fma_f32 v[96:97], v[72:73], v[72:73], v[96:97]
    v_pk_fma_f32 v[98:99], v[74:75], v[74:75], v[98:99]
    v_pk_fma_f32 v[96:97], v[76:77], v[76:77], v[96:97]
    v_pk_fma_f32 v[98:99], v[78:79], v[78:79], v[98:99]
    v_pk_fma_f32 v[96:97], v[80:81], v[80:81], v[96:97]
    v_pk_fma_f32 v[98:99], v[82:83], v[82:83], v[98:99]
    v_pk_add_f32 v[96:97], v[96:97], v[98:99]
    v_add_f32 v96, v96, v97
    s_nop 1
    v_add_f32_dpp v96, v96, v96 row_ror:8 row_mask:0xf bank_mask:0xf
    s_nop 1
    v_add_f32_dpp v96, v96, v96 row_ror:4 row_mask:0xf bank_mask:0xf
    s_nop 1
    v_add_f32_dpp v96, v96, v96 row_ror:2 row_mask:0xf bank_mask:0xf
    s_nop 1
    v_add_f32_dpp v96, v96, v96 row_ror:1 row_mask:0xf bank_mask:0xf
    v_mov_b32 v12, v96
    s_nop 1
    v_permlane16_swap_b32 v96, v12
    s_nop 0
    v_add_f32 v96, v96, v12
    v_mul_f32 v96, 0x3acccccd, v96
    v_cvt_pk_bf16_f32 v96, v96, v96
    v_and_b32 v96, 0xffff0000, v96
    v_add_f32 v96, 0x3727c5ac, v96
    v_cvt_pk_bf16_f32 v96, v96, v96
    v_and_b32 v96, 0xffff0000, v96
    v_sqrt_f32 v96, v96
    v_lshlrev_b32 v21, 3, v21
    v_cvt_pk_bf16_f32 v96, v96, v96
    v_and_b32 v96, 0xffff0000, v96
    v_rcp_f32 v95, v96
    v_cvt_pk_bf16_f32 v94, v94, v94
    v_and_b32 v94, 0xffff0000, v94
    v_and_b32 v12, 31, v1
    v_cmp_eq_u32 vcc, 0, v12
    v_mov_b32 v12, 0x40000000
    s_mov_b32 s54, 0xa00000
    v_cndmask_b32 v21, v12, v21, vcc
    buffer_store_dwordx2 v[94:95], v21, s[28:31], s54 offen sc1
    s_cmp_ge_u32 s2, 64
    s_cbranch_scc1 L_rs3_1
    s_waitcnt vmcnt(2)
    v_lshlrev_b32 v64, 16, v104
    v_and_b32 v65, 0xffff0000, v104
    v_lshlrev_b32 v66, 16, v105
    v_and_b32 v67, 0xffff0000, v105
    v_lshlrev_b32 v68, 16, v106
    v_and_b32 v69, 0xffff0000, v106
    v_lshlrev_b32 v70, 16, v107
    v_and_b32 v71, 0xffff0000, v107
    v_lshlrev_b32 v72, 16, v108
    v_and_b32 v73, 0xffff0000, v108
    v_lshlrev_b32 v74, 16, v109
    v_and_b32 v75, 0xffff0000, v109
    v_lshlrev_b32 v76, 16, v110
    v_and_b32 v77, 0xffff0000, v110
    v_lshlrev_b32 v78, 16, v111
    v_and_b32 v79, 0xffff0000, v111
    v_lshlrev_b32 v80, 16, v112
    v_and_b32 v81, 0xffff0000, v112
    v_lshlrev_b32 v82, 16, v113
    v_and_b32 v83, 0xffff0000, v113
    v_pk_add_f32 v[104:105], v[64:65], v[66:67]
    v_pk_add_f32 v[106:107], v[68:69], v[70:71]
    v_pk_add_f32 v[104:105], v[104:105], v[72:73]
    v_pk_add_f32 v[106:107], v[106:107], v[74:75]
    v_pk_add_f32 v[104:105], v[104:105], v[76:77]
    v_pk_add_f32 v[106:107], v[106:107], v[78:79]
    v_pk_add_f32 v[104:105], v[104:105], v[80:81]
    v_pk_add_f32 v[106:107], v[106:107], v[82:83]
    v_pk_add_f32 v[104:105], v[104:105], v[106:107]
    v_add_f32 v104, v104, v105
    s_nop 1
    v_add_f32_dpp v104, v104, v104 row_ror:8 row_mask:0xf bank_mask:0xf
    s_nop 1
    v_add_f32_dpp v104, v104, v104 row_ror:4 row_mask:0xf bank_mask:0xf
    s_nop 1
    v_add_f32_dpp v104, v104, v104 row_ror:2 row_mask:0xf bank_mask:0xf
    s_nop 1
    v_add_f32_dpp v104, v104, v104 row_ror:1 row_mask:0xf bank_mask:0xf
    v_mov_b32 v12, v104
    s_nop 1
    v_permlane16_swap_b32 v104, v12
    s_nop 0
    v_add_f32 v104, v104, v12
    v_mul_f32 v104, 0xbacccccd, v104
    v_pk_add_f32 v[64:65], v[64:65], v[104:105] op_sel_hi:[1,0]
    v_pk_add_f32 v[66:67], v[66:67], v[104:105] op_sel_hi:[1,0]
    v_pk_add_f32 v[68:69], v[68:69], v[104:105] op_sel_hi:[1,0]
    v_pk_add_f32 v[70:71], v[70:71], v[104:105] op_sel_hi:[1,0]
    v_pk_add_f32 v[72:73], v[72:73], v[104:105] op_sel_hi:[1,0]
    v_pk_add_f32 v[74:75], v[74:75], v[104:105] op_sel_hi:[1,0]
    v_pk_add_f32 v[76:77], v[76:77], v[104:105] op_sel_hi:[1,0]
    v_pk_add_f32 v[78:79], v[78:79], v[104:105] op_sel_hi:[1,0]
    v_pk_add_f32 v[80:81], v[80:81], v[104:105] op_sel_hi:[1,0]
    v_pk_add_f32 v[82:83], v[82:83], v[104:105] op_sel_hi:[1,0]
    v_pk_mul_f32 v[106:107], v[64:65], v[64:65]
    v_pk_mul_f32 v[108:109], v[66:67], v[66:67]
    v_pk_fma_f32 v[106:107], v[68:69], v[68:69], v[106:107]
    v_pk_fma_f32 v[108:109], v[70:71], v[70:71], v[108:109]
    v_pk_fma_f32 v[106:107], v[72:73], v[72:73], v[106:107]
    v_pk_fma_f32 v[108:109], v[74:75], v[74:75], v[108:109]
    v_pk_fma_f32 v[106:107], v[76:77], v[76:77], v[106:107]
    v_pk_fma_f32 v[108:109], v[78:79], v[78:79], v[108:109]
    v_pk_fma_f32 v[106:107], v[80:81], v[80:81], v[106:107]
    v_pk_fma_f32 v[108:109], v[82:83], v[82:83], v[108:109]
    v_pk_add_f32 v[106:107], v[106:107], v[108:109]
    v_add_f32 v106, v106, v107
    s_nop 1
    v_add_f32_dpp v106, v106, v106 row_ror:8 row_mask:0xf bank_mask:0xf
    s_nop 1
    v_add_f32_dpp v106, v106, v106 row_ror:4 row_mask:0xf bank_mask:0xf
    s_nop 1
    v_add_f32_dpp v106, v106, v106 row_ror:2 row_mask:0xf bank_mask:0xf
    s_nop 1
    v_add_f32_dpp v106, v106, v106 row_ror:1 row_mask:0xf bank_mask:0xf
    v_mov_b32 v12, v106
    s_nop 1
    v_permlane16_swap_b32 v106, v12
    s_nop 0
    v_add_f32 v106, v106, v12
    v_mul_f32 v106, 0x3acccccd, v106
    v_cvt_pk_bf16_f32 v106, v106, v106
    v_and_b32 v106, 0xffff0000, v106
    v_add_f32 v106, 0x3727c5ac, v106
    v_cvt_pk_bf16_f32 v106, v106, v106
    v_and_b32 v106, 0xffff0000, v106
    v_sqrt_f32 v106, v106
    v_lshlrev_b32 v22, 3, v22
    v_cvt_pk_bf16_f32 v106, v106, v106
    v_and_b32 v106, 0xffff0000, v106
    v_rcp_f32 v105, v106
    v_cvt_pk_bf16_f32 v104, v104, v104
    v_and_b32 v104, 0xffff0000, v104
    v_and_b32 v12, 31, v1
    v_cmp_eq_u32 vcc, 0, v12
    v_mov_b32 v12, 0x40000000
    s_mov_b32 s54, 0xa00000
    v_cndmask_b32 v22, v12, v22, vcc
    buffer_store_dwordx2 v[104:105], v22, s[28:31], s54 offen sc1
L_rs3_1:
    s_add_u32 m0, s58, 0x0
    s_nop 0
    buffer_load_dwordx4 v2, s[24:27], s56 offen  lds
    s_add_u32 m0, s58, 0x400
    s_nop 0
    buffer_load_dwordx4 v3, s[24:27], s56 offen  lds
    s_add_u32 m0, s58, 0x800
    s_nop 0
    buffer_load_dwordx4 v4, s[24:27], s56 offen  lds
    s_add_u32 m0, s58, 0xc00
    s_nop 0
    buffer_load_dwordx4 v5, s[24:27], s56 offen  lds
    s_add_u32 m0, s58, 0x1000
    s_nop 0
    buffer_load_dwordx4 v6, s[24:27], s56 offen  lds
    s_add_u32 m0, s58, 0x1400
    s_nop 0
    buffer_load_dwordx4 v7, s[24:27], s56 offen  lds
    s_lshl_b32 s52, s51, 6
    s_mul_i32 s54, s50, 160
    v_add_u32 v16, s52, v1
    v_mul_u32_u24 v12, 2185, v16
    v_lshrrev_b32 v12, 16, v12
    v_mul_u32_u24 v13, 30, v12
    v_sub_u32 v13, v16, v13
    v_mul_u32_u24 v14, 26, v13
    v_lshrrev_b32 v14, 8, v14
    v_mul_u32_u24 v14, 1120, v14
    v_lshl_add_u32 v14, v13, 4, v14
    v_and_b32 v13, 12, v12
    v_add_u32 v13, v13, v12
    v_lshrrev_b32 v15, 4, v12
    v_mul_u32_u24 v15, 12, v15
    v_sub_u32 v13, v13, v15
    v_mul_u32_u24 v13, 3840, v13
    v_add3_u32 v8, v13, v14, s54
    v_add_u32 v16, 0x100, v16
    v_mul_u32_u24 v12, 2185, v16
    v_lshrrev_b32 v12, 16, v12
    v_mul_u32_u24 v13, 30, v12
    v_sub_u32 v13, v16, v13
    v_mul_u32_u24 v14, 26, v13
    v_lshrrev_b32 v14, 8, v14
    v_mul_u32_u24 v14, 1120, v14
    v_lshl_add_u32 v14, v13, 4, v14
    v_and_b32 v13, 12, v12
    v_add_u32 v13, v13, v12
    v_lshrrev_b32 v15, 4, v12
    v_mul_u32_u24 v15, 12, v15
    v_sub_u32 v13, v13, v15
    v_mul_u32_u24 v13, 3840, v13
    v_add3_u32 v9, v13, v14, s54
    v_add_u32 v16, 0x100, v16
    v_mul_u32_u24 v12, 2185, v16
    v_lshrrev_b32 v12, 16, v12
    v_mul_u32_u24 v13, 30, v12
    v_sub_u32 v13, v16, v13
    v_mul_u32_u24 v14, 26, v13
    v_lshrrev_b32 v14, 8, v14
    v_mul_u32_u24 v14, 1120, v14
    v_lshl_add_u32 v14, v13, 4, v14
    v_and_b32 v13, 12, v12
    v_add_u32 v13, v13, v12
    v_lshrrev_b32 v15, 4, v12
    v_mul_u32_u24 v15, 12, v15
    v_sub_u32 v13, v13, v15
    v_mul_u32_u24 v13, 3840, v13
    v_add3_u32 v10, v13, v14, s54
    v_add_u32 v16, 0x100, v16
    v_mul_u32_u24 v12, 2185, v16
    v_lshrrev_b32 v12, 16, v12
    v_mul_u32_u24 v13, 30, v12
    v_sub_u32 v13, v16, v13
    v_mul_u32_u24 v14, 26, v13
    v_lshrrev_b32 v14, 8, v14
    v_mul_u32_u24 v14, 1120, v14
    v_lshl_add_u32 v14, v13, 4, v14
    v_and_b32 v13, 12, v12
    v_add_u32 v13, v13, v12
    v_lshrrev_b32 v15, 4, v12
    v_mul_u32_u24 v15, 12, v15
    v_sub_u32 v13, v13, v15
    v_mul_u32_u24 v13, 3840, v13
    v_add3_u32 v11, v13, v14, s54
    s_cmp_eq_u32 s51, 3
    s_cselect_b32 s52, 0x40000000, 0
    v_or_b32 v11, s52, v11
    s_mov_b32 s36, s6
    s_and_b32 s37, s7, 0xffff
    s_mov_b32 s38, 0x258000
    s_mov_b32 s39, 0x20000
    s_mov_b32 s40, s6
    s_and_b32 s41, s7, 0xffff
    s_mov_b32 s42, 0x258000
    s_mov_b32 s43, 0x20000
L_loader:
    s_lshl_b32 s59, s51, 10
    s_add_u32 m0, s59, 0x12000
    s_nop 0
    buffer_load_dwordx4 v8, s[36:39], s57 offen  lds
    s_add_u32 m0, s59, 0x13000
    s_nop 0
    buffer_load_dwordx4 v9, s[36:39], s57 offen  lds
    s_add_u32 m0, s59, 0x14000
    s_nop 0
    buffer_load_dwordx4 v10, s[40:43], s57 offen  lds
    s_add_u32 m0, s59, 0x15000
    s_nop 0
    buffer_load_dwordx4 v11, s[40:43], s57 offen  lds
    s_add_u32 s57, s57, s66
    s_cmp_ge_u32 s57, s67
    s_cselect_b32 s57, 0, s57
    s_add_u32 m0, s59, 0x16000
    s_nop 0
    buffer_load_dwordx4 v8, s[36:39], s57 offen  lds
    s_add_u32 m0, s59, 0x17000
    s_nop 0
    buffer_load_dwordx4 v9, s[36:39], s57 offen  lds
    s_add_u32 m0, s59, 0x18000
    s_nop 0
    buffer_load_dwordx4 v10, s[40:43], s57 offen  lds
    s_add_u32 m0, s59, 0x19000
    s_nop 0
    buffer_load_dwordx4 v11, s[40:43], s57 offen  lds
    s_add_u32 s57, s57, s66
    s_cmp_ge_u32 s57, s67
    s_cselect_b32 s57, 0, s57
    s_add_u32 s56, s56, 0x80
    s_cmp_ge_u32 s56, 0x500
    s_cselect_b32 s56, 0, s56
    s_mov_b32 s28, s22
    s_and_b32 s29, s23, 0xffff
    s_mov_b32 s30, 0xf20000
    s_mov_b32 s31, 0x20000
    v_cmp_gt_u32 vcc, 32, v1
    v_lshlrev_b32 v12, 2, v1
    v_mov_b32 v13, 0x40000000
    v_cndmask_b32 v12, v13, v12, vcc
    s_mul_i32 s75, s2, 4352
    s_add_u32 s75, s75, 0xe00000
    s_lshl_b32 s54, s51, 7
    s_add_u32 s54, s54, s75
    v_mov_b32 v13, 0
    buffer_store_dword v13, v12, s[28:31], s54 offen sc1
    s_add_u32 s75, s75, 128
    s_cmp_eq_u32 s68, 1
    s_cbranch_scc1 L_s2q_2
    s_cmp_lt_u32 s51, 2
    s_cselect_b32 s72, 0, 6400
    s_lshl_b32 s53, s51, 6
    v_add_u32 v19, s53, v1
    v_lshlrev_b32 v19, 2, v19
    s_lshl_b32 s53, s50, 9
    s_add_u32 s72, s72, s53
    s_add_u32 s72, s72, 0xa11e00
    s_branch L_s2d_3
L_s2q_2:
    s_lshl_b32 s53, s51, 6
    v_add_u32 v19, s53, v1
    v_mul_u32_u24 v14, 820, v19
    v_lshrrev_b32 v14, 16, v14
    v_mul_u32_u24 v14, 560, v14
    v_add_lshl_u32 v19, v19, v14, 2
    s_mul_i32 s72, s50, 320
    s_add_u32 s72, s72, 0xa10000
    s_mul_i32 s52, s51, 48
    v_bfe_u32 v32, v1, 1, 3
    v_mul_u32_u24 v32, 6, v32
    v_and_b32 v44, 1, v1
    v_add3_u32 v32, v32, v44, s52
    v_lshlrev_b32 v39, 3, v32
    v_add_u32 v39, 0x26000, v39
    v_lshrrev_b32 v45, 4, v1
    v_mul_u32_u24 v35, 80, v45
    v_add_u32 v35, 0x26800, v35
    v_mul_u32_u24 v33, 3328, v45
    v_lshl_add_u32 v33, v32, 4, v33
    v_add_u32 v33, 32, v33
    v_add_u32 v34, 53248, v33
    s_mul_i32 s53, s51, 6912
    s_add_u32 s53, s53, 106496
    v_mul_u32_u24 v36, 1536, v45
    v_lshl_add_u32 v38, v32, 4, s53
    v_add_u32 v36, v36, v38
    v_and_b32 v37, 1, v45
    v_mul_u32_u24 v37, 768, v37
    v_lshrrev_b32 v44, 1, v45
    v_lshl_add_u32 v37, v44, 3, v37
    v_add_u32 v37, v37, v38
    v_add_u32 v37, 6144, v37
    s_mul_i32 s53, s51, 7680
    s_add_u32 s53, s53, 106496
    v_lshl_add_u32 v38, v1, 4, s53
    s_mov_b32 s54, 151552
    s_mul_i32 s60, s49, 176
    s_add_u32 s61, s60, 176
    s_min_u32 s61, s61, 2048
    s_sub_u32 s61, s61, s60
    s_add_u32 s53, s64, s52
    v_mov_b32 v48, 0x40000000
    v_cmp_le_u32 vcc, 48, v1
    v_add_u32 v46, 0, v1
    v_mov_b32 v47, 0
    v_cndmask_b32 v44, 0, 48, vcc
    v_sub_u32 v46, v46, v44
    v_add_u32 v46, s53, v46
    v_cndmask_b32 v44, 0, 1, vcc
    v_lshl_add_u32 v47, v44, 9, v47
    v_lshrrev_b32 v44, 5, v46
    v_mul_lo_u32 v44, v44, s54
    v_add_u32 v47, v47, v44
    v_and_b32 v44, 31, v46
    v_lshl_add_u32 v47, v44, 4, v47
    v_subrev_u32 v46, s60, v46
    v_cmp_gt_u32 vcc, s61, v46
    s_nop 1
    v_cndmask_b32 v40, v48, v47, vcc
    v_cmp_le_u32 vcc, 32, v1
    v_add_u32 v46, 16, v1
    v_mov_b32 v47, 512
    v_cndmask_b32 v44, 0, 48, vcc
    v_sub_u32 v46, v46, v44
    v_add_u32 v46, s53, v46
    v_cndmask_b32 v44, 0, 1, vcc
    v_lshl_add_u32 v47, v44, 9, v47
    v_lshrrev_b32 v44, 5, v46
    v_mul_lo_u32 v44, v44, s54
    v_add_u32 v47, v47, v44
    v_and_b32 v44, 31, v46
    v_lshl_add_u32 v47, v44, 4, v47
    v_subrev_u32 v46, s60, v46
    v_cmp_gt_u32 vcc, s61, v46
    s_nop 1
    v_cndmask_b32 v41, v48, v47, vcc
    v_cmp_le_u32 vcc, 16, v1
    v_add_u32 v46, 32, v1
    v_mov_b32 v47, 1024
    v_cndmask_b32 v44, 0, 48, vcc
    v_sub_u32 v46, v46, v44
    v_add_u32 v46, s53, v46
    v_cndmask_b32 v44, 0, 1, vcc
    v_lshl_add_u32 v47, v44, 9, v47
    v_lshrrev_b32 v44, 5, v46
    v_mul_lo_u32 v44, v44, s54
    v_add_u32 v47, v47, v44
    v_and_b32 v44, 31, v46
    v_lshl_add_u32 v47, v44, 4, v47
    v_subrev_u32 v46, s60, v46
    v_cmp_gt_u32 vcc, s61, v46
    s_nop 1
    v_cndmask_b32 v42, v48, v47, vcc
    v_cmp_gt_u32 vcc, 32, v1
    s_mul_i32 s53, s51, 3072
    s_add_u32 s53, s53, 139264
    v_cndmask_b32 v43, v48, v41, vcc
    v_lshl_add_u32 v44, v1, 4, s53
    ds_write_b128 v44, v[32:35] offset:0
    ds_write_b128 v44, v[36:39] offset:1024
    ds_write_b128 v44, v[40:43] offset:2048
    s_waitcnt vmcnt(0) lgkmcnt(0)
L_s2d_3:
    v_mov_b32 v17, 0
    s_waitcnt vmcnt(5)
    s_barrier
L_nb0_4:
    s_add_u32 m0, s58, 0x6000
    s_nop 0
    buffer_load_dwordx4 v2, s[24:27], s56 offen  lds
    s_add_u32 m0, s58, 0x6400
    s_nop 0
    buffer_load_dwordx4 v3, s[24:27], s56 offen  lds
    s_add_u32 m0, s58, 0x6800
    s_nop 0
    buffer_load_dwordx4 v4, s[24:27], s56 offen  lds
    s_add_u32 m0, s58, 0x6c00
    s_nop 0
    buffer_load_dwordx4 v5, s[24:27], s56 offen  lds
    s_add_u32 m0, s58, 0x7000
    s_nop 0
    buffer_load_dwordx4 v6, s[24:27], s56 offen  lds
    s_add_u32 m0, s58, 0x7400
    s_nop 0
    buffer_load_dwordx4 v7, s[24:27], s56 offen  lds
    s_add_u32 s56, s56, 0x80
    s_cmp_ge_u32 s56, 0x500
    s_cselect_b32 s56, 0, s56
    s_add_u32 m0, s59, 0x1a000
    s_nop 0
    buffer_load_dwordx4 v8, s[36:39], s57 offen  lds
    s_add_u32 m0, s59, 0x1b000
    s_nop 0
    buffer_load_dwordx4 v9, s[36:39], s57 offen  lds
    s_add_u32 m0, s59, 0x1c000
    s_nop 0
    buffer_load_dwordx4 v10, s[40:43], s57 offen  lds
    s_add_u32 m0, s59, 0x1d000
    s_nop 0
    buffer_load_dwordx4 v11, s[40:43], s57 offen  lds
    s_add_u32 s57, s57, s66
    s_cmp_ge_u32 s57, s67
    s_cselect_b32 s57, 0, s57
    s_add_u32 m0, s59, 0x1e000
    s_nop 0
    buffer_load_dwordx4 v8, s[36:39], s57 offen  lds
    s_add_u32 m0, s59, 0x1f000
    s_nop 0
    buffer_load_dwordx4 v9, s[36:39], s57 offen  lds
    s_add_u32 m0, s59, 0x20000
    s_nop 0
    buffer_load_dwordx4 v10, s[40:43], s57 offen  lds
    s_add_u32 m0, s59, 0x21000
    s_nop 0
    buffer_load_dwordx4 v11, s[40:43], s57 offen  lds
    s_add_u32 s57, s57, s66
    s_cmp_ge_u32 s57, s67
    s_cselect_b32 s57, 0, s57
    s_waitcnt vmcnt(15)
    s_barrier
    s_add_u32 m0, s59, 0x12000
    s_nop 0
    buffer_load_dwordx4 v8, s[36:39], s57 offen  lds
    s_add_u32 m0, s59, 0x13000
    s_nop 0
    buffer_load_dwordx4 v9, s[36:39], s57 offen  lds
    s_add_u32 m0, s59, 0x14000
    s_nop 0
    buffer_load_dwordx4 v10, s[40:43], s57 offen  lds
    s_add_u32 m0, s59, 0x15000
    s_nop 0
    buffer_load_dwordx4 v11, s[40:43], s57 offen  lds
    s_add_u32 s57, s57, s66
    s_cmp_ge_u32 s57, s67
    s_cselect_b32 s57, 0, s57
    s_add_u32 m0, s58, 0xc000
    s_nop 0
    buffer_load_dwordx4 v2, s[24:27], s56 offen  lds
    s_add_u32 m0, s58, 0xc400
    s_nop 0
    buffer_load_dwordx4 v3, s[24:27], s56 offen  lds
    s_add_u32 m0, s58, 0xc800
    s_nop 0
    buffer_load_dwordx4 v4, s[24:27], s56 offen  lds
    s_add_u32 m0, s58, 0xcc00
    s_nop 0
    buffer_load_dwordx4 v5, s[24:27], s56 offen  lds
    s_add_u32 m0, s58, 0xd000
    s_nop 0
    buffer_load_dwordx4 v6, s[24:27], s56 offen  lds
    s_add_u32 m0, s58, 0xd400
    s_nop 0
    buffer_load_dwordx4 v7, s[24:27], s56 offen  lds
    s_add_u32 s56, s56, 0x80
    s_cmp_ge_u32 s56, 0x500
    s_cselect_b32 s56, 0, s56
    s_waitcnt vmcnt(14)
    s_barrier
    s_add_u32 m0, s59, 0x16000
    s_nop 0
    buffer_load_dwordx4 v8, s[36:39], s57 offen  lds
    s_add_u32 m0, s59, 0x17000
    s_nop 0
    buffer_load_dwordx4 v9, s[36:39], s57 offen  lds
    s_add_u32 m0, s59, 0x18000
    s_nop 0
    buffer_load_dwordx4 v10, s[40:43], s57 offen  lds
    s_add_u32 m0, s59, 0x19000
    s_nop 0
    buffer_load_dwordx4 v11, s[40:43], s57 offen  lds
    s_add_u32 s57, s57, s66
    s_cmp_ge_u32 s57, s67
    s_cselect_b32 s57, 0, s57
    s_add_u32 m0, s58, 0x0
    s_nop 0
    buffer_load_dwordx4 v2, s[24:27], s56 offen  lds
    s_add_u32 m0, s58, 0x400
    s_nop 0
    buffer_load_dwordx4 v3, s[24:27], s56 offen  lds
    s_add_u32 m0, s58, 0x800
    s_nop 0
    buffer_load_dwordx4 v4, s[24:27], s56 offen  lds
    s_waitcnt vmcnt(17)
    s_barrier
    s_add_u32 m0, s59, 0x1a000
    s_nop 0
    buffer_load_dwordx4 v8, s[36:39], s57 offen  lds
    s_add_u32 m0, s59, 0x1b000
    s_nop 0
    buffer_load_dwordx4 v9, s[36:39], s57 offen  lds
    s_add_u32 m0, s59, 0x1c000
    s_nop 0
    buffer_load_dwordx4 v10, s[40:43], s57 offen  lds
    s_add_u32 m0, s59, 0x1d000
    s_nop 0
    buffer_load_dwordx4 v11, s[40:43], s57 offen  lds
    s_add_u32 s57, s57, s66
    s_cmp_ge_u32 s57, s67
    s_cselect_b32 s57, 0, s57
    s_add_u32 m0, s58, 0xc00
    s_nop 0
    buffer_load_dwordx4 v5, s[24:27], s56 offen  lds
    s_add_u32 m0, s58, 0x1000
    s_nop 0
    buffer_load_dwordx4 v6, s[24:27], s56 offen  lds
    s_add_u32 m0, s58, 0x1400
    s_nop 0
    buffer_load_dwordx4 v7, s[24:27], s56 offen  lds
    s_add_u32 s56, s56, 0x80
    s_cmp_ge_u32 s56, 0x500
    s_cselect_b32 s56, 0, s56
    s_lshl2_add_u32 s52, s2, s51
    s_sub_u32 s52, s52, 0
    s_cmp_lt_u32 s52, 270
    s_cselect_b64 s[44:45], s[16:17], s[8:9]
    s_cselect_b32 s46, 0x154000, 0
    s_cselect_b32 s54, 0, 270
    s_add_u32 s46, s46, 0xc8000
    s_and_b32 s45, s45, 0xffff
    s_mov_b32 s47, 0x20000
    s_sub_u32 s52, s52, s54
    s_min_u32 s52, s52, 1000
    s_lshl_b32 s52, s52, 13
    v_lshlrev_b32 v14, 7, v1
    buffer_load_dword v0, v14, s[44:47], s52 offen
    s_waitcnt vmcnt(15)
    s_barrier
    s_add_u32 m0, s59, 0x1e000
    s_nop 0
    buffer_load_dwordx4 v8, s[36:39], s57 offen  lds
    s_add_u32 m0, s59, 0x1f000
    s_nop 0
    buffer_load_dwordx4 v9, s[36:39], s57 offen  lds
    s_add_u32 m0, s59, 0x20000
    s_nop 0
    buffer_load_dwordx4 v10, s[40:43], s57 offen  lds
    s_add_u32 m0, s59, 0x21000
    s_nop 0
    buffer_load_dwordx4 v11, s[40:43], s57 offen  lds
    s_add_u32 s57, s57, s66
    s_cmp_ge_u32 s57, s67
    s_cselect_b32 s57, 0, s57
    s_add_u32 m0, s58, 0x6000
    s_nop 0
    buffer_load_dwordx4 v2, s[24:27], s56 offen  lds
    s_add_u32 m0, s58, 0x6400
    s_nop 0
    buffer_load_dwordx4 v3, s[24:27], s56 offen  lds
    s_add_u32 m0, s58, 0x6800
    s_nop 0
    buffer_load_dwordx4 v4, s[24:27], s56 offen  lds
    s_waitcnt vmcnt(18)
    s_barrier
    s_add_u32 m0, s59, 0x12000
    s_nop 0
    buffer_load_dwordx4 v8, s[36:39], s57 offen  lds
    s_add_u32 m0, s59, 0x13000
    s_nop 0
    buffer_load_dwordx4 v9, s[36:39], s57 offen  lds
    s_add_u32 m0, s59, 0x14000
    s_nop 0
    buffer_load_dwordx4 v10, s[40:43], s57 offen  lds
    s_add_u32 m0, s59, 0x15000
    s_nop 0
    buffer_load_dwordx4 v11, s[40:43], s57 offen  lds
    s_add_u32 s57, s57, s66
    s_cmp_ge_u32 s57, s67
    s_cselect_b32 s57, 0, s57
    s_add_u32 m0, s58, 0x6c00
    s_nop 0
    buffer_load_dwordx4 v5, s[24:27], s56 offen  lds
    s_add_u32 m0, s58, 0x7000
    s_nop 0
    buffer_load_dwordx4 v6, s[24:27], s56 offen  lds
    s_add_u32 m0, s58, 0x7400
    s_nop 0
    buffer_load_dwordx4 v7, s[24:27], s56 offen  lds
    s_add_u32 s56, s56, 0x80
    s_cmp_ge_u32 s56, 0x500
    s_cselect_b32 s56, 0, s56
    s_waitcnt vmcnt(15)
    s_barrier
    s_add_u32 m0, s59, 0x16000
    s_nop 0
    buffer_load_dwordx4 v8, s[36:39], s57 offen  lds
    s_add_u32 m0, s59, 0x17000
    s_nop 0
    buffer_load_dwordx4 v9, s[36:39], s57 offen  lds
    s_add_u32 m0, s59, 0x18000
    s_nop 0
    buffer_load_dwordx4 v10, s[40:43], s57 offen  lds
    s_add_u32 m0, s59, 0x19000
    s_nop 0
    buffer_load_dwordx4 v11, s[40:43], s57 offen  lds
    s_add_u32 s57, s57, s66
    s_cmp_ge_u32 s57, s67
    s_cselect_b32 s57, 0, s57
    s_add_u32 m0, s58, 0xc000
    s_nop 0
    buffer_load_dwordx4 v2, s[24:27], s56 offen  lds
    s_add_u32 m0, s58, 0xc400
    s_nop 0
    buffer_load_dwordx4 v3, s[24:27], s56 offen  lds
    s_add_u32 m0, s58, 0xc800
    s_nop 0
    buffer_load_dwordx4 v4, s[24:27], s56 offen  lds
    s_waitcnt vmcnt(17)
    s_barrier
    s_add_u32 m0, s59, 0x1a000
    s_nop 0
    buffer_load_dwordx4 v8, s[36:39], s57 offen  lds
    s_add_u32 m0, s59, 0x1b000
    s_nop 0
    buffer_load_dwordx4 v9, s[36:39], s57 offen  lds
    s_add_u32 m0, s59, 0x1c000
    s_nop 0
    buffer_load_dwordx4 v10, s[40:43], s57 offen  lds
    s_add_u32 m0, s59, 0x1d000
    s_nop 0
    buffer_load_dwordx4 v11, s[40:43], s57 offen  lds
    s_add_u32 s57, s57, s66
    s_cmp_ge_u32 s57, s67
    s_cselect_b32 s57, 0, s57
    s_add_u32 m0, s58, 0xcc00
    s_nop 0
    buffer_load_dwordx4 v5, s[24:27], s56 offen  lds
    s_add_u32 m0, s58, 0xd000
    s_nop 0
    buffer_load_dwordx4 v6, s[24:27], s56 offen  lds
    s_add_u32 m0, s58, 0xd400
    s_nop 0
    buffer_load_dwordx4 v7, s[24:27], s56 offen  lds
    s_add_u32 s56, s56, 0x80
    s_cmp_ge_u32 s56, 0x500
    s_cselect_b32 s56, 0, s56
    s_waitcnt vmcnt(14)
    s_barrier
    s_add_u32 m0, s59, 0x1e000
    s_nop 0
    buffer_load_dwordx4 v8, s[36:39], s57 offen  lds
    s_add_u32 m0, s59, 0x1f000
    s_nop 0
    buffer_load_dwordx4 v9, s[36:39], s57 offen  lds
    s_add_u32 m0, s59, 0x20000
    s_nop 0
    buffer_load_dwordx4 v10, s[40:43], s57 offen  lds
    s_add_u32 m0, s59, 0x21000
    s_nop 0
    buffer_load_dwordx4 v11, s[40:43], s57 offen  lds
    s_add_u32 s57, s57, s66
    s_cmp_ge_u32 s57, s67
    s_cselect_b32 s57, 0, s57
    s_add_u32 m0, s58, 0x0
    s_nop 0
    buffer_load_dwordx4 v2, s[24:27], s56 offen  lds
    s_add_u32 m0, s58, 0x400
    s_nop 0
    buffer_load_dwordx4 v3, s[24:27], s56 offen  lds
    s_add_u32 m0, s58, 0x800
    s_nop 0
    buffer_load_dwordx4 v4, s[24:27], s56 offen  lds
    s_waitcnt vmcnt(17)
    s_barrier
    s_add_u32 m0, s59, 0x12000
    s_nop 0
    buffer_load_dwordx4 v8, s[36:39], s57 offen  lds
    s_add_u32 m0, s59, 0x13000
    s_nop 0
    buffer_load_dwordx4 v9, s[36:39], s57 offen  lds
    s_add_u32 m0, s59, 0x14000
    s_nop 0
    buffer_load_dwordx4 v10, s[40:43], s57 offen  lds
    s_add_u32 m0, s59, 0x15000
    s_nop 0
    buffer_load_dwordx4 v11, s[40:43], s57 offen  lds
    s_add_u32 s57, s57, s66
    s_cmp_ge_u32 s57, s67
    s_cselect_b32 s57, 0, s57
    s_add_u32 m0, s58, 0xc00
    s_nop 0
    buffer_load_dwordx4 v5, s[24:27], s56 offen  lds
    s_add_u32 m0, s58, 0x1000
    s_nop 0
    buffer_load_dwordx4 v6, s[24:27], s56 offen  lds
    s_add_u32 m0, s58, 0x1400
    s_nop 0
    buffer_load_dwordx4 v7, s[24:27], s56 offen  lds
    s_add_u32 s56, s56, 0x80
    s_cmp_ge_u32 s56, 0x500
    s_cselect_b32 s56, 0, s56
    s_waitcnt vmcnt(14)
    s_barrier
    s_add_u32 m0, s59, 0x16000
    s_nop 0
    buffer_load_dwordx4 v8, s[36:39], s57 offen  lds
    s_add_u32 m0, s59, 0x17000
    s_nop 0
    buffer_load_dwordx4 v9, s[36:39], s57 offen  lds
    s_add_u32 m0, s59, 0x18000
    s_nop 0
    buffer_load_dwordx4 v10, s[40:43], s57 offen  lds
    s_add_u32 m0, s59, 0x19000
    s_nop 0
    buffer_load_dwordx4 v11, s[40:43], s57 offen  lds
    s_add_u32 s57, s57, s66
    s_cmp_ge_u32 s57, s67
    s_cselect_b32 s57, 0, s57
    s_add_u32 m0, s58, 0x6000
    s_nop 0
    buffer_load_dwordx4 v2, s[24:27], s56 offen  lds
    s_add_u32 m0, s58, 0x6400
    s_nop 0
    buffer_load_dwordx4 v3, s[24:27], s56 offen  lds
    s_add_u32 m0, s58, 0x6800
    s_nop 0
    buffer_load_dwordx4 v4, s[24:27], s56 offen  lds
    s_waitcnt vmcnt(17)
    s_barrier
    s_add_u32 m0, s59, 0x1a000
    s_nop 0
    buffer_load_dwordx4 v8, s[36:39], s57 offen  lds
    s_add_u32 m0, s59, 0x1b000
    s_nop 0
    buffer_load_dwordx4 v9, s[36:39], s57 offen  lds
    s_add_u32 m0, s59, 0x1c000
    s_nop 0
    buffer_load_dwordx4 v10, s[40:43], s57 offen  lds
    s_add_u32 m0, s59, 0x1d000
    s_nop 0
    buffer_load_dwordx4 v11, s[40:43], s57 offen  lds
    s_add_u32 s57, s57, s66
    s_cmp_ge_u32 s57, s67
    s_cselect_b32 s57, 0, s57
    s_add_u32 m0, s58, 0x6c00
    s_nop 0
    buffer_load_dwordx4 v5, s[24:27], s56 offen  lds
    s_add_u32 m0, s58, 0x7000
    s_nop 0
    buffer_load_dwordx4 v6, s[24:27], s56 offen  lds
    s_add_u32 m0, s58, 0x7400
    s_nop 0
    buffer_load_dwordx4 v7, s[24:27], s56 offen  lds
    s_add_u32 s56, s56, 0x80
    s_cmp_ge_u32 s56, 0x500
    s_cselect_b32 s56, 0, s56
    s_mov_b32 s44, s16
    s_and_b32 s45, s17, 0xffff
    s_mov_b32 s46, 0x21c000
    s_mov_b32 s47, 0x20000
    s_mov_b32 s76, s8
    s_and_b32 s77, s9, 0xffff
    s_mov_b32 s78, 0xc8000
    s_mov_b32 s79, 0x20000
    v_bfe_u32 v13, v1, 4, 1
    v_lshlrev_b32 v13, 2, v13
    v_and_b32 v12, 7, v1
    v_xor_b32 v13, v13, v12
    v_lshlrev_b32 v13, 4, v13
    s_lshl_b32 s52, s74, 7
    v_add_u32 v13, s52, v13
    v_lshrrev_b32 v12, 3, v1
    v_mul_u32_u24 v12, 1280, v12
    v_add_u32 v20, v12, v13
    s_mul_i32 s52, s51, 30720
    v_add_u32 v23, s52, v20
    v_lshrrev_b32 v12, 5, v1
    v_mul_u32_u24 v12, 20, v12
    v_bfe_u32 v21, v1, 3, 2
    v_add3_u32 v12, v12, v21, 16
    v_mul_u32_u24 v12, 1280, v12
    v_add_u32 v21, v12, v13
    s_mov_b32 s52, 0
    s_mul_i32 s60, s52, 122880
    s_mul_i32 s61, s52, 6144
    s_mul_i32 s62, s51, 3072
    s_and_b32 s63, s51, 1
    s_lshr_b32 s71, s51, 1
    s_mul_i32 s52, s63, 409600
    s_mul_i32 s54, s71, 10240
    s_add_u32 s52, s52, s54
    s_mul_i32 s54, s71, 40960
    v_add_u32 v21, s54, v21
    s_mul_i32 s53, s63, 1105920
    s_mul_i32 s54, s71, 61440
    s_add_u32 s53, s53, s54
    s_cmp_ge_u32 s74, 10
    s_cselect_b32 s52, 0x40000000, s52
    s_cselect_b32 s53, 0x40000000, s53
    v_add_u32 v22, s52, v20
    v_add_u32 v21, s52, v21
    v_add_u32 v20, s53, v20
    s_waitcnt vmcnt(14)
    s_barrier
    s_add_u32 m0, s59, 0x1e000
    s_nop 0
    buffer_load_dwordx4 v8, s[36:39], s57 offen  lds
    s_add_u32 m0, s59, 0x1f000
    s_nop 0
    buffer_load_dwordx4 v9, s[36:39], s57 offen  lds
    s_add_u32 m0, s59, 0x20000
    s_nop 0
    buffer_load_dwordx4 v10, s[40:43], s57 offen  lds
    s_add_u32 m0, s59, 0x21000
    s_nop 0
    buffer_load_dwordx4 v11, s[40:43], s57 offen  lds
    s_add_u32 s57, s57, s66
    s_cmp_ge_u32 s57, s67
    s_cselect_b32 s57, 0, s57
    s_add_u32 m0, s58, 0xc000
    s_nop 0
    buffer_load_dwordx4 v2, s[24:27], s56 offen  lds
    s_add_u32 m0, s58, 0xc400
    s_nop 0
    buffer_load_dwordx4 v3, s[24:27], s56 offen  lds
    s_add_u32 m0, s58, 0xc800
    s_nop 0
    buffer_load_dwordx4 v4, s[24:27], s56 offen  lds
    s_waitcnt vmcnt(17)
    s_barrier
    s_add_u32 m0, s59, 0x12000
    s_nop 0
    buffer_load_dwordx4 v8, s[36:39], s57 offen  lds
    s_add_u32 m0, s59, 0x13000
    s_nop 0
    buffer_load_dwordx4 v9, s[36:39], s57 offen  lds
    s_add_u32 m0, s59, 0x14000
    s_nop 0
    buffer_load_dwordx4 v10, s[40:43], s57 offen  lds
    s_add_u32 m0, s59, 0x15000
    s_nop 0
    buffer_load_dwordx4 v11, s[40:43], s57 offen  lds
    s_add_u32 s57, s57, s66
    s_cmp_ge_u32 s57, s67
    s_cselect_b32 s57, 0, s57
    s_add_u32 m0, s58, 0xcc00
    s_nop 0
    buffer_load_dwordx4 v5, s[24:27], s56 offen  lds
    s_add_u32 m0, s58, 0xd000
    s_nop 0
    buffer_load_dwordx4 v6, s[24:27], s56 offen  lds
    s_add_u32 m0, s58, 0xd400
    s_nop 0
    buffer_load_dwordx4 v7, s[24:27], s56 offen  lds
    s_add_u32 s56, s56, 0x80
    s_cmp_ge_u32 s56, 0x500
    s_cselect_b32 s56, 0, s56
    s_cmp_lg_u32 s51, 0
    s_cbranch_scc1 L_np_5
    buffer_load_dword v16, v17, s[28:31], s75 offen sc1
L_np_5:
    s_waitcnt vmcnt(14)
    s_barrier
    s_add_u32 m0, s59, 0x16000
    s_nop 0
    buffer_load_dwordx4 v8, s[36:39], s57 offen  lds
    s_add_u32 m0, s59, 0x17000
    s_nop 0
    buffer_load_dwordx4 v9, s[36:39], s57 offen  lds
    s_add_u32 m0, s59, 0x18000
    s_nop 0
    buffer_load_dwordx4 v10, s[40:43], s57 offen  lds
    s_add_u32 m0, s59, 0x19000
    s_nop 0
    buffer_load_dwordx4 v11, s[40:43], s57 offen  lds
    s_add_u32 s57, s57, s66
    s_cmp_ge_u32 s57, s67
    s_cselect_b32 s57, 0, s57
    s_add_u32 m0, s58, 0x0
    s_nop 0
    buffer_load_dwordx4 v2, s[24:27], s56 offen  lds
    s_add_u32 m0, s58, 0x400
    s_nop 0
    buffer_load_dwordx4 v3, s[24:27], s56 offen  lds
    s_add_u32 m0, s58, 0x800
    s_nop 0
    buffer_load_dwordx4 v4, s[24:27], s56 offen  lds
    s_waitcnt vmcnt(17)
    s_barrier
    s_add_u32 m0, s59, 0x1a000
    s_nop 0
    buffer_load_dwordx4 v8, s[36:39], s57 offen  lds
    s_add_u32 m0, s59, 0x1b000
    s_nop 0
    buffer_load_dwordx4 v9, s[36:39], s57 offen  lds
    s_add_u32 m0, s59, 0x1c000
    s_nop 0
    buffer_load_dwordx4 v10, s[40:43], s57 offen  lds
    s_add_u32 m0, s59, 0x1d000
    s_nop 0
    buffer_load_dwordx4 v11, s[40:43], s57 offen  lds
    s_add_u32 s57, s57, s66
    s_cmp_ge_u32 s57, s67
    s_cselect_b32 s57, 0, s57
    s_add_u32 m0, s58, 0xc00
    s_nop 0
    buffer_load_dwordx4 v5, s[24:27], s56 offen  lds
    s_add_u32 m0, s58, 0x1000
    s_nop 0
    buffer_load_dwordx4 v6, s[24:27], s56 offen  lds
    s_add_u32 m0, s58, 0x1400
    s_nop 0
    buffer_load_dwordx4 v7, s[24:27], s56 offen  lds
    s_add_u32 s56, s56, 0x80
    s_cmp_ge_u32 s56, 0x500
    s_cselect_b32 s56, 0, s56
    s_cmp_lg_u32 s51, 0
    s_cbranch_scc1 L_fok_6
    s_waitcnt vmcnt(14)
    s_mov_b32 s3, 0x40000
    s_branch L_sck_9
L_ssp_8:
    buffer_load_dword v16, v17, s[28:31], s75 offen sc1
    s_waitcnt vmcnt(0)
L_sck_9:
    v_cmp_gt_u32 vcc, 1, v16
    s_nop 1
    s_cmp_eq_u64 vcc, 0
    s_cbranch_scc1 L_sok_7
    s_sleep 2
    s_sub_u32 s3, s3, 1
    s_cbranch_scc0 L_ssp_8
L_sok_7:
L_fok_6:
    s_waitcnt vmcnt(14)
    s_barrier
    s_add_u32 m0, s59, 0x1e000
    s_nop 0
    buffer_load_dwordx4 v8, s[36:39], s57 offen  lds
    s_add_u32 m0, s59, 0x1f000
    s_nop 0
    buffer_load_dwordx4 v9, s[36:39], s57 offen  lds
    s_add_u32 m0, s59, 0x20000
    s_nop 0
    buffer_load_dwordx4 v10, s[40:43], s57 offen  lds
    s_add_u32 m0, s59, 0x21000
    s_nop 0
    buffer_load_dwordx4 v11, s[40:43], s57 offen  lds
    s_add_u32 s57, s57, s66
    s_cmp_ge_u32 s57, s67
    s_cselect_b32 s57, 0, s57
    s_add_u32 s52, s72, 0
    buffer_load_dword v26, v19, s[28:31], s52 offen sc1
    s_add_u32 s52, s72, 21504
    buffer_load_dword v27, v19, s[28:31], s52 offen sc1
    s_add_u32 s52, s72, 43008
    buffer_load_dword v28, v19, s[28:31], s52 offen sc1
    s_add_u32 s52, s72, 64512
    buffer_load_dword v29, v19, s[28:31], s52 offen sc1
    s_lshl_b32 s52, s51, 6
    v_add_u32 v12, s52, v1
    v_lshlrev_b32 v18, 3, v12
    s_lshl_b32 s52, s64, 3
    s_add_u32 s52, s52, 0xa00000
    buffer_load_dwordx2 v[24:25], v18, s[28:31], s52 offen sc1
    s_cmp_eq_u32 s68, 1
    s_cbranch_scc1 L_qkv_ltail
    s_add_u32 s54, s60, 245760
    s_cmp_ge_u32 s54, 1105920
    s_cselect_b32 s55, 1105920, 0
    s_sub_u32 s54, s54, s55
    s_add_u32 s52, s54, 0
    s_add_u32 m0, s62, 0x6000
    s_nop 0
    buffer_load_dwordx4 v23, s[44:47], s52 offen  lds
    s_add_u32 s52, s54, 10240
    s_add_u32 m0, s62, 0x6400
    s_nop 0
    buffer_load_dwordx4 v23, s[44:47], s52 offen  lds
    s_add_u32 s52, s54, 20480
    s_add_u32 m0, s62, 0x6800
    s_nop 0
    buffer_load_dwordx4 v23, s[44:47], s52 offen  lds
    s_add_u32 s54, s60, 368640
    s_cmp_ge_u32 s54, 1105920
    s_cselect_b32 s55, 1105920, 0
    s_sub_u32 s54, s54, s55
    s_add_u32 s52, s54, 0
    s_add_u32 m0, s62, 0x9000
    s_nop 0
    buffer_load_dwordx4 v23, s[44:47], s52 offen  lds
    s_add_u32 s52, s54, 10240
    s_add_u32 m0, s62, 0x9400
    s_nop 0
    buffer_load_dwordx4 v23, s[44:47], s52 offen  lds
    s_add_u32 s52, s54, 20480
    s_add_u32 m0, s62, 0x9800
    s_nop 0
    buffer_load_dwordx4 v23, s[44:47], s52 offen  lds
    s_add_u32 s54, s60, 614400
    s_cmp_ge_u32 s54, 1105920
    s_cselect_b32 s55, 1105920, 0
    s_sub_u32 s54, s54, s55
    s_add_u32 s52, s54, 1105920
    s_add_u32 m0, s62, 0x22000
    s_nop 0
    buffer_load_dwordx4 v23, s[44:47], s52 offen  lds
    s_add_u32 s52, s54, 1116160
    s_add_u32 m0, s62, 0x22400
    s_nop 0
    buffer_load_dwordx4 v23, s[44:47], s52 offen  lds
    s_add_u32 s52, s54, 1126400
    s_add_u32 m0, s62, 0x22800
    s_nop 0
    buffer_load_dwordx4 v23, s[44:47], s52 offen  lds
    s_waitcnt vmcnt(28)
    s_barrier
    s_waitcnt vmcnt(9)
    v_pk_add_f32 v[26:27], v[26:27], v[28:29]
    v_add_u32 v12, 0x26000, v18
    v_lshrrev_b32 v13, 1, v18
    v_add_f32 v26, v26, v27
    v_add_u32 v13, 0x26800, v13
    ds_write_b64 v12, v[24:25]
    ds_write_b32 v13, v26
    ds_write_b32 v13, v17 offset:1024
    s_waitcnt vmcnt(14)
    s_waitcnt lgkmcnt(0)
    s_barrier
    s_add_u32 s54, s60, 0
    s_cmp_ge_u32 s54, 1105920
    s_cselect_b32 s55, 1105920, 0
    s_sub_u32 s54, s54, s55
    s_add_u32 s52, s54, 1105920
    s_add_u32 m0, s62, 0x13000
    s_nop 0
    buffer_load_dwordx4 v23, s[44:47], s52 offen  lds
    s_add_u32 s52, s54, 1116160
    s_add_u32 m0, s62, 0x13400
    s_nop 0
    buffer_load_dwordx4 v23, s[44:47], s52 offen  lds
    s_add_u32 s52, s54, 1126400
    s_add_u32 m0, s62, 0x13800
    s_nop 0
    buffer_load_dwordx4 v23, s[44:47], s52 offen  lds
    s_add_u32 s54, s60, 122880
    s_cmp_ge_u32 s54, 1105920
    s_cselect_b32 s55, 1105920, 0
    s_sub_u32 s54, s54, s55
    s_add_u32 s52, s54, 1105920
    s_add_u32 m0, s62, 0x16000
    s_nop 0
    buffer_load_dwordx4 v23, s[44:47], s52 offen  lds
    s_add_u32 s52, s54, 1116160
    s_add_u32 m0, s62, 0x16400
    s_nop 0
    buffer_load_dwordx4 v23, s[44:47], s52 offen  lds
    s_add_u32 s52, s54, 1126400
    s_add_u32 m0, s62, 0x16800
    s_nop 0
    buffer_load_dwordx4 v23, s[44:47], s52 offen  lds
    s_add_u32 s54, s60, 491520
    s_cmp_ge_u32 s54, 1105920
    s_cselect_b32 s55, 1105920, 0
    s_sub_u32 s54, s54, s55
    s_add_u32 s52, s54, 0
    s_add_u32 m0, s62, 0xc000
    s_nop 0
    buffer_load_dwordx4 v23, s[44:47], s52 offen  lds
    s_add_u32 s52, s54, 10240
    s_add_u32 m0, s62, 0xc400
    s_nop 0
    buffer_load_dwordx4 v23, s[44:47], s52 offen  lds
    s_add_u32 s52, s54, 20480
    s_add_u32 m0, s62, 0xc800
    s_nop 0
    buffer_load_dwordx4 v23, s[44:47], s52 offen  lds
    s_add_u32 s54, s60, 614400
    s_cmp_ge_u32 s54, 1105920
    s_cselect_b32 s55, 1105920, 0
    s_sub_u32 s54, s54, s55
    s_add_u32 s52, s54, 0
    s_add_u32 m0, s62, 0xf000
    s_nop 0
    buffer_load_dwordx4 v23, s[44:47], s52 offen  lds
    s_add_u32 s52, s54, 10240
    s_add_u32 m0, s62, 0xf400
    s_nop 0
    buffer_load_dwordx4 v23, s[44:47], s52 offen  lds
    s_add_u32 s52, s54, 20480
    s_add_u32 m0, s62, 0xf800
    s_nop 0
    buffer_load_dwordx4 v23, s[44:47], s52 offen  lds
    s_add_u32 s54, s60, 737280
    s_cmp_ge_u32 s54, 1105920
    s_cselect_b32 s55, 1105920, 0
    s_sub_u32 s54, s54, s55
    buffer_load_dwordx4 v[104:107], v20, s[44:47], s54 offen
    s_add_u32 s54, s54, 10240
    buffer_load_dwordx4 v[108:111], v20, s[44:47], s54 offen
    s_add_u32 s54, s54, 10240
    buffer_load_dwordx4 v[112:115], v20, s[44:47], s54 offen
    s_add_u32 s54, s54, 10240
    buffer_load_dwordx4 v[116:119], v20, s[44:47], s54 offen
    s_add_u32 s54, s54, 10240
    buffer_load_dwordx4 v[120:123], v20, s[44:47], s54 offen
    s_add_u32 s54, s54, 10240
    buffer_load_dwordx4 v[124:127], v20, s[44:47], s54 offen
    s_add_u32 s54, s60, 860160
    s_cmp_ge_u32 s54, 1105920
    s_cselect_b32 s55, 1105920, 0
    s_sub_u32 s54, s54, s55
    buffer_load_dwordx4 v[128:131], v20, s[44:47], s54 offen
    s_add_u32 s54, s54, 10240
    buffer_load_dwordx4 v[132:135], v20, s[44:47], s54 offen
    s_add_u32 s54, s54, 10240
    buffer_load_dwordx4 v[136:139], v20, s[44:47], s54 offen
    s_add_u32 s54, s54, 10240
    buffer_load_dwordx4 v[140:143], v20, s[44:47], s54 offen
    s_add_u32 s54, s54, 10240
    buffer_load_dwordx4 v[144:147], v20, s[44:47], s54 offen
    s_add_u32 s54, s54, 10240
    buffer_load_dwordx4 v[148:151], v20, s[44:47], s54 offen
    s_add_u32 s54, s60, 983040
    s_cmp_ge_u32 s54, 1105920
    s_cselect_b32 s55, 1105920, 0
    s_sub_u32 s54, s54, s55
    buffer_load_dwordx4 v[152:155], v20, s[44:47], s54 offen
    s_add_u32 s54, s54, 10240
    buffer_load_dwordx4 v[156:159], v20, s[44:47], s54 offen
    s_add_u32 s54, s54, 10240
    buffer_load_dwordx4 v[160:163], v20, s[44:47], s54 offen
    s_add_u32 s54, s54, 10240
    buffer_load_dwordx4 v[164:167], v20, s[44:47], s54 offen
    s_add_u32 s54, s54, 10240
    buffer_load_dwordx4 v[168:171], v20, s[44:47], s54 offen
    s_add_u32 s54, s54, 10240
    buffer_load_dwordx4 v[172:175], v20, s[44:47], s54 offen
    v_mov_b32 v2, 0x26c10
    s_mov_b32 s100, 0x400000
L_lw_10:
    s_sleep 1
    ds_read_b32 v3, v2
    s_sub_u32 s100, s100, 1
    s_cbranch_scc1 L_lx_11
    s_waitcnt lgkmcnt(0)
    v_readfirstlane_b32 s3, v3
    s_nop 1
    s_cmp_lt_u32 s3, 4
    s_cbranch_scc1 L_lw_10
L_lx_11:
    s_add_u32 s54, s60, 0
    s_cmp_ge_u32 s54, 1105920
    s_cselect_b32 s55, 1105920, 0
    s_sub_u32 s54, s54, s55
    s_add_u32 s52, s54, 0
    s_add_u32 m0, s62, 0x0
    s_nop 0
    buffer_load_dwordx4 v23, s[44:47], s52 offen  lds
    s_add_u32 s52, s54, 10240
    s_add_u32 m0, s62, 0x400
    s_nop 0
    buffer_load_dwordx4 v23, s[44:47], s52 offen  lds
    s_add_u32 s52, s54, 20480
    s_add_u32 m0, s62, 0x800
    s_nop 0
    buffer_load_dwordx4 v23, s[44:47], s52 offen  lds
    s_add_u32 s54, s60, 122880
    s_cmp_ge_u32 s54, 1105920
    s_cselect_b32 s55, 1105920, 0
    s_sub_u32 s54, s54, s55
    s_add_u32 s52, s54, 0
    s_add_u32 m0, s62, 0x3000
    s_nop 0
    buffer_load_dwordx4 v23, s[44:47], s52 offen  lds
    s_add_u32 s52, s54, 10240
    s_add_u32 m0, s62, 0x3400
    s_nop 0
    buffer_load_dwordx4 v23, s[44:47], s52 offen  lds
    s_add_u32 s52, s54, 20480
    s_add_u32 m0, s62, 0x3800
    s_nop 0
    buffer_load_dwordx4 v23, s[44:47], s52 offen  lds
    s_add_u32 s54, s60, 245760
    s_cmp_ge_u32 s54, 1105920
    s_cselect_b32 s55, 1105920, 0
    s_sub_u32 s54, s54, s55
    s_add_u32 s52, s54, 1105920
    s_add_u32 m0, s62, 0x19000
    s_nop 0
    buffer_load_dwordx4 v23, s[44:47], s52 offen  lds
    s_add_u32 s52, s54, 1116160
    s_add_u32 m0, s62, 0x19400
    s_nop 0
    buffer_load_dwordx4 v23, s[44:47], s52 offen  lds
    s_add_u32 s52, s54, 1126400
    s_add_u32 m0, s62, 0x19800
    s_nop 0
    buffer_load_dwordx4 v23, s[44:47], s52 offen  lds
    s_add_u32 s54, s60, 368640
    s_cmp_ge_u32 s54, 1105920
    s_cselect_b32 s55, 1105920, 0
    s_sub_u32 s54, s54, s55
    s_add_u32 s52, s54, 1105920
    s_add_u32 m0, s62, 0x1c000
    s_nop 0
    buffer_load_dwordx4 v23, s[44:47], s52 offen  lds
    s_add_u32 s52, s54, 1116160
    s_add_u32 m0, s62, 0x1c400
    s_nop 0
    buffer_load_dwordx4 v23, s[44:47], s52 offen  lds
    s_add_u32 s52, s54, 1126400
    s_add_u32 m0, s62, 0x1c800
    s_nop 0
    buffer_load_dwordx4 v23, s[44:47], s52 offen  lds
    s_add_u32 s54, s60, 491520
    s_cmp_ge_u32 s54, 1105920
    s_cselect_b32 s55, 1105920, 0
    s_sub_u32 s54, s54, s55
    s_add_u32 s52, s54, 1105920
    s_add_u32 m0, s62, 0x1f000
    s_nop 0
    buffer_load_dwordx4 v23, s[44:47], s52 offen  lds
    s_add_u32 s52, s54, 1116160
    s_add_u32 m0, s62, 0x1f400
    s_nop 0
    buffer_load_dwordx4 v23, s[44:47], s52 offen  lds
    s_add_u32 s52, s54, 1126400
    s_add_u32 m0, s62, 0x1f800
    s_nop 0
    buffer_load_dwordx4 v23, s[44:47], s52 offen  lds
L_lnext:
    s_lshl_b32 s52, s63, 6
    s_add_u32 s53, s52, 0x26c40
    v_mov_b32 v2, s53
    s_sub_u32 s53, 0x26c80, s52
    v_mov_b32 v3, s53
    v_mov_b32 v14, 0x26c00
    v_mov_b32 v15, 1
    s_mov_b32 s52, 0
    buffer_load_dwordx4 v[176:179], v22, s[76:79], s52 offen
    s_mov_b32 s52, 25600
    buffer_load_dwordx4 v[180:183], v22, s[76:79], s52 offen
    s_mov_b32 s52, 51200
    buffer_load_dwordx4 v[184:187], v22, s[76:79], s52 offen
    s_mov_b32 s52, 76800
    buffer_load_dwordx4 v[188:191], v22, s[76:79], s52 offen
    s_mov_b32 s52, 0
    buffer_load_dwordx4 v[192:195], v21, s[76:79], s52 offen
    s_mov_b32 s52, 102400
    buffer_load_dwordx4 v[196:199], v22, s[76:79], s52 offen
    s_mov_b32 s52, 128000
    buffer_load_dwordx4 v[200:203], v22, s[76:79], s52 offen
    s_mov_b32 s52, 153600
    buffer_load_dwordx4 v[204:207], v22, s[76:79], s52 offen
    s_waitcnt vmcnt(8)
    s_mov_b64 exec, 1
    ds_add_u32 v14, v15 offset:40
    s_mov_b64 exec, -1
    s_mov_b32 s52, 179200
    buffer_load_dwordx4 v[208:211], v22, s[76:79], s52 offen
    s_mov_b32 s52, 102400
    buffer_load_dwordx4 v[212:215], v21, s[76:79], s52 offen
    s_mov_b32 s52, 204800
    buffer_load_dwordx4 v[216:219], v22, s[76:79], s52 offen
    s_mov_b32 s52, 230400
    buffer_load_dwordx4 v[220:223], v22, s[76:79], s52 offen
    s_mov_b32 s52, 256000
    buffer_load_dwordx4 v[224:227], v22, s[76:79], s52 offen
    s_mov_b32 s52, 281600
    buffer_load_dwordx4 v[228:231], v22, s[76:79], s52 offen
    s_mov_b32 s52, 204800
    buffer_load_dwordx4 v[232:235], v21, s[76:79], s52 offen
    s_mov_b32 s52, 307200
    buffer_load_dwordx4 v[236:239], v22, s[76:79], s52 offen
    s_mov_b32 s52, 332800
    buffer_load_dwordx4 v[240:243], v22, s[76:79], s52 offen
    s_mov_b32 s52, 358400
    buffer_load_dwordx4 v[244:247], v22, s[76:79], s52 offen
    s_mov_b32 s52, 384000
    buffer_load_dwordx4 v[248:251], v22, s[76:79], s52 offen
    s_mov_b32 s52, 307200
    buffer_load_dwordx4 v[252:255], v21, s[76:79], s52 offen
    s_branch L_aux
L_spare_lnext:
    s_mov_b32 s44, s16
    s_and_b32 s45, s17, 0xffff
    s_mov_b32 s46, 0x21c000
    s_mov_b32 s47, 0x20000
    s_mov_b32 s76, s8
    s_and_b32 s77, s9, 0xffff
    s_mov_b32 s78, 0xc8000
    s_mov_b32 s79, 0x20000
    v_bfe_u32 v13, v1, 4, 1
    v_lshlrev_b32 v13, 2, v13
    v_and_b32 v12, 7, v1
    v_xor_b32 v13, v13, v12
    v_lshlrev_b32 v13, 4, v13
    s_lshl_b32 s52, s74, 7
    v_add_u32 v13, s52, v13
    v_lshrrev_b32 v12, 3, v1
    v_mul_u32_u24 v12, 1280, v12
    v_add_u32 v20, v12, v13
    s_mul_i32 s52, s51, 30720
    v_add_u32 v23, s52, v20
    v_lshrrev_b32 v12, 5, v1
    v_mul_u32_u24 v12, 20, v12
    v_bfe_u32 v21, v1, 3, 2
    v_add3_u32 v12, v12, v21, 16
    v_mul_u32_u24 v12, 1280, v12
    v_add_u32 v21, v12, v13
    s_mov_b32 s52, 0
    s_mul_i32 s60, s52, 122880
    s_mul_i32 s61, s52, 6144
    s_mul_i32 s62, s51, 3072
    s_and_b32 s63, s51, 1
    s_lshr_b32 s71, s51, 1
    s_mul_i32 s52, s63, 409600
    s_mul_i32 s54, s71, 10240
    s_add_u32 s52, s52, s54
    s_mul_i32 s54, s71, 40960
    v_add_u32 v21, s54, v21
    s_mul_i32 s53, s63, 1105920
    s_mul_i32 s54, s71, 61440
    s_add_u32 s53, s53, s54
    s_cmp_ge_u32 s74, 10
    s_cselect_b32 s52, 0x40000000, s52
    s_cselect_b32 s53, 0x40000000, s53
    v_add_u32 v22, s52, v20
    v_add_u32 v21, s52, v21
    v_add_u32 v20, s53, v20
    s_add_u32 s54, s60, 737280
    s_cmp_ge_u32 s54, 1105920
    s_cselect_b32 s55, 1105920, 0
    s_sub_u32 s54, s54, s55
    buffer_load_dwordx4 v[104:107], v20, s[44:47], s54 offen
    s_add_u32 s54, s54, 10240
    buffer_load_dwordx4 v[108:111], v20, s[44:47], s54 offen
    s_add_u32 s54, s54, 10240
    buffer_load_dwordx4 v[112:115], v20, s[44:47], s54 offen
    s_add_u32 s54, s54, 10240
    buffer_load_dwordx4 v[116:119], v20, s[44:47], s54 offen
    s_add_u32 s54, s54, 10240
    buffer_load_dwordx4 v[120:123], v20, s[44:47], s54 offen
    s_add_u32 s54, s54, 10240
    buffer_load_dwordx4 v[124:127], v20, s[44:47], s54 offen
    s_add_u32 s54, s60, 860160
    s_cmp_ge_u32 s54, 1105920
    s_cselect_b32 s55, 1105920, 0
    s_sub_u32 s54, s54, s55
    buffer_load_dwordx4 v[128:131], v20, s[44:47], s54 offen
    s_add_u32 s54, s54, 10240
    buffer_load_dwordx4 v[132:135], v20, s[44:47], s54 offen
    s_add_u32 s54, s54, 10240
    buffer_load_dwordx4 v[136:139], v20, s[44:47], s54 offen
    s_add_u32 s54, s54, 10240
    buffer_load_dwordx4 v[140:143], v20, s[44:47], s54 offen
    s_add_u32 s54, s54, 10240
    buffer_load_dwordx4 v[144:147], v20, s[44:47], s54 offen
    s_add_u32 s54, s54, 10240
    buffer_load_dwordx4 v[148:151], v20, s[44:47], s54 offen
    s_add_u32 s54, s60, 983040
    s_cmp_ge_u32 s54, 1105920
    s_cselect_b32 s55, 1105920, 0
    s_sub_u32 s54, s54, s55
    buffer_load_dwordx4 v[152:155], v20, s[44:47], s54 offen
    s_add_u32 s54, s54, 10240
    buffer_load_dwordx4 v[156:159], v20, s[44:47], s54 offen
    s_add_u32 s54, s54, 10240
    buffer_load_dwordx4 v[160:163], v20, s[44:47], s54 offen
    s_add_u32 s54, s54, 10240
    buffer_load_dwordx4 v[164:167], v20, s[44:47], s54 offen
    s_add_u32 s54, s54, 10240
    buffer_load_dwordx4 v[168:171], v20, s[44:47], s54 offen
    s_add_u32 s54, s54, 10240
    buffer_load_dwordx4 v[172:175], v20, s[44:47], s54 offen
    s_add_u32 s54, s60, 0
    s_cmp_ge_u32 s54, 1105920
    s_cselect_b32 s55, 1105920, 0
    s_sub_u32 s54, s54, s55
    s_add_u32 s52, s54, 0
    s_add_u32 m0, s62, 0x0
    s_nop 0
    buffer_load_dwordx4 v23, s[44:47], s52 offen  lds
    s_add_u32 s52, s54, 10240
    s_add_u32 m0, s62, 0x400
    s_nop 0
    buffer_load_dwordx4 v23, s[44:47], s52 offen  lds
    s_add_u32 s52, s54, 20480
    s_add_u32 m0, s62, 0x800
    s_nop 0
    buffer_load_dwordx4 v23, s[44:47], s52 offen  lds
    s_add_u32 s54, s60, 0
    s_cmp_ge_u32 s54, 1105920
    s_cselect_b32 s55, 1105920, 0
    s_sub_u32 s54, s54, s55
    s_add_u32 s52, s54, 1105920
    s_add_u32 m0, s62, 0x13000
    s_nop 0
    buffer_load_dwordx4 v23, s[44:47], s52 offen  lds
    s_add_u32 s52, s54, 1116160
    s_add_u32 m0, s62, 0x13400
    s_nop 0
    buffer_load_dwordx4 v23, s[44:47], s52 offen  lds
    s_add_u32 s52, s54, 1126400
    s_add_u32 m0, s62, 0x13800
    s_nop 0
    buffer_load_dwordx4 v23, s[44:47], s52 offen  lds
    s_add_u32 s54, s60, 122880
    s_cmp_ge_u32 s54, 1105920
    s_cselect_b32 s55, 1105920, 0
    s_sub_u32 s54, s54, s55
    s_add_u32 s52, s54, 0
    s_add_u32 m0, s62, 0x3000
    s_nop 0
    buffer_load_dwordx4 v23, s[44:47], s52 offen  lds
    s_add_u32 s52, s54, 10240
    s_add_u32 m0, s62, 0x3400
    s_nop 0
    buffer_load_dwordx4 v23, s[44:47], s52 offen  lds
    s_add_u32 s52, s54, 20480
    s_add_u32 m0, s62, 0x3800
    s_nop 0
    buffer_load_dwordx4 v23, s[44:47], s52 offen  lds
    s_add_u32 s54, s60, 122880
    s_cmp_ge_u32 s54, 1105920
    s_cselect_b32 s55, 1105920, 0
    s_sub_u32 s54, s54, s55
    s_add_u32 s52, s54, 1105920
    s_add_u32 m0, s62, 0x16000
    s_nop 0
    buffer_load_dwordx4 v23, s[44:47], s52 offen  lds
    s_add_u32 s52, s54, 1116160
    s_add_u32 m0, s62, 0x16400
    s_nop 0
    buffer_load_dwordx4 v23, s[44:47], s52 offen  lds
    s_add_u32 s52, s54, 1126400
    s_add_u32 m0, s62, 0x16800
    s_nop 0
    buffer_load_dwordx4 v23, s[44:47], s52 offen  lds
    s_add_u32 s54, s60, 245760
    s_cmp_ge_u32 s54, 1105920
    s_cselect_b32 s55, 1105920, 0
    s_sub_u32 s54, s54, s55
    s_add_u32 s52, s54, 0
    s_add_u32 m0, s62, 0x6000
    s_nop 0
    buffer_load_dwordx4 v23, s[44:47], s52 offen  lds
    s_add_u32 s52, s54, 10240
    s_add_u32 m0, s62, 0x6400
    s_nop 0
    buffer_load_dwordx4 v23, s[44:47], s52 offen  lds
    s_add_u32 s52, s54, 20480
    s_add_u32 m0, s62, 0x6800
    s_nop 0
    buffer_load_dwordx4 v23, s[44:47], s52 offen  lds
    s_add_u32 s54, s60, 245760
    s_cmp_ge_u32 s54, 1105920
    s_cselect_b32 s55, 1105920, 0
    s_sub_u32 s54, s54, s55
    s_add_u32 s52, s54, 1105920
    s_add_u32 m0, s62, 0x19000
    s_nop 0
    buffer_load_dwordx4 v23, s[44:47], s52 offen  lds
    s_add_u32 s52, s54, 1116160
    s_add_u32 m0, s62, 0x19400
    s_nop 0
    buffer_load_dwordx4 v23, s[44:47], s52 offen  lds
    s_add_u32 s52, s54, 1126400
    s_add_u32 m0, s62, 0x19800
    s_nop 0
    buffer_load_dwordx4 v23, s[44:47], s52 offen  lds
    s_add_u32 s54, s60, 368640
    s_cmp_ge_u32 s54, 1105920
    s_cselect_b32 s55, 1105920, 0
    s_sub_u32 s54, s54, s55
    s_add_u32 s52, s54, 0
    s_add_u32 m0, s62, 0x9000
    s_nop 0
    buffer_load_dwordx4 v23, s[44:47], s52 offen  lds
    s_add_u32 s52, s54, 10240
    s_add_u32 m0, s62, 0x9400
    s_nop 0
    buffer_load_dwordx4 v23, s[44:47], s52 offen  lds
    s_add_u32 s52, s54, 20480
    s_add_u32 m0, s62, 0x9800
    s_nop 0
    buffer_load_dwordx4 v23, s[44:47], s52 offen  lds
    s_add_u32 s54, s60, 368640
    s_cmp_ge_u32 s54, 1105920
    s_cselect_b32 s55, 1105920, 0
    s_sub_u32 s54, s54, s55
    s_add_u32 s52, s54, 1105920
    s_add_u32 m0, s62, 0x1c000
    s_nop 0
    buffer_load_dwordx4 v23, s[44:47], s52 offen  lds
    s_add_u32 s52, s54, 1116160
    s_add_u32 m0, s62, 0x1c400
    s_nop 0
    buffer_load_dwordx4 v23, s[44:47], s52 offen  lds
    s_add_u32 s52, s54, 1126400
    s_add_u32 m0, s62, 0x1c800
    s_nop 0
    buffer_load_dwordx4 v23, s[44:47], s52 offen  lds
    s_add_u32 s54, s60, 491520
    s_cmp_ge_u32 s54, 1105920
    s_cselect_b32 s55, 1105920, 0
    s_sub_u32 s54, s54, s55
    s_add_u32 s52, s54, 0
    s_add_u32 m0, s62, 0xc000
    s_nop 0
    buffer_load_dwordx4 v23, s[44:47], s52 offen  lds
    s_add_u32 s52, s54, 10240
    s_add_u32 m0, s62, 0xc400
    s_nop 0
    buffer_load_dwordx4 v23, s[44:47], s52 offen  lds
    s_add_u32 s52, s54, 20480
    s_add_u32 m0, s62, 0xc800
    s_nop 0
    buffer_load_dwordx4 v23, s[44:47], s52 offen  lds
    s_add_u32 s54, s60, 491520
    s_cmp_ge_u32 s54, 1105920
    s_cselect_b32 s55, 1105920, 0
    s_sub_u32 s54, s54, s55
    s_add_u32 s52, s54, 1105920
    s_add_u32 m0, s62, 0x1f000
    s_nop 0
    buffer_load_dwordx4 v23, s[44:47], s52 offen  lds
    s_add_u32 s52, s54, 1116160
    s_add_u32 m0, s62, 0x1f400
    s_nop 0
    buffer_load_dwordx4 v23, s[44:47], s52 offen  lds
    s_add_u32 s52, s54, 1126400
    s_add_u32 m0, s62, 0x1f800
    s_nop 0
    buffer_load_dwordx4 v23, s[44:47], s52 offen  lds
    s_add_u32 s54, s60, 614400
    s_cmp_ge_u32 s54, 1105920
    s_cselect_b32 s55, 1105920, 0
    s_sub_u32 s54, s54, s55
    s_add_u32 s52, s54, 0
    s_add_u32 m0, s62, 0xf000
    s_nop 0
    buffer_load_dwordx4 v23, s[44:47], s52 offen  lds
    s_add_u32 s52, s54, 10240
    s_add_u32 m0, s62, 0xf400
    s_nop 0
    buffer_load_dwordx4 v23, s[44:47], s52 offen  lds
    s_add_u32 s52, s54, 20480
    s_add_u32 m0, s62, 0xf800
    s_nop 0
    buffer_load_dwordx4 v23, s[44:47], s52 offen  lds
    s_add_u32 s54, s60, 614400
    s_cmp_ge_u32 s54, 1105920
    s_cselect_b32 s55, 1105920, 0
    s_sub_u32 s54, s54, s55
    s_add_u32 s52, s54, 1105920
    s_add_u32 m0, s62, 0x22000
    s_nop 0
    buffer_load_dwordx4 v23, s[44:47], s52 offen  lds
    s_add_u32 s52, s54, 1116160
    s_add_u32 m0, s62, 0x22400
    s_nop 0
    buffer_load_dwordx4 v23, s[44:47], s52 offen  lds
    s_add_u32 s52, s54, 1126400
    s_add_u32 m0, s62, 0x22800
    s_nop 0
    buffer_load_dwordx4 v23, s[44:47], s52 offen  lds
    s_branch L_lnext
L_qkv_ltail:
    s_waitcnt vmcnt(19)
    s_barrier
    s_waitcnt vmcnt(0)
    v_pk_add_f32 v[26:27], v[26:27], v[28:29]
    v_add_u32 v12, 0x26000, v18
    v_lshrrev_b32 v13, 1, v18
    v_add_f32 v26, v26, v27
    v_add_u32 v13, 0x26800, v13
    ds_write_b64 v12, v[24:25]
    ds_write_b32 v13, v26
    ds_write_b32 v13, v17 offset:1024
    s_waitcnt vmcnt(0) lgkmcnt(0)
    s_barrier
    s_branch L_done
L_ffn_compute:
    s_cmp_eq_u32 s48, 3
    s_cselect_b32 s65, 1, 9
    s_and_b32 s52, s48, 1
    s_lshr_b32 s53, s48, 1
    v_and_b32 v8, 15, v1
    s_mul_i32 s54, s52, 96
    v_add_u32 v8, s54, v8
    v_lshlrev_b32 v8, 7, v8
    v_lshrrev_b32 v9, 4, v1
    v_bfe_u32 v10, v1, 1, 3
    v_xor_b32 v10, v10, v9
    v_lshl_add_u32 v2, v10, 4, v8
    v_xor_b32 v3, 64, v2
    v_lshrrev_b32 v8, 2, v1
    v_lshlrev_b32 v8, 7, v8
    v_bfe_u32 v9, v1, 3, 2
    v_lshl_add_u32 v8, v9, 5, v8
    v_and_b32 v9, 3, v1
    v_lshl_add_u32 v8, v9, 3, v8
    s_lshl_b32 s54, s53, 12
    s_add_u32 s54, s54, 0x12000
    v_add_u32 v4, s54, v8
    v_xor_b32 v5, 32, v4
    v_xor_b32 v6, 64, v4
    v_xor_b32 v7, 96, v4
    v_mov_b64 v[64:65], 0
    v_mov_b64 v[66:67], 0
    v_mov_b64 v[68:69], 0
    v_mov_b64 v[70:71], 0
    v_mov_b64 v[72:73], 0
    v_mov_b64 v[74:75], 0
    v_mov_b64 v[76:77], 0
    v_mov_b64 v[78:79], 0
    v_mov_b64 v[80:81], 0
    v_mov_b64 v[82:83], 0
    v_mov_b64 v[84:85], 0
    v_mov_b64 v[86:87], 0
    v_mov_b64 v[88:89], 0
    v_mov_b64 v[90:91], 0
    v_mov_b64 v[92:93], 0
    v_mov_b64 v[94:95], 0
    v_mov_b64 v[96:97], 0
    v_mov_b64 v[98:99], 0
    v_mov_b64 v[100:101], 0
    v_mov_b64 v[102:103], 0
    v_mov_b64 v[104:105], 0
    v_mov_b64 v[106:107], 0
    v_mov_b64 v[108:109], 0
    v_mov_b64 v[110:111], 0
    v_mov_b64 v[112:113], 0
    v_mov_b64 v[114:115], 0
    v_mov_b64 v[116:117], 0
    v_mov_b64 v[118:119], 0
    v_mov_b64 v[120:121], 0
    v_mov_b64 v[122:123], 0
    v_mov_b64 v[124:125], 0
    v_mov_b64 v[126:127], 0
    v_mov_b64 v[128:129], 0
    v_mov_b64 v[130:131], 0
    v_mov_b64 v[132:133], 0
    v_mov_b64 v[134:135], 0
    v_mov_b64 v[136:137], 0
    v_mov_b64 v[138:139], 0
    v_mov_b64 v[140:141], 0
    v_mov_b64 v[142:143], 0
    v_mov_b64 v[144:145], 0
    v_mov_b64 v[146:147], 0
    v_mov_b64 v[148:149], 0
    v_mov_b64 v[150:151], 0
    v_mov_b64 v[152:153], 0
    v_mov_b64 v[154:155], 0
    v_mov_b64 v[156:157], 0
    v_mov_b64 v[158:159], 0
    v_mov_b64 v[160:161], 0
    v_mov_b64 v[162:163], 0
    v_mov_b64 v[164:165], 0
    v_mov_b64 v[166:167], 0
    v_mov_b64 v[168:169], 0
    v_mov_b64 v[170:171], 0
    v_mov_b64 v[172:173], 0
    v_mov_b64 v[174:175], 0
    v_mov_b64 v[176:177], 0
    v_mov_b64 v[178:179], 0
    v_mov_b64 v[180:181], 0
    v_mov_b64 v[182:183], 0
    v_mov_b64 v[184:185], 0
    v_mov_b64 v[186:187], 0
    v_mov_b64 v[188:189], 0
    v_mov_b64 v[190:191], 0
    v_mov_b64 v[192:193], 0
    v_mov_b64 v[194:195], 0
    v_mov_b64 v[196:197], 0
    v_mov_b64 v[198:199], 0
    v_mov_b64 v[200:201], 0
    v_mov_b64 v[202:203], 0
    v_mov_b64 v[204:205], 0
    v_mov_b64 v[206:207], 0
    v_mov_b64 v[208:209], 0
    v_mov_b64 v[210:211], 0
    v_mov_b64 v[212:213], 0
    v_mov_b64 v[214:215], 0
    v_mov_b64 v[216:217], 0
    v_mov_b64 v[218:219], 0
    v_mov_b64 v[220:221], 0
    v_mov_b64 v[222:223], 0
    v_mov_b64 v[224:225], 0
    v_mov_b64 v[226:227], 0
    v_mov_b64 v[228:229], 0
    v_mov_b64 v[230:231], 0
    v_mov_b64 v[232:233], 0
    v_mov_b64 v[234:235], 0
    v_mov_b64 v[236:237], 0
    v_mov_b64 v[238:239], 0
    v_mov_b64 v[240:241], 0
    v_mov_b64 v[242:243], 0
    v_mov_b64 v[244:245], 0
    v_mov_b64 v[246:247], 0
    v_mov_b64 v[248:249], 0
    v_mov_b64 v[250:251], 0
    v_mov_b64 v[252:253], 0
    v_mov_b64 v[254:255], 0
    s_lshl1_add_u32 s54, s50, s53
    s_mul_i32 s61, s49, 6
    s_mul_i32 s55, s52, 3
    s_add_u32 s61, s61, s55
    s_cmp_ge_u32 s54, 27
    s_cselect_b32 s61, 64, s61
    s_lshl_b32 s54, s54, 12
    s_add_u32 s54, s54, 4096
    s_add_u32 s55, s61, 0
    s_mul_i32 s56, s55, 151552
    s_add_u32 s56, s56, s54
    s_cmp_lt_u32 s55, 64
    s_cselect_b32 s56, s56, 0x40000000
    s_add_u32 s55, s61, 1
    s_mul_i32 s57, s55, 151552
    s_add_u32 s57, s57, s54
    s_cmp_lt_u32 s55, 64
    s_cselect_b32 s57, s57, 0x40000000
    s_add_u32 s55, s61, 2
    s_mul_i32 s58, s55, 151552
    s_add_u32 s58, s58, s54
    s_cmp_lt_u32 s55, 64
    s_cselect_b32 s58, s58, 0x40000000
    s_mul_i32 s59, s52, 768
    s_add_u32 s59, s59, 0x26000
    s_lshl_b32 s66, s53, 8
    s_add_u32 s66, s66, 0x26800
    s_mov_b32 s60, 0
    s_mov_b32 s63, 0
    s_mov_b32 s62, 0x8000
    s_mov_b32 s55, 0x6000
    s_waitcnt lgkmcnt(0)
    s_mov_b32 s32, s20
    s_and_b32 s33, s21, 0xffff
    s_mov_b32 s34, 0x100
    s_mov_b32 s35, 0x20000
    s_mov_b32 s28, s22
    s_and_b32 s29, s23, 0xffff
    s_mov_b32 s30, 0xf20000
    s_mov_b32 s31, 0x20000
    s_mov_b32 s24, s4
    s_and_b32 s25, s5, 0xffff
    s_mov_b32 s26, 0x280000
    s_mov_b32 s27, 0x20000
    s_waitcnt vmcnt(0)
    s_barrier
    ds_read_b128 v[8:11], v2 offset:0
    ds_read_b128 v[12:15], v2 offset:2048
    ds_read_b128 v[16:19], v2 offset:4096
    ds_read_b64_tr_b16 v[32:33], v4 offset:0
    ds_read_b64_tr_b16 v[34:35], v4 offset:2048
    ds_read_b64_tr_b16 v[36:37], v5 offset:0
    ds_read_b64_tr_b16 v[38:39], v5 offset:2048
    ds_read_b64_tr_b16 v[40:41], v6 offset:0
    ds_read_b64_tr_b16 v[42:43], v6 offset:2048
    ds_read_b64_tr_b16 v[44:45], v7 offset:0
    ds_read_b64_tr_b16 v[46:47], v7 offset:2048
    ds_read_b64_tr_b16 v[48:49], v4 offset:8192
    ds_read_b64_tr_b16 v[50:51], v4 offset:10240
    ds_read_b64_tr_b16 v[52:53], v5 offset:8192
    ds_read_b64_tr_b16 v[54:55], v5 offset:10240
    ds_read_b64_tr_b16 v[56:57], v6 offset:8192
    ds_read_b64_tr_b16 v[58:59], v6 offset:10240
L_ffn_loop_12:
    s_waitcnt lgkmcnt(6)
    v_mfma_f32_16x16x32_bf16 v[64:67], v[32:35], v[8:11], v[64:67]
    ds_read_b64_tr_b16 v[60:61], v7 offset:8192
    v_mfma_f32_16x16x32_bf16 v[96:99], v[32:35], v[12:15], v[96:99]
    ds_read_b64_tr_b16 v[62:63], v7 offset:10240
    v_mfma_f32_16x16x32_bf16 v[128:131], v[32:35], v[16:19], v[128:131]
    ds_read_b128 v[20:23], v2 offset:6144
    v_mfma_f32_16x16x32_bf16 v[132:135], v[36:39], v[16:19], v[132:135]
    ds_read_b128 v[24:27], v2 offset:8192
    v_mfma_f32_16x16x32_bf16 v[100:103], v[36:39], v[12:15], v[100:103]
    ds_read_b128 v[28:31], v2 offset:10240
    v_mfma_f32_16x16x32_bf16 v[68:71], v[36:39], v[8:11], v[68:71]
    v_mfma_f32_16x16x32_bf16 v[72:75], v[40:43], v[8:11], v[72:75]
    v_mfma_f32_16x16x32_bf16 v[104:107], v[40:43], v[12:15], v[104:107]
    v_mfma_f32_16x16x32_bf16 v[136:139], v[40:43], v[16:19], v[136:139]
    v_mfma_f32_16x16x32_bf16 v[140:143], v[44:47], v[16:19], v[140:143]
    v_mfma_f32_16x16x32_bf16 v[108:111], v[44:47], v[12:15], v[108:111]
    v_mfma_f32_16x16x32_bf16 v[76:79], v[44:47], v[8:11], v[76:79]
    s_waitcnt lgkmcnt(3)
    v_mfma_f32_16x16x32_bf16 v[80:83], v[48:51], v[8:11], v[80:83]
    v_mfma_f32_16x16x32_bf16 v[112:115], v[48:51], v[12:15], v[112:115]
    v_mfma_f32_16x16x32_bf16 v[144:147], v[48:51], v[16:19], v[144:147]
    v_mfma_f32_16x16x32_bf16 v[148:151], v[52:55], v[16:19], v[148:151]
    v_mfma_f32_16x16x32_bf16 v[116:119], v[52:55], v[12:15], v[116:119]
    v_mfma_f32_16x16x32_bf16 v[84:87], v[52:55], v[8:11], v[84:87]
    v_mfma_f32_16x16x32_bf16 v[88:91], v[56:59], v[8:11], v[88:91]
    v_mfma_f32_16x16x32_bf16 v[120:123], v[56:59], v[12:15], v[120:123]
    v_mfma_f32_16x16x32_bf16 v[152:155], v[56:59], v[16:19], v[152:155]
    v_mfma_f32_16x16x32_bf16 v[156:159], v[60:63], v[16:19], v[156:159]
    v_mfma_f32_16x16x32_bf16 v[124:127], v[60:63], v[12:15], v[124:127]
    v_mfma_f32_16x16x32_bf16 v[92:95], v[60:63], v[8:11], v[92:95]
    s_waitcnt lgkmcnt(0)
    s_barrier
    v_mfma_f32_16x16x32_bf16 v[160:163], v[32:35], v[20:23], v[160:163]
    ds_read_b128 v[8:11], v3 offset:0
    v_mfma_f32_16x16x32_bf16 v[192:195], v[32:35], v[24:27], v[192:195]
    ds_read_b128 v[12:15], v3 offset:2048
    v_mfma_f32_16x16x32_bf16 v[224:227], v[32:35], v[28:31], v[224:227]
    ds_read_b128 v[16:19], v3 offset:4096
    v_mfma_f32_16x16x32_bf16 v[228:231], v[36:39], v[28:31], v[228:231]
    ds_read_b64_tr_b16 v[32:33], v4 offset:16384
    v_mfma_f32_16x16x32_bf16 v[196:199], v[36:39], v[24:27], v[196:199]
    ds_read_b64_tr_b16 v[34:35], v4 offset:18432
    v_mfma_f32_16x16x32_bf16 v[164:167], v[36:39], v[20:23], v[164:167]
    v_mfma_f32_16x16x32_bf16 v[168:171], v[40:43], v[20:23], v[168:171]
    ds_read_b64_tr_b16 v[36:37], v5 offset:16384
    v_mfma_f32_16x16x32_bf16 v[200:203], v[40:43], v[24:27], v[200:203]
    ds_read_b64_tr_b16 v[38:39], v5 offset:18432
    v_mfma_f32_16x16x32_bf16 v[232:235], v[40:43], v[28:31], v[232:235]
    v_mfma_f32_16x16x32_bf16 v[236:239], v[44:47], v[28:31], v[236:239]
    ds_read_b64_tr_b16 v[40:41], v6 offset:16384
    v_mfma_f32_16x16x32_bf16 v[204:207], v[44:47], v[24:27], v[204:207]
    ds_read_b64_tr_b16 v[42:43], v6 offset:18432
    v_mfma_f32_16x16x32_bf16 v[172:175], v[44:47], v[20:23], v[172:175]
    v_mfma_f32_16x16x32_bf16 v[176:179], v[48:51], v[20:23], v[176:179]
    ds_read_b64_tr_b16 v[44:45], v7 offset:16384
    v_mfma_f32_16x16x32_bf16 v[208:211], v[48:51], v[24:27], v[208:211]
    ds_read_b64_tr_b16 v[46:47], v7 offset:18432
    v_mfma_f32_16x16x32_bf16 v[240:243], v[48:51], v[28:31], v[240:243]
    v_mfma_f32_16x16x32_bf16 v[244:247], v[52:55], v[28:31], v[244:247]
    ds_read_b64_tr_b16 v[48:49], v4 offset:24576
    v_mfma_f32_16x16x32_bf16 v[212:215], v[52:55], v[24:27], v[212:215]
    ds_read_b64_tr_b16 v[50:51], v4 offset:26624
    v_mfma_f32_16x16x32_bf16 v[180:183], v[52:55], v[20:23], v[180:183]
    v_mfma_f32_16x16x32_bf16 v[184:187], v[56:59], v[20:23], v[184:187]
    ds_read_b64_tr_b16 v[52:53], v5 offset:24576
    v_mfma_f32_16x16x32_bf16 v[216:219], v[56:59], v[24:27], v[216:219]
    ds_read_b64_tr_b16 v[54:55], v5 offset:26624
    v_mfma_f32_16x16x32_bf16 v[248:251], v[56:59], v[28:31], v[248:251]
    v_mfma_f32_16x16x32_bf16 v[252:255], v[60:63], v[28:31], v[252:255]
    ds_read_b64_tr_b16 v[56:57], v6 offset:24576
    v_mfma_f32_16x16x32_bf16 v[220:223], v[60:63], v[24:27], v[220:223]
    ds_read_b64_tr_b16 v[58:59], v6 offset:26624
    v_mfma_f32_16x16x32_bf16 v[188:191], v[60:63], v[20:23], v[188:191]
    s_waitcnt lgkmcnt(6)
    v_mfma_f32_16x16x32_bf16 v[64:67], v[32:35], v[8:11], v[64:67]
    ds_read_b64_tr_b16 v[60:61], v7 offset:24576
    v_mfma_f32_16x16x32_bf16 v[96:99], v[32:35], v[12:15], v[96:99]
    ds_read_b64_tr_b16 v[62:63], v7 offset:26624
    v_mfma_f32_16x16x32_bf16 v[128:131], v[32:35], v[16:19], v[128:131]
    ds_read_b128 v[20:23], v3 offset:6144
    v_mfma_f32_16x16x32_bf16 v[132:135], v[36:39], v[16:19], v[132:135]
    ds_read_b128 v[24:27], v3 offset:8192
    v_mfma_f32_16x16x32_bf16 v[100:103], v[36:39], v[12:15], v[100:103]
    ds_read_b128 v[28:31], v3 offset:10240
    v_mfma_f32_16x16x32_bf16 v[68:71], v[36:39], v[8:11], v[68:71]
    v_mfma_f32_16x16x32_bf16 v[72:75], v[40:43], v[8:11], v[72:75]
    s_add_u32 s63, s63, 1
    s_cmp_eq_u32 s63, 3
    v_mfma_f32_16x16x32_bf16 v[104:107], v[40:43], v[12:15], v[104:107]
    s_cselect_b32 s61, 0xffff4000, s55
    s_cselect_b32 s63, 0, s63
    v_mfma_f32_16x16x32_bf16 v[136:139], v[40:43], v[16:19], v[136:139]
    v_add_u32 v2, s61, v2
    v_add_u32 v3, s61, v3
    v_mfma_f32_16x16x32_bf16 v[140:143], v[44:47], v[16:19], v[140:143]
    v_add_u32 v4, s62, v4
    v_add_u32 v5, s62, v5
    v_mfma_f32_16x16x32_bf16 v[108:111], v[44:47], v[12:15], v[108:111]
    v_add_u32 v6, s62, v6
    v_add_u32 v7, s62, v7
    v_mfma_f32_16x16x32_bf16 v[76:79], v[44:47], v[8:11], v[76:79]
    s_sub_u32 s62, 0, s62
    s_waitcnt lgkmcnt(3)
    v_mfma_f32_16x16x32_bf16 v[80:83], v[48:51], v[8:11], v[80:83]
    v_mfma_f32_16x16x32_bf16 v[112:115], v[48:51], v[12:15], v[112:115]
    s_add_u32 s60, s60, 1
    s_cmp_lg_u32 s60, s65
    v_mfma_f32_16x16x32_bf16 v[144:147], v[48:51], v[16:19], v[144:147]
    v_mfma_f32_16x16x32_bf16 v[148:151], v[52:55], v[16:19], v[148:151]
    v_mfma_f32_16x16x32_bf16 v[116:119], v[52:55], v[12:15], v[116:119]
    v_mfma_f32_16x16x32_bf16 v[84:87], v[52:55], v[8:11], v[84:87]
    v_mfma_f32_16x16x32_bf16 v[88:91], v[56:59], v[8:11], v[88:91]
    v_mfma_f32_16x16x32_bf16 v[120:123], v[56:59], v[12:15], v[120:123]
    v_mfma_f32_16x16x32_bf16 v[152:155], v[56:59], v[16:19], v[152:155]
    v_mfma_f32_16x16x32_bf16 v[156:159], v[60:63], v[16:19], v[156:159]
    v_mfma_f32_16x16x32_bf16 v[124:127], v[60:63], v[12:15], v[124:127]
    v_mfma_f32_16x16x32_bf16 v[92:95], v[60:63], v[8:11], v[92:95]
    s_waitcnt lgkmcnt(0)
    s_barrier
    v_mfma_f32_16x16x32_bf16 v[160:163], v[32:35], v[20:23], v[160:163]
    ds_read_b128 v[8:11], v2 offset:0
    v_mfma_f32_16x16x32_bf16 v[192:195], v[32:35], v[24:27], v[192:195]
    ds_read_b128 v[12:15], v2 offset:2048
    v_mfma_f32_16x16x32_bf16 v[224:227], v[32:35], v[28:31], v[224:227]
    ds_read_b128 v[16:19], v2 offset:4096
    v_mfma_f32_16x16x32_bf16 v[228:231], v[36:39], v[28:31], v[228:231]
    ds_read_b64_tr_b16 v[32:33], v4 offset:0
    v_mfma_f32_16x16x32_bf16 v[196:199], v[36:39], v[24:27], v[196:199]
    ds_read_b64_tr_b16 v[34:35], v4 offset:2048
    v_mfma_f32_16x16x32_bf16 v[164:167], v[36:39], v[20:23], v[164:167]
    v_mfma_f32_16x16x32_bf16 v[168:171], v[40:43], v[20:23], v[168:171]
    ds_read_b64_tr_b16 v[36:37], v5 offset:0
    v_mfma_f32_16x16x32_bf16 v[200:203], v[40:43], v[24:27], v[200:203]
    ds_read_b64_tr_b16 v[38:39], v5 offset:2048
    v_mfma_f32_16x16x32_bf16 v[232:235], v[40:43], v[28:31], v[232:235]
    v_mfma_f32_16x16x32_bf16 v[236:239], v[44:47], v[28:31], v[236:239]
    ds_read_b64_tr_b16 v[40:41], v6 offset:0
    v_mfma_f32_16x16x32_bf16 v[204:207], v[44:47], v[24:27], v[204:207]
    ds_read_b64_tr_b16 v[42:43], v6 offset:2048
    v_mfma_f32_16x16x32_bf16 v[172:175], v[44:47], v[20:23], v[172:175]
    v_mfma_f32_16x16x32_bf16 v[176:179], v[48:51], v[20:23], v[176:179]
    ds_read_b64_tr_b16 v[44:45], v7 offset:0
    v_mfma_f32_16x16x32_bf16 v[208:211], v[48:51], v[24:27], v[208:211]
    ds_read_b64_tr_b16 v[46:47], v7 offset:2048
    v_mfma_f32_16x16x32_bf16 v[240:243], v[48:51], v[28:31], v[240:243]
    v_mfma_f32_16x16x32_bf16 v[244:247], v[52:55], v[28:31], v[244:247]
    ds_read_b64_tr_b16 v[48:49], v4 offset:8192
    v_mfma_f32_16x16x32_bf16 v[212:215], v[52:55], v[24:27], v[212:215]
    ds_read_b64_tr_b16 v[50:51], v4 offset:10240
    v_mfma_f32_16x16x32_bf16 v[180:183], v[52:55], v[20:23], v[180:183]
    v_mfma_f32_16x16x32_bf16 v[184:187], v[56:59], v[20:23], v[184:187]
    ds_read_b64_tr_b16 v[52:53], v5 offset:8192
    v_mfma_f32_16x16x32_bf16 v[216:219], v[56:59], v[24:27], v[216:219]
    ds_read_b64_tr_b16 v[54:55], v5 offset:10240
    v_mfma_f32_16x16x32_bf16 v[248:251], v[56:59], v[28:31], v[248:251]
    v_mfma_f32_16x16x32_bf16 v[252:255], v[60:63], v[28:31], v[252:255]
    ds_read_b64_tr_b16 v[56:57], v6 offset:8192
    v_mfma_f32_16x16x32_bf16 v[220:223], v[60:63], v[24:27], v[220:223]
    ds_read_b64_tr_b16 v[58:59], v6 offset:10240
    v_mfma_f32_16x16x32_bf16 v[188:191], v[60:63], v[20:23], v[188:191]
    s_cbranch_scc1 L_ffn_loop_12
    s_cmp_eq_u32 s60, 9
    s_cbranch_scc1 L_lout_13
    v_mov_b32 v0, 1
    s_lshr_b32 s54, s2, 3
    s_lshl2_add_u32 s54, s54, 128
    s_mov_b64 exec, 1
    buffer_atomic_add v0, v1, s[32:35], s54 offen sc1
    s_mov_b64 exec, -1
    s_mov_b32 s65, 9
    s_branch L_ffn_loop_12
L_lout_13:
    s_waitcnt lgkmcnt(6)
    v_mfma_f32_16x16x32_bf16 v[64:67], v[32:35], v[8:11], v[64:67]
    ds_read_b64_tr_b16 v[60:61], v7 offset:8192
    v_mfma_f32_16x16x32_bf16 v[96:99], v[32:35], v[12:15], v[96:99]
    ds_read_b64_tr_b16 v[62:63], v7 offset:10240
    v_mfma_f32_16x16x32_bf16 v[128:131], v[32:35], v[16:19], v[128:131]
    ds_read_b128 v[20:23], v2 offset:6144
    v_mfma_f32_16x16x32_bf16 v[132:135], v[36:39], v[16:19], v[132:135]
    ds_read_b128 v[24:27], v2 offset:8192
    v_mfma_f32_16x16x32_bf16 v[100:103], v[36:39], v[12:15], v[100:103]
    ds_read_b128 v[28:31], v2 offset:10240
    v_mfma_f32_16x16x32_bf16 v[68:71], v[36:39], v[8:11], v[68:71]
    v_mfma_f32_16x16x32_bf16 v[72:75], v[40:43], v[8:11], v[72:75]
    v_mfma_f32_16x16x32_bf16 v[104:107], v[40:43], v[12:15], v[104:107]
    v_mfma_f32_16x16x32_bf16 v[136:139], v[40:43], v[16:19], v[136:139]
    v_mfma_f32_16x16x32_bf16 v[140:143], v[44:47], v[16:19], v[140:143]
    v_mfma_f32_16x16x32_bf16 v[108:111], v[44:47], v[12:15], v[108:111]
    v_mfma_f32_16x16x32_bf16 v[76:79], v[44:47], v[8:11], v[76:79]
    s_waitcnt lgkmcnt(3)
    v_mfma_f32_16x16x32_bf16 v[80:83], v[48:51], v[8:11], v[80:83]
    v_mfma_f32_16x16x32_bf16 v[112:115], v[48:51], v[12:15], v[112:115]
    v_mfma_f32_16x16x32_bf16 v[144:147], v[48:51], v[16:19], v[144:147]
    v_mfma_f32_16x16x32_bf16 v[148:151], v[52:55], v[16:19], v[148:151]
    v_mfma_f32_16x16x32_bf16 v[116:119], v[52:55], v[12:15], v[116:119]
    v_mfma_f32_16x16x32_bf16 v[84:87], v[52:55], v[8:11], v[84:87]
    v_mfma_f32_16x16x32_bf16 v[88:91], v[56:59], v[8:11], v[88:91]
    v_mfma_f32_16x16x32_bf16 v[120:123], v[56:59], v[12:15], v[120:123]
    v_mfma_f32_16x16x32_bf16 v[152:155], v[56:59], v[16:19], v[152:155]
    v_mfma_f32_16x16x32_bf16 v[156:159], v[60:63], v[16:19], v[156:159]
    v_mfma_f32_16x16x32_bf16 v[124:127], v[60:63], v[12:15], v[124:127]
    v_mfma_f32_16x16x32_bf16 v[92:95], v[60:63], v[8:11], v[92:95]
    s_waitcnt lgkmcnt(0)
    v_mfma_f32_16x16x32_bf16 v[160:163], v[32:35], v[20:23], v[160:163]
    ds_read_b128 v[8:11], v3 offset:0
    v_mfma_f32_16x16x32_bf16 v[192:195], v[32:35], v[24:27], v[192:195]
    ds_read_b128 v[12:15], v3 offset:2048
    v_mfma_f32_16x16x32_bf16 v[224:227], v[32:35], v[28:31], v[224:227]
    ds_read_b128 v[16:19], v3 offset:4096
    v_mfma_f32_16x16x32_bf16 v[228:231], v[36:39], v[28:31], v[228:231]
    ds_read_b64_tr_b16 v[32:33], v4 offset:16384
    v_mfma_f32_16x16x32_bf16 v[196:199], v[36:39], v[24:27], v[196:199]
    ds_read_b64_tr_b16 v[34:35], v4 offset:18432
    v_mfma_f32_16x16x32_bf16 v[164:167], v[36:39], v[20:23], v[164:167]
    v_mfma_f32_16x16x32_bf16 v[168:171], v[40:43], v[20:23], v[168:171]
    ds_read_b64_tr_b16 v[36:37], v5 offset:16384
    v_mfma_f32_16x16x32_bf16 v[200:203], v[40:43], v[24:27], v[200:203]
    ds_read_b64_tr_b16 v[38:39], v5 offset:18432
    v_mfma_f32_16x16x32_bf16 v[232:235], v[40:43], v[28:31], v[232:235]
    v_mfma_f32_16x16x32_bf16 v[236:239], v[44:47], v[28:31], v[236:239]
    ds_read_b64_tr_b16 v[40:41], v6 offset:16384
    v_mfma_f32_16x16x32_bf16 v[204:207], v[44:47], v[24:27], v[204:207]
    ds_read_b64_tr_b16 v[42:43], v6 offset:18432
    v_mfma_f32_16x16x32_bf16 v[172:175], v[44:47], v[20:23], v[172:175]
    v_mfma_f32_16x16x32_bf16 v[176:179], v[48:51], v[20:23], v[176:179]
    ds_read_b64_tr_b16 v[44:45], v7 offset:16384
    v_mfma_f32_16x16x32_bf16 v[208:211], v[48:51], v[24:27], v[208:211]
    ds_read_b64_tr_b16 v[46:47], v7 offset:18432
    v_mfma_f32_16x16x32_bf16 v[240:243], v[48:51], v[28:31], v[240:243]
    v_mfma_f32_16x16x32_bf16 v[244:247], v[52:55], v[28:31], v[244:247]
    ds_read_b64_tr_b16 v[48:49], v4 offset:24576
    v_mfma_f32_16x16x32_bf16 v[212:215], v[52:55], v[24:27], v[212:215]
    ds_read_b64_tr_b16 v[50:51], v4 offset:26624
    v_mfma_f32_16x16x32_bf16 v[180:183], v[52:55], v[20:23], v[180:183]
    v_mfma_f32_16x16x32_bf16 v[184:187], v[56:59], v[20:23], v[184:187]
    ds_read_b64_tr_b16 v[52:53], v5 offset:24576
    v_mfma_f32_16x16x32_bf16 v[216:219], v[56:59], v[24:27], v[216:219]
    ds_read_b64_tr_b16 v[54:55], v5 offset:26624
    v_mfma_f32_16x16x32_bf16 v[248:251], v[56:59], v[28:31], v[248:251]
    v_mfma_f32_16x16x32_bf16 v[252:255], v[60:63], v[28:31], v[252:255]
    ds_read_b64_tr_b16 v[56:57], v6 offset:24576
    v_mfma_f32_16x16x32_bf16 v[220:223], v[60:63], v[24:27], v[220:223]
    ds_read_b64_tr_b16 v[58:59], v6 offset:26624
    v_mfma_f32_16x16x32_bf16 v[188:191], v[60:63], v[20:23], v[188:191]
    s_waitcnt lgkmcnt(6)
    v_mfma_f32_16x16x32_bf16 v[64:67], v[32:35], v[8:11], v[64:67]
    ds_read_b64_tr_b16 v[60:61], v7 offset:24576
    v_mfma_f32_16x16x32_bf16 v[96:99], v[32:35], v[12:15], v[96:99]
    ds_read_b64_tr_b16 v[62:63], v7 offset:26624
    v_mfma_f32_16x16x32_bf16 v[128:131], v[32:35], v[16:19], v[128:131]
    ds_read_b128 v[20:23], v3 offset:6144
    v_mfma_f32_16x16x32_bf16 v[132:135], v[36:39], v[16:19], v[132:135]
    ds_read_b128 v[24:27], v3 offset:8192
    v_mfma_f32_16x16x32_bf16 v[100:103], v[36:39], v[12:15], v[100:103]
    ds_read_b128 v[28:31], v3 offset:10240
    v_mfma_f32_16x16x32_bf16 v[68:71], v[36:39], v[8:11], v[68:71]
    v_mfma_f32_16x16x32_bf16 v[72:75], v[40:43], v[8:11], v[72:75]
    v_mfma_f32_16x16x32_bf16 v[104:107], v[40:43], v[12:15], v[104:107]
    v_mfma_f32_16x16x32_bf16 v[136:139], v[40:43], v[16:19], v[136:139]
    v_mfma_f32_16x16x32_bf16 v[140:143], v[44:47], v[16:19], v[140:143]
    v_mfma_f32_16x16x32_bf16 v[108:111], v[44:47], v[12:15], v[108:111]
    v_mfma_f32_16x16x32_bf16 v[76:79], v[44:47], v[8:11], v[76:79]
    s_waitcnt lgkmcnt(3)
    v_mfma_f32_16x16x32_bf16 v[80:83], v[48:51], v[8:11], v[80:83]
    v_mfma_f32_16x16x32_bf16 v[112:115], v[48:51], v[12:15], v[112:115]
    v_mfma_f32_16x16x32_bf16 v[144:147], v[48:51], v[16:19], v[144:147]
    v_mfma_f32_16x16x32_bf16 v[148:151], v[52:55], v[16:19], v[148:151]
    v_mfma_f32_16x16x32_bf16 v[116:119], v[52:55], v[12:15], v[116:119]
    v_mfma_f32_16x16x32_bf16 v[84:87], v[52:55], v[8:11], v[84:87]
    v_mfma_f32_16x16x32_bf16 v[88:91], v[56:59], v[8:11], v[88:91]
    v_mfma_f32_16x16x32_bf16 v[120:123], v[56:59], v[12:15], v[120:123]
    v_mfma_f32_16x16x32_bf16 v[152:155], v[56:59], v[16:19], v[152:155]
    v_mfma_f32_16x16x32_bf16 v[156:159], v[60:63], v[16:19], v[156:159]
    v_mfma_f32_16x16x32_bf16 v[124:127], v[60:63], v[12:15], v[124:127]
    v_mfma_f32_16x16x32_bf16 v[92:95], v[60:63], v[8:11], v[92:95]
    v_mov_b32 v2, 0x26c10
    v_mov_b32 v3, 1
    s_mov_b64 exec, 1
    ds_add_u32 v2, v3
    s_mov_b64 exec, -1
    v_and_b32 v4, 15, v1
    v_lshl_add_u32 v4, v4, 3, s59
    ds_read_b64 v[8:9], v4 offset:0
    ds_read_b64 v[10:11], v4 offset:128
    ds_read_b64 v[12:13], v4 offset:256
    ds_read_b64 v[14:15], v4 offset:384
    ds_read_b64 v[16:17], v4 offset:512
    ds_read_b64 v[18:19], v4 offset:640
    v_and_b32 v5, 48, v1
    v_add_u32 v5, s66, v5
    v_lshrrev_b32 v6, 4, v1
    v_and_b32 v7, 15, v1
    v_lshlrev_b32 v7, 4, v7
    v_lshl_add_u32 v6, v6, 9, v7
    s_waitcnt lgkmcnt(7)
    v_mfma_f32_16x16x32_bf16 v[160:163], v[32:35], v[20:23], v[160:163]
    v_mfma_f32_16x16x32_bf16 v[192:195], v[32:35], v[24:27], v[192:195]
    v_mfma_f32_16x16x32_bf16 v[224:227], v[32:35], v[28:31], v[224:227]
    v_mfma_f32_16x16x32_bf16 v[228:231], v[36:39], v[28:31], v[228:231]
    v_mfma_f32_16x16x32_bf16 v[196:199], v[36:39], v[24:27], v[196:199]
    v_mfma_f32_16x16x32_bf16 v[164:167], v[36:39], v[20:23], v[164:167]
    v_mfma_f32_16x16x32_bf16 v[168:171], v[40:43], v[20:23], v[168:171]
    v_mfma_f32_16x16x32_bf16 v[200:203], v[40:43], v[24:27], v[200:203]
    v_mfma_f32_16x16x32_bf16 v[232:235], v[40:43], v[28:31], v[232:235]
    v_mfma_f32_16x16x32_bf16 v[236:239], v[44:47], v[28:31], v[236:239]
    v_mfma_f32_16x16x32_bf16 v[204:207], v[44:47], v[24:27], v[204:207]
    v_mfma_f32_16x16x32_bf16 v[172:175], v[44:47], v[20:23], v[172:175]
    v_mfma_f32_16x16x32_bf16 v[176:179], v[48:51], v[20:23], v[176:179]
    v_mfma_f32_16x16x32_bf16 v[208:211], v[48:51], v[24:27], v[208:211]
    v_mfma_f32_16x16x32_bf16 v[240:243], v[48:51], v[28:31], v[240:243]
    v_mfma_f32_16x16x32_bf16 v[244:247], v[52:55], v[28:31], v[244:247]
    v_mfma_f32_16x16x32_bf16 v[212:215], v[52:55], v[24:27], v[212:215]
    v_mfma_f32_16x16x32_bf16 v[180:183], v[52:55], v[20:23], v[180:183]
    v_mfma_f32_16x16x32_bf16 v[184:187], v[56:59], v[20:23], v[184:187]
    v_mfma_f32_16x16x32_bf16 v[216:219], v[56:59], v[24:27], v[216:219]
    v_mfma_f32_16x16x32_bf16 v[248:251], v[56:59], v[28:31], v[248:251]
    v_mfma_f32_16x16x32_bf16 v[252:255], v[60:63], v[28:31], v[252:255]
    v_mfma_f32_16x16x32_bf16 v[220:223], v[60:63], v[24:27], v[220:223]
    v_mfma_f32_16x16x32_bf16 v[188:191], v[60:63], v[20:23], v[188:191]
    s_setprio 3
    ds_read_b128 v[32:35], v5 offset:0
    ds_read_b128 v[36:39], v5 offset:64
    ds_read_b128 v[40:43], v5 offset:128
    ds_read_b128 v[44:47], v5 offset:192
    ds_read_b128 v[48:51], v5 offset:512
    ds_read_b128 v[52:55], v5 offset:576
    ds_read_b128 v[56:59], v5 offset:640
    ds_read_b128 v[60:63], v5 offset:704
    s_waitcnt lgkmcnt(8)
    v_mul_f32 v20, 0xbfb8aa3b, v9
    v_mul_f32 v21, v9, v9
    v_rcp_f32 v21, v21
    v_mul_f32 v22, 0xbfb8aa3b, v11
    v_mul_f32 v23, v11, v11
    v_rcp_f32 v23, v23
    v_mul_f32 v24, 0xbfb8aa3b, v13
    v_mul_f32 v25, v13, v13
    v_rcp_f32 v25, v25
    v_mul_f32 v26, 0xbfb8aa3b, v15
    v_mul_f32 v27, v15, v15
    v_rcp_f32 v27, v27
    v_mul_f32 v28, 0xbfb8aa3b, v17
    v_mul_f32 v29, v17, v17
    v_rcp_f32 v29, v29
    v_mul_f32 v30, 0xbfb8aa3b, v19
    v_mul_f32 v31, v19, v19
    v_rcp_f32 v31, v31
    s_waitcnt lgkmcnt(0)
    v_pk_fma_f32 v[64:65], v[32:33], v[8:9], v[64:65] op_sel_hi:[1,0,1]
    v_pk_fma_f32 v[66:67], v[34:35], v[8:9], v[66:67] op_sel_hi:[1,0,1]
    v_pk_fma_f32 v[68:69], v[36:37], v[8:9], v[68:69] op_sel_hi:[1,0,1]
    v_pk_fma_f32 v[70:71], v[38:39], v[8:9], v[70:71] op_sel_hi:[1,0,1]
    v_pk_fma_f32 v[72:73], v[40:41], v[8:9], v[72:73] op_sel_hi:[1,0,1]
    v_pk_fma_f32 v[74:75], v[42:43], v[8:9], v[74:75] op_sel_hi:[1,0,1]
    v_pk_fma_f32 v[76:77], v[44:45], v[8:9], v[76:77] op_sel_hi:[1,0,1]
    v_pk_fma_f32 v[78:79], v[46:47], v[8:9], v[78:79] op_sel_hi:[1,0,1]
    v_pk_fma_f32 v[80:81], v[48:49], v[8:9], v[80:81] op_sel_hi:[1,0,1]
    v_pk_fma_f32 v[82:83], v[50:51], v[8:9], v[82:83] op_sel_hi:[1,0,1]
    v_pk_fma_f32 v[84:85], v[52:53], v[8:9], v[84:85] op_sel_hi:[1,0,1]
    v_pk_fma_f32 v[86:87], v[54:55], v[8:9], v[86:87] op_sel_hi:[1,0,1]
    v_pk_fma_f32 v[88:89], v[56:57], v[8:9], v[88:89] op_sel_hi:[1,0,1]
    v_pk_fma_f32 v[90:91], v[58:59], v[8:9], v[90:91] op_sel_hi:[1,0,1]
    v_pk_fma_f32 v[92:93], v[60:61], v[8:9], v[92:93] op_sel_hi:[1,0,1]
    v_pk_fma_f32 v[94:95], v[62:63], v[8:9], v[94:95] op_sel_hi:[1,0,1]
    v_pk_mul_f32 v[80:81], v[64:65], v[80:81]
    v_pk_mul_f32 v[82:83], v[66:67], v[82:83]
    v_pk_mul_f32 v[84:85], v[68:69], v[84:85]
    v_pk_mul_f32 v[86:87], v[70:71], v[86:87]
    v_pk_mul_f32 v[88:89], v[72:73], v[88:89]
    v_pk_mul_f32 v[90:91], v[74:75], v[90:91]
    v_pk_mul_f32 v[92:93], v[76:77], v[92:93]
    v_pk_mul_f32 v[94:95], v[78:79], v[94:95]
    v_pk_mul_f32 v[64:65], v[64:65], v[20:21] op_sel_hi:[1,0]
    v_pk_mul_f32 v[66:67], v[66:67], v[20:21] op_sel_hi:[1,0]
    v_pk_mul_f32 v[68:69], v[68:69], v[20:21] op_sel_hi:[1,0]
    v_pk_mul_f32 v[70:71], v[70:71], v[20:21] op_sel_hi:[1,0]
    v_pk_mul_f32 v[72:73], v[72:73], v[20:21] op_sel_hi:[1,0]
    v_pk_mul_f32 v[74:75], v[74:75], v[20:21] op_sel_hi:[1,0]
    v_pk_mul_f32 v[76:77], v[76:77], v[20:21] op_sel_hi:[1,0]
    v_pk_mul_f32 v[78:79], v[78:79], v[20:21] op_sel_hi:[1,0]
    v_exp_f32 v64, v64
    v_exp_f32 v65, v65
    v_exp_f32 v66, v66
    v_exp_f32 v67, v67
    v_exp_f32 v68, v68
    v_exp_f32 v69, v69
    v_exp_f32 v70, v70
    v_exp_f32 v71, v71
    v_exp_f32 v72, v72
    v_exp_f32 v73, v73
    v_exp_f32 v74, v74
    v_exp_f32 v75, v75
    v_exp_f32 v76, v76
    v_exp_f32 v77, v77
    v_exp_f32 v78, v78
    v_exp_f32 v79, v79
    v_pk_fma_f32 v[64:65], v[64:65], v[20:21], v[20:21] op_sel:[0,1,1] op_sel_hi:[1,1,1]
    v_pk_fma_f32 v[66:67], v[66:67], v[20:21], v[20:21] op_sel:[0,1,1] op_sel_hi:[1,1,1]
    v_pk_fma_f32 v[68:69], v[68:69], v[20:21], v[20:21] op_sel:[0,1,1] op_sel_hi:[1,1,1]
    v_pk_fma_f32 v[70:71], v[70:71], v[20:21], v[20:21] op_sel:[0,1,1] op_sel_hi:[1,1,1]
    v_pk_fma_f32 v[72:73], v[72:73], v[20:21], v[20:21] op_sel:[0,1,1] op_sel_hi:[1,1,1]
    v_pk_fma_f32 v[74:75], v[74:75], v[20:21], v[20:21] op_sel:[0,1,1] op_sel_hi:[1,1,1]
    v_pk_fma_f32 v[76:77], v[76:77], v[20:21], v[20:21] op_sel:[0,1,1] op_sel_hi:[1,1,1]
    v_pk_fma_f32 v[78:79], v[78:79], v[20:21], v[20:21] op_sel:[0,1,1] op_sel_hi:[1,1,1]
    v_rcp_f32 v64, v64
    v_rcp_f32 v65, v65
    v_rcp_f32 v66, v66
    v_rcp_f32 v67, v67
    v_rcp_f32 v68, v68
    v_rcp_f32 v69, v69
    v_rcp_f32 v70, v70
    v_rcp_f32 v71, v71
    v_rcp_f32 v72, v72
    v_rcp_f32 v73, v73
    v_rcp_f32 v74, v74
    v_rcp_f32 v75, v75
    v_rcp_f32 v76, v76
    v_rcp_f32 v77, v77
    v_rcp_f32 v78, v78
    v_rcp_f32 v79, v79
    v_pk_mul_f32 v[80:81], v[80:81], v[64:65]
    v_pk_mul_f32 v[82:83], v[82:83], v[66:67]
    v_pk_mul_f32 v[84:85], v[84:85], v[68:69]
    v_pk_mul_f32 v[86:87], v[86:87], v[70:71]
    v_pk_mul_f32 v[88:89], v[88:89], v[72:73]
    v_pk_mul_f32 v[90:91], v[90:91], v[74:75]
    v_pk_mul_f32 v[92:93], v[92:93], v[76:77]
    v_pk_mul_f32 v[94:95], v[94:95], v[78:79]
    v_cvt_pk_bf16_f32 v64, v80, v81
    v_cvt_pk_bf16_f32 v65, v82, v83
    v_cvt_pk_bf16_f32 v66, v84, v85
    v_cvt_pk_bf16_f32 v67, v86, v87
    v_cvt_pk_bf16_f32 v68, v88, v89
    v_cvt_pk_bf16_f32 v69, v90, v91
    v_cvt_pk_bf16_f32 v70, v92, v93
    v_cvt_pk_bf16_f32 v71, v94, v95
    buffer_store_dwordx4 v[64:67], v6, s[28:31], s56 offen offset:0 sc1
    buffer_store_dwordx4 v[68:71], v6, s[28:31], s56 offen offset:2048 sc1
    v_pk_fma_f32 v[96:97], v[32:33], v[10:11], v[96:97] op_sel_hi:[1,0,1]
    v_pk_fma_f32 v[98:99], v[34:35], v[10:11], v[98:99] op_sel_hi:[1,0,1]
    v_pk_fma_f32 v[100:101], v[36:37], v[10:11], v[100:101] op_sel_hi:[1,0,1]
    v_pk_fma_f32 v[102:103], v[38:39], v[10:11], v[102:103] op_sel_hi:[1,0,1]
    v_pk_fma_f32 v[104:105], v[40:41], v[10:11], v[104:105] op_sel_hi:[1,0,1]
    v_pk_fma_f32 v[106:107], v[42:43], v[10:11], v[106:107] op_sel_hi:[1,0,1]
    v_pk_fma_f32 v[108:109], v[44:45], v[10:11], v[108:109] op_sel_hi:[1,0,1]
    v_pk_fma_f32 v[110:111], v[46:47], v[10:11], v[110:111] op_sel_hi:[1,0,1]
    v_pk_fma_f32 v[112:113], v[48:49], v[10:11], v[112:113] op_sel_hi:[1,0,1]
    v_pk_fma_f32 v[114:115], v[50:51], v[10:11], v[114:115] op_sel_hi:[1,0,1]
    v_pk_fma_f32 v[116:117], v[52:53], v[10:11], v[116:117] op_sel_hi:[1,0,1]
    v_pk_fma_f32 v[118:119], v[54:55], v[10:11], v[118:119] op_sel_hi:[1,0,1]
    v_pk_fma_f32 v[120:121], v[56:57], v[10:11], v[120:121] op_sel_hi:[1,0,1]
    v_pk_fma_f32 v[122:123], v[58:59], v[10:11], v[122:123] op_sel_hi:[1,0,1]
    v_pk_fma_f32 v[124:125], v[60:61], v[10:11], v[124:125] op_sel_hi:[1,0,1]
    v_pk_fma_f32 v[126:127], v[62:63], v[10:11], v[126:127] op_sel_hi:[1,0,1]
    v_pk_mul_f32 v[112:113], v[96:97], v[112:113]
    v_pk_mul_f32 v[114:115], v[98:99], v[114:115]
    v_pk_mul_f32 v[116:117], v[100:101], v[116:117]
    v_pk_mul_f32 v[118:119], v[102:103], v[118:119]
    v_pk_mul_f32 v[120:121], v[104:105], v[120:121]
    v_pk_mul_f32 v[122:123], v[106:107], v[122:123]
    v_pk_mul_f32 v[124:125], v[108:109], v[124:125]
    v_pk_mul_f32 v[126:127], v[110:111], v[126:127]
    v_pk_mul_f32 v[96:97], v[96:97], v[22:23] op_sel_hi:[1,0]
    v_pk_mul_f32 v[98:99], v[98:99], v[22:23] op_sel_hi:[1,0]
    v_pk_mul_f32 v[100:101], v[100:101], v[22:23] op_sel_hi:[1,0]
    v_pk_mul_f32 v[102:103], v[102:103], v[22:23] op_sel_hi:[1,0]
    v_pk_mul_f32 v[104:105], v[104:105], v[22:23] op_sel_hi:[1,0]
    v_pk_mul_f32 v[106:107], v[106:107], v[22:23] op_sel_hi:[1,0]
    v_pk_mul_f32 v[108:109], v[108:109], v[22:23] op_sel_hi:[1,0]
    v_pk_mul_f32 v[110:111], v[110:111], v[22:23] op_sel_hi:[1,0]
    v_exp_f32 v96, v96
    v_exp_f32 v97, v97
    v_exp_f32 v98, v98
    v_exp_f32 v99, v99
    v_exp_f32 v100, v100
    v_exp_f32 v101, v101
    v_exp_f32 v102, v102
    v_exp_f32 v103, v103
    v_exp_f32 v104, v104
    v_exp_f32 v105, v105
    v_exp_f32 v106, v106
    v_exp_f32 v107, v107
    v_exp_f32 v108, v108
    v_exp_f32 v109, v109
    v_exp_f32 v110, v110
    v_exp_f32 v111, v111
    v_pk_fma_f32 v[96:97], v[96:97], v[22:23], v[22:23] op_sel:[0,1,1] op_sel_hi:[1,1,1]
    v_pk_fma_f32 v[98:99], v[98:99], v[22:23], v[22:23] op_sel:[0,1,1] op_sel_hi:[1,1,1]
    v_pk_fma_f32 v[100:101], v[100:101], v[22:23], v[22:23] op_sel:[0,1,1] op_sel_hi:[1,1,1]
    v_pk_fma_f32 v[102:103], v[102:103], v[22:23], v[22:23] op_sel:[0,1,1] op_sel_hi:[1,1,1]
    v_pk_fma_f32 v[104:105], v[104:105], v[22:23], v[22:23] op_sel:[0,1,1] op_sel_hi:[1,1,1]
    v_pk_fma_f32 v[106:107], v[106:107], v[22:23], v[22:23] op_sel:[0,1,1] op_sel_hi:[1,1,1]
    v_pk_fma_f32 v[108:109], v[108:109], v[22:23], v[22:23] op_sel:[0,1,1] op_sel_hi:[1,1,1]
    v_pk_fma_f32 v[110:111], v[110:111], v[22:23], v[22:23] op_sel:[0,1,1] op_sel_hi:[1,1,1]
    v_rcp_f32 v96, v96
    v_rcp_f32 v97, v97
    v_rcp_f32 v98, v98
    v_rcp_f32 v99, v99
    v_rcp_f32 v100, v100
    v_rcp_f32 v101, v101
    v_rcp_f32 v102, v102
    v_rcp_f32 v103, v103
    v_rcp_f32 v104, v104
    v_rcp_f32 v105, v105
    v_rcp_f32 v106, v106
    v_rcp_f32 v107, v107
    v_rcp_f32 v108, v108
    v_rcp_f32 v109, v109
    v_rcp_f32 v110, v110
    v_rcp_f32 v111, v111
    v_pk_mul_f32 v[112:113], v[112:113], v[96:97]
    v_pk_mul_f32 v[114:115], v[114:115], v[98:99]
    v_pk_mul_f32 v[116:117], v[116:117], v[100:101]
    v_pk_mul_f32 v[118:119], v[118:119], v[102:103]
    v_pk_mul_f32 v[120:121], v[120:121], v[104:105]
    v_pk_mul_f32 v[122:123], v[122:123], v[106:107]
    v_pk_mul_f32 v[124:125], v[124:125], v[108:109]
    v_pk_mul_f32 v[126:127], v[126:127], v[110:111]
    v_cvt_pk_bf16_f32 v96, v112, v113
    v_cvt_pk_bf16_f32 v97, v114, v115
    v_cvt_pk_bf16_f32 v98, v116, v117
    v_cvt_pk_bf16_f32 v99, v118, v119
    v_cvt_pk_bf16_f32 v100, v120, v121
    v_cvt_pk_bf16_f32 v101, v122, v123
    v_cvt_pk_bf16_f32 v102, v124, v125
    v_cvt_pk_bf16_f32 v103, v126, v127
    buffer_store_dwordx4 v[96:99], v6, s[28:31], s56 offen offset:256 sc1
    buffer_store_dwordx4 v[100:103], v6, s[28:31], s56 offen offset:2304 sc1
    v_pk_fma_f32 v[128:129], v[32:33], v[12:13], v[128:129] op_sel_hi:[1,0,1]
    v_pk_fma_f32 v[130:131], v[34:35], v[12:13], v[130:131] op_sel_hi:[1,0,1]
    v_pk_fma_f32 v[132:133], v[36:37], v[12:13], v[132:133] op_sel_hi:[1,0,1]
    v_pk_fma_f32 v[134:135], v[38:39], v[12:13], v[134:135] op_sel_hi:[1,0,1]
    v_pk_fma_f32 v[136:137], v[40:41], v[12:13], v[136:137] op_sel_hi:[1,0,1]
    v_pk_fma_f32 v[138:139], v[42:43], v[12:13], v[138:139] op_sel_hi:[1,0,1]
    v_pk_fma_f32 v[140:141], v[44:45], v[12:13], v[140:141] op_sel_hi:[1,0,1]
    v_pk_fma_f32 v[142:143], v[46:47], v[12:13], v[142:143] op_sel_hi:[1,0,1]
    v_pk_fma_f32 v[144:145], v[48:49], v[12:13], v[144:145] op_sel_hi:[1,0,1]
    v_pk_fma_f32 v[146:147], v[50:51], v[12:13], v[146:147] op_sel_hi:[1,0,1]
    v_pk_fma_f32 v[148:149], v[52:53], v[12:13], v[148:149] op_sel_hi:[1,0,1]
    v_pk_fma_f32 v[150:151], v[54:55], v[12:13], v[150:151] op_sel_hi:[1,0,1]
    v_pk_fma_f32 v[152:153], v[56:57], v[12:13], v[152:153] op_sel_hi:[1,0,1]
    v_pk_fma_f32 v[154:155], v[58:59], v[12:13], v[154:155] op_sel_hi:[1,0,1]
    v_pk_fma_f32 v[156:157], v[60:61], v[12:13], v[156:157] op_sel_hi:[1,0,1]
    v_pk_fma_f32 v[158:159], v[62:63], v[12:13], v[158:159] op_sel_hi:[1,0,1]
    v_pk_mul_f32 v[144:145], v[128:129], v[144:145]
    v_pk_mul_f32 v[146:147], v[130:131], v[146:147]
    v_pk_mul_f32 v[148:149], v[132:133], v[148:149]
    v_pk_mul_f32 v[150:151], v[134:135], v[150:151]
    v_pk_mul_f32 v[152:153], v[136:137], v[152:153]
    v_pk_mul_f32 v[154:155], v[138:139], v[154:155]
    v_pk_mul_f32 v[156:157], v[140:141], v[156:157]
    v_pk_mul_f32 v[158:159], v[142:143], v[158:159]
    v_pk_mul_f32 v[128:129], v[128:129], v[24:25] op_sel_hi:[1,0]
    v_pk_mul_f32 v[130:131], v[130:131], v[24:25] op_sel_hi:[1,0]
    v_pk_mul_f32 v[132:133], v[132:133], v[24:25] op_sel_hi:[1,0]
    v_pk_mul_f32 v[134:135], v[134:135], v[24:25] op_sel_hi:[1,0]
    v_pk_mul_f32 v[136:137], v[136:137], v[24:25] op_sel_hi:[1,0]
    v_pk_mul_f32 v[138:139], v[138:139], v[24:25] op_sel_hi:[1,0]
    v_pk_mul_f32 v[140:141], v[140:141], v[24:25] op_sel_hi:[1,0]
    v_pk_mul_f32 v[142:143], v[142:143], v[24:25] op_sel_hi:[1,0]
    v_exp_f32 v128, v128
    v_exp_f32 v129, v129
    v_exp_f32 v130, v130
    v_exp_f32 v131, v131
    v_exp_f32 v132, v132
    v_exp_f32 v133, v133
    v_exp_f32 v134, v134
    v_exp_f32 v135, v135
    v_exp_f32 v136, v136
    v_exp_f32 v137, v137
    v_exp_f32 v138, v138
    v_exp_f32 v139, v139
    v_exp_f32 v140, v140
    v_exp_f32 v141, v141
    v_exp_f32 v142, v142
    v_exp_f32 v143, v143
    v_pk_fma_f32 v[128:129], v[128:129], v[24:25], v[24:25] op_sel:[0,1,1] op_sel_hi:[1,1,1]
    v_pk_fma_f32 v[130:131], v[130:131], v[24:25], v[24:25] op_sel:[0,1,1] op_sel_hi:[1,1,1]
    v_pk_fma_f32 v[132:133], v[132:133], v[24:25], v[24:25] op_sel:[0,1,1] op_sel_hi:[1,1,1]
    v_pk_fma_f32 v[134:135], v[134:135], v[24:25], v[24:25] op_sel:[0,1,1] op_sel_hi:[1,1,1]
    v_pk_fma_f32 v[136:137], v[136:137], v[24:25], v[24:25] op_sel:[0,1,1] op_sel_hi:[1,1,1]
    v_pk_fma_f32 v[138:139], v[138:139], v[24:25], v[24:25] op_sel:[0,1,1] op_sel_hi:[1,1,1]
    v_pk_fma_f32 v[140:141], v[140:141], v[24:25], v[24:25] op_sel:[0,1,1] op_sel_hi:[1,1,1]
    v_pk_fma_f32 v[142:143], v[142:143], v[24:25], v[24:25] op_sel:[0,1,1] op_sel_hi:[1,1,1]
    v_rcp_f32 v128, v128
    v_rcp_f32 v129, v129
    v_rcp_f32 v130, v130
    v_rcp_f32 v131, v131
    v_rcp_f32 v132, v132
    v_rcp_f32 v133, v133
    v_rcp_f32 v134, v134
    v_rcp_f32 v135, v135
    v_rcp_f32 v136, v136
    v_rcp_f32 v137, v137
    v_rcp_f32 v138, v138
    v_rcp_f32 v139, v139
    v_rcp_f32 v140, v140
    v_rcp_f32 v141, v141
    v_rcp_f32 v142, v142
    v_rcp_f32 v143, v143
    v_pk_mul_f32 v[144:145], v[144:145], v[128:129]
    v_pk_mul_f32 v[146:147], v[146:147], v[130:131]
    v_pk_mul_f32 v[148:149], v[148:149], v[132:133]
    v_pk_mul_f32 v[150:151], v[150:151], v[134:135]
    v_pk_mul_f32 v[152:153], v[152:153], v[136:137]
    v_pk_mul_f32 v[154:155], v[154:155], v[138:139]
    v_pk_mul_f32 v[156:157], v[156:157], v[140:141]
    v_pk_mul_f32 v[158:159], v[158:159], v[142:143]
    v_cvt_pk_bf16_f32 v128, v144, v145
    v_cvt_pk_bf16_f32 v129, v146, v147
    v_cvt_pk_bf16_f32 v130, v148, v149
    v_cvt_pk_bf16_f32 v131, v150, v151
    v_cvt_pk_bf16_f32 v132, v152, v153
    v_cvt_pk_bf16_f32 v133, v154, v155
    v_cvt_pk_bf16_f32 v134, v156, v157
    v_cvt_pk_bf16_f32 v135, v158, v159
    buffer_store_dwordx4 v[128:131], v6, s[28:31], s57 offen offset:0 sc1
    buffer_store_dwordx4 v[132:135], v6, s[28:31], s57 offen offset:2048 sc1
    v_pk_fma_f32 v[160:161], v[32:33], v[14:15], v[160:161] op_sel_hi:[1,0,1]
    v_pk_fma_f32 v[162:163], v[34:35], v[14:15], v[162:163] op_sel_hi:[1,0,1]
    v_pk_fma_f32 v[164:165], v[36:37], v[14:15], v[164:165] op_sel_hi:[1,0,1]
    v_pk_fma_f32 v[166:167], v[38:39], v[14:15], v[166:167] op_sel_hi:[1,0,1]
    v_pk_fma_f32 v[168:169], v[40:41], v[14:15], v[168:169] op_sel_hi:[1,0,1]
    v_pk_fma_f32 v[170:171], v[42:43], v[14:15], v[170:171] op_sel_hi:[1,0,1]
    v_pk_fma_f32 v[172:173], v[44:45], v[14:15], v[172:173] op_sel_hi:[1,0,1]
    v_pk_fma_f32 v[174:175], v[46:47], v[14:15], v[174:175] op_sel_hi:[1,0,1]
    v_pk_fma_f32 v[176:177], v[48:49], v[14:15], v[176:177] op_sel_hi:[1,0,1]
    v_pk_fma_f32 v[178:179], v[50:51], v[14:15], v[178:179] op_sel_hi:[1,0,1]
    v_pk_fma_f32 v[180:181], v[52:53], v[14:15], v[180:181] op_sel_hi:[1,0,1]
    v_pk_fma_f32 v[182:183], v[54:55], v[14:15], v[182:183] op_sel_hi:[1,0,1]
    v_pk_fma_f32 v[184:185], v[56:57], v[14:15], v[184:185] op_sel_hi:[1,0,1]
    v_pk_fma_f32 v[186:187], v[58:59], v[14:15], v[186:187] op_sel_hi:[1,0,1]
    v_pk_fma_f32 v[188:189], v[60:61], v[14:15], v[188:189] op_sel_hi:[1,0,1]
    v_pk_fma_f32 v[190:191], v[62:63], v[14:15], v[190:191] op_sel_hi:[1,0,1]
    v_pk_mul_f32 v[176:177], v[160:161], v[176:177]
    v_pk_mul_f32 v[178:179], v[162:163], v[178:179]
    v_pk_mul_f32 v[180:181], v[164:165], v[180:181]
    v_pk_mul_f32 v[182:183], v[166:167], v[182:183]
    v_pk_mul_f32 v[184:185], v[168:169], v[184:185]
    v_pk_mul_f32 v[186:187], v[170:171], v[186:187]
    v_pk_mul_f32 v[188:189], v[172:173], v[188:189]
    v_pk_mul_f32 v[190:191], v[174:175], v[190:191]
    v_pk_mul_f32 v[160:161], v[160:161], v[26:27] op_sel_hi:[1,0]
    v_pk_mul_f32 v[162:163], v[162:163], v[26:27] op_sel_hi:[1,0]
    v_pk_mul_f32 v[164:165], v[164:165], v[26:27] op_sel_hi:[1,0]
    v_pk_mul_f32 v[166:167], v[166:167], v[26:27] op_sel_hi:[1,0]
    v_pk_mul_f32 v[168:169], v[168:169], v[26:27] op_sel_hi:[1,0]
    v_pk_mul_f32 v[170:171], v[170:171], v[26:27] op_sel_hi:[1,0]
    v_pk_mul_f32 v[172:173], v[172:173], v[26:27] op_sel_hi:[1,0]
    v_pk_mul_f32 v[174:175], v[174:175], v[26:27] op_sel_hi:[1,0]
    v_exp_f32 v160, v160
    v_exp_f32 v161, v161
    v_exp_f32 v162, v162
    v_exp_f32 v163, v163
    v_exp_f32 v164, v164
    v_exp_f32 v165, v165
    v_exp_f32 v166, v166
    v_exp_f32 v167, v167
    v_exp_f32 v168, v168
    v_exp_f32 v169, v169
    v_exp_f32 v170, v170
    v_exp_f32 v171, v171
    v_exp_f32 v172, v172
    v_exp_f32 v173, v173
    v_exp_f32 v174, v174
    v_exp_f32 v175, v175
    v_pk_fma_f32 v[160:161], v[160:161], v[26:27], v[26:27] op_sel:[0,1,1] op_sel_hi:[1,1,1]
    v_pk_fma_f32 v[162:163], v[162:163], v[26:27], v[26:27] op_sel:[0,1,1] op_sel_hi:[1,1,1]
    v_pk_fma_f32 v[164:165], v[164:165], v[26:27], v[26:27] op_sel:[0,1,1] op_sel_hi:[1,1,1]
    v_pk_fma_f32 v[166:167], v[166:167], v[26:27], v[26:27] op_sel:[0,1,1] op_sel_hi:[1,1,1]
    v_pk_fma_f32 v[168:169], v[168:169], v[26:27], v[26:27] op_sel:[0,1,1] op_sel_hi:[1,1,1]
    v_pk_fma_f32 v[170:171], v[170:171], v[26:27], v[26:27] op_sel:[0,1,1] op_sel_hi:[1,1,1]
    v_pk_fma_f32 v[172:173], v[172:173], v[26:27], v[26:27] op_sel:[0,1,1] op_sel_hi:[1,1,1]
    v_pk_fma_f32 v[174:175], v[174:175], v[26:27], v[26:27] op_sel:[0,1,1] op_sel_hi:[1,1,1]
    v_rcp_f32 v160, v160
    v_rcp_f32 v161, v161
    v_rcp_f32 v162, v162
    v_rcp_f32 v163, v163
    v_rcp_f32 v164, v164
    v_rcp_f32 v165, v165
    v_rcp_f32 v166, v166
    v_rcp_f32 v167, v167
    v_rcp_f32 v168, v168
    v_rcp_f32 v169, v169
    v_rcp_f32 v170, v170
    v_rcp_f32 v171, v171
    v_rcp_f32 v172, v172
    v_rcp_f32 v173, v173
    v_rcp_f32 v174, v174
    v_rcp_f32 v175, v175
    v_pk_mul_f32 v[176:177], v[176:177], v[160:161]
    v_pk_mul_f32 v[178:179], v[178:179], v[162:163]
    v_pk_mul_f32 v[180:181], v[180:181], v[164:165]
    v_pk_mul_f32 v[182:183], v[182:183], v[166:167]
    v_pk_mul_f32 v[184:185], v[184:185], v[168:169]
    v_pk_mul_f32 v[186:187], v[186:187], v[170:171]
    v_pk_mul_f32 v[188:189], v[188:189], v[172:173]
    v_pk_mul_f32 v[190:191], v[190:191], v[174:175]
    v_cvt_pk_bf16_f32 v160, v176, v177
    v_cvt_pk_bf16_f32 v161, v178, v179
    v_cvt_pk_bf16_f32 v162, v180, v181
    v_cvt_pk_bf16_f32 v163, v182, v183
    v_cvt_pk_bf16_f32 v164, v184, v185
    v_cvt_pk_bf16_f32 v165, v186, v187
    v_cvt_pk_bf16_f32 v166, v188, v189
    v_cvt_pk_bf16_f32 v167, v190, v191
    buffer_store_dwordx4 v[160:163], v6, s[28:31], s57 offen offset:256 sc1
    buffer_store_dwordx4 v[164:167], v6, s[28:31], s57 offen offset:2304 sc1
    v_pk_fma_f32 v[192:193], v[32:33], v[16:17], v[192:193] op_sel_hi:[1,0,1]
    v_pk_fma_f32 v[194:195], v[34:35], v[16:17], v[194:195] op_sel_hi:[1,0,1]
    v_pk_fma_f32 v[196:197], v[36:37], v[16:17], v[196:197] op_sel_hi:[1,0,1]
    v_pk_fma_f32 v[198:199], v[38:39], v[16:17], v[198:199] op_sel_hi:[1,0,1]
    v_pk_fma_f32 v[200:201], v[40:41], v[16:17], v[200:201] op_sel_hi:[1,0,1]
    v_pk_fma_f32 v[202:203], v[42:43], v[16:17], v[202:203] op_sel_hi:[1,0,1]
    v_pk_fma_f32 v[204:205], v[44:45], v[16:17], v[204:205] op_sel_hi:[1,0,1]
    v_pk_fma_f32 v[206:207], v[46:47], v[16:17], v[206:207] op_sel_hi:[1,0,1]
    v_pk_fma_f32 v[208:209], v[48:49], v[16:17], v[208:209] op_sel_hi:[1,0,1]
    v_pk_fma_f32 v[210:211], v[50:51], v[16:17], v[210:211] op_sel_hi:[1,0,1]
    v_pk_fma_f32 v[212:213], v[52:53], v[16:17], v[212:213] op_sel_hi:[1,0,1]
    v_pk_fma_f32 v[214:215], v[54:55], v[16:17], v[214:215] op_sel_hi:[1,0,1]
    v_pk_fma_f32 v[216:217], v[56:57], v[16:17], v[216:217] op_sel_hi:[1,0,1]
    v_pk_fma_f32 v[218:219], v[58:59], v[16:17], v[218:219] op_sel_hi:[1,0,1]
    v_pk_fma_f32 v[220:221], v[60:61], v[16:17], v[220:221] op_sel_hi:[1,0,1]
    v_pk_fma_f32 v[222:223], v[62:63], v[16:17], v[222:223] op_sel_hi:[1,0,1]
    v_pk_mul_f32 v[208:209], v[192:193], v[208:209]
    v_pk_mul_f32 v[210:211], v[194:195], v[210:211]
    v_pk_mul_f32 v[212:213], v[196:197], v[212:213]
    v_pk_mul_f32 v[214:215], v[198:199], v[214:215]
    v_pk_mul_f32 v[216:217], v[200:201], v[216:217]
    v_pk_mul_f32 v[218:219], v[202:203], v[218:219]
    v_pk_mul_f32 v[220:221], v[204:205], v[220:221]
    v_pk_mul_f32 v[222:223], v[206:207], v[222:223]
    v_pk_mul_f32 v[192:193], v[192:193], v[28:29] op_sel_hi:[1,0]
    v_pk_mul_f32 v[194:195], v[194:195], v[28:29] op_sel_hi:[1,0]
    v_pk_mul_f32 v[196:197], v[196:197], v[28:29] op_sel_hi:[1,0]
    v_pk_mul_f32 v[198:199], v[198:199], v[28:29] op_sel_hi:[1,0]
    v_pk_mul_f32 v[200:201], v[200:201], v[28:29] op_sel_hi:[1,0]
    v_pk_mul_f32 v[202:203], v[202:203], v[28:29] op_sel_hi:[1,0]
    v_pk_mul_f32 v[204:205], v[204:205], v[28:29] op_sel_hi:[1,0]
    v_pk_mul_f32 v[206:207], v[206:207], v[28:29] op_sel_hi:[1,0]
    v_exp_f32 v192, v192
    v_exp_f32 v193, v193
    v_exp_f32 v194, v194
    v_exp_f32 v195, v195
    v_exp_f32 v196, v196
    v_exp_f32 v197, v197
    v_exp_f32 v198, v198
    v_exp_f32 v199, v199
    v_exp_f32 v200, v200
    v_exp_f32 v201, v201
    v_exp_f32 v202, v202
    v_exp_f32 v203, v203
    v_exp_f32 v204, v204
    v_exp_f32 v205, v205
    v_exp_f32 v206, v206
    v_exp_f32 v207, v207
    v_pk_fma_f32 v[192:193], v[192:193], v[28:29], v[28:29] op_sel:[0,1,1] op_sel_hi:[1,1,1]
    v_pk_fma_f32 v[194:195], v[194:195], v[28:29], v[28:29] op_sel:[0,1,1] op_sel_hi:[1,1,1]
    v_pk_fma_f32 v[196:197], v[196:197], v[28:29], v[28:29] op_sel:[0,1,1] op_sel_hi:[1,1,1]
    v_pk_fma_f32 v[198:199], v[198:199], v[28:29], v[28:29] op_sel:[0,1,1] op_sel_hi:[1,1,1]
    v_pk_fma_f32 v[200:201], v[200:201], v[28:29], v[28:29] op_sel:[0,1,1] op_sel_hi:[1,1,1]
    v_pk_fma_f32 v[202:203], v[202:203], v[28:29], v[28:29] op_sel:[0,1,1] op_sel_hi:[1,1,1]
    v_pk_fma_f32 v[204:205], v[204:205], v[28:29], v[28:29] op_sel:[0,1,1] op_sel_hi:[1,1,1]
    v_pk_fma_f32 v[206:207], v[206:207], v[28:29], v[28:29] op_sel:[0,1,1] op_sel_hi:[1,1,1]
    v_rcp_f32 v192, v192
    v_rcp_f32 v193, v193
    v_rcp_f32 v194, v194
    v_rcp_f32 v195, v195
    v_rcp_f32 v196, v196
    v_rcp_f32 v197, v197
    v_rcp_f32 v198, v198
    v_rcp_f32 v199, v199
    v_rcp_f32 v200, v200
    v_rcp_f32 v201, v201
    v_rcp_f32 v202, v202
    v_rcp_f32 v203, v203
    v_rcp_f32 v204, v204
    v_rcp_f32 v205, v205
    v_rcp_f32 v206, v206
    v_rcp_f32 v207, v207
    v_pk_mul_f32 v[208:209], v[208:209], v[192:193]
    v_pk_mul_f32 v[210:211], v[210:211], v[194:195]
    v_pk_mul_f32 v[212:213], v[212:213], v[196:197]
    v_pk_mul_f32 v[214:215], v[214:215], v[198:199]
    v_pk_mul_f32 v[216:217], v[216:217], v[200:201]
    v_pk_mul_f32 v[218:219], v[218:219], v[202:203]
    v_pk_mul_f32 v[220:221], v[220:221], v[204:205]
    v_pk_mul_f32 v[222:223], v[222:223], v[206:207]
    v_cvt_pk_bf16_f32 v192, v208, v209
    v_cvt_pk_bf16_f32 v193, v210, v211
    v_cvt_pk_bf16_f32 v194, v212, v213
    v_cvt_pk_bf16_f32 v195, v214, v215
    v_cvt_pk_bf16_f32 v196, v216, v217
    v_cvt_pk_bf16_f32 v197, v218, v219
    v_cvt_pk_bf16_f32 v198, v220, v221
    v_cvt_pk_bf16_f32 v199, v222, v223
    buffer_store_dwordx4 v[192:195], v6, s[28:31], s58 offen offset:0 sc1
    buffer_store_dwordx4 v[196:199], v6, s[28:31], s58 offen offset:2048 sc1
    v_pk_fma_f32 v[224:225], v[32:33], v[18:19], v[224:225] op_sel_hi:[1,0,1]
    v_pk_fma_f32 v[226:227], v[34:35], v[18:19], v[226:227] op_sel_hi:[1,0,1]
    v_pk_fma_f32 v[228:229], v[36:37], v[18:19], v[228:229] op_sel_hi:[1,0,1]
    v_pk_fma_f32 v[230:231], v[38:39], v[18:19], v[230:231] op_sel_hi:[1,0,1]
    v_pk_fma_f32 v[232:233], v[40:41], v[18:19], v[232:233] op_sel_hi:[1,0,1]
    v_pk_fma_f32 v[234:235], v[42:43], v[18:19], v[234:235] op_sel_hi:[1,0,1]
    v_pk_fma_f32 v[236:237], v[44:45], v[18:19], v[236:237] op_sel_hi:[1,0,1]
    v_pk_fma_f32 v[238:239], v[46:47], v[18:19], v[238:239] op_sel_hi:[1,0,1]
    v_pk_fma_f32 v[240:241], v[48:49], v[18:19], v[240:241] op_sel_hi:[1,0,1]
    v_pk_fma_f32 v[242:243], v[50:51], v[18:19], v[242:243] op_sel_hi:[1,0,1]
    v_pk_fma_f32 v[244:245], v[52:53], v[18:19], v[244:245] op_sel_hi:[1,0,1]
    v_pk_fma_f32 v[246:247], v[54:55], v[18:19], v[246:247] op_sel_hi:[1,0,1]
    v_pk_fma_f32 v[248:249], v[56:57], v[18:19], v[248:249] op_sel_hi:[1,0,1]
    v_pk_fma_f32 v[250:251], v[58:59], v[18:19], v[250:251] op_sel_hi:[1,0,1]
    v_pk_fma_f32 v[252:253], v[60:61], v[18:19], v[252:253] op_sel_hi:[1,0,1]
    v_pk_fma_f32 v[254:255], v[62:63], v[18:19], v[254:255] op_sel_hi:[1,0,1]
    v_pk_mul_f32 v[240:241], v[224:225], v[240:241]
    v_pk_mul_f32 v[242:243], v[226:227], v[242:243]
    v_pk_mul_f32 v[244:245], v[228:229], v[244:245]
    v_pk_mul_f32 v[246:247], v[230:231], v[246:247]
    v_pk_mul_f32 v[248:249], v[232:233], v[248:249]
    v_pk_mul_f32 v[250:251], v[234:235], v[250:251]
    v_pk_mul_f32 v[252:253], v[236:237], v[252:253]
    v_pk_mul_f32 v[254:255], v[238:239], v[254:255]
    v_pk_mul_f32 v[224:225], v[224:225], v[30:31] op_sel_hi:[1,0]
    v_pk_mul_f32 v[226:227], v[226:227], v[30:31] op_sel_hi:[1,0]
    v_pk_mul_f32 v[228:229], v[228:229], v[30:31] op_sel_hi:[1,0]
    v_pk_mul_f32 v[230:231], v[230:231], v[30:31] op_sel_hi:[1,0]
    v_pk_mul_f32 v[232:233], v[232:233], v[30:31] op_sel_hi:[1,0]
    v_pk_mul_f32 v[234:235], v[234:235], v[30:31] op_sel_hi:[1,0]
    v_pk_mul_f32 v[236:237], v[236:237], v[30:31] op_sel_hi:[1,0]
    v_pk_mul_f32 v[238:239], v[238:239], v[30:31] op_sel_hi:[1,0]
    v_exp_f32 v224, v224
    v_exp_f32 v225, v225
    v_exp_f32 v226, v226
    v_exp_f32 v227, v227
    v_exp_f32 v228, v228
    v_exp_f32 v229, v229
    v_exp_f32 v230, v230
    v_exp_f32 v231, v231
    v_exp_f32 v232, v232
    v_exp_f32 v233, v233
    v_exp_f32 v234, v234
    v_exp_f32 v235, v235
    v_exp_f32 v236, v236
    v_exp_f32 v237, v237
    v_exp_f32 v238, v238
    v_exp_f32 v239, v239
    v_pk_fma_f32 v[224:225], v[224:225], v[30:31], v[30:31] op_sel:[0,1,1] op_sel_hi:[1,1,1]
    v_pk_fma_f32 v[226:227], v[226:227], v[30:31], v[30:31] op_sel:[0,1,1] op_sel_hi:[1,1,1]
    v_pk_fma_f32 v[228:229], v[228:229], v[30:31], v[30:31] op_sel:[0,1,1] op_sel_hi:[1,1,1]
    v_pk_fma_f32 v[230:231], v[230:231], v[30:31], v[30:31] op_sel:[0,1,1] op_sel_hi:[1,1,1]
    v_pk_fma_f32 v[232:233], v[232:233], v[30:31], v[30:31] op_sel:[0,1,1] op_sel_hi:[1,1,1]
    v_pk_fma_f32 v[234:235], v[234:235], v[30:31], v[30:31] op_sel:[0,1,1] op_sel_hi:[1,1,1]
    v_pk_fma_f32 v[236:237], v[236:237], v[30:31], v[30:31] op_sel:[0,1,1] op_sel_hi:[1,1,1]
    v_pk_fma_f32 v[238:239], v[238:239], v[30:31], v[30:31] op_sel:[0,1,1] op_sel_hi:[1,1,1]
    v_rcp_f32 v224, v224
    v_rcp_f32 v225, v225
    v_rcp_f32 v226, v226
    v_rcp_f32 v227, v227
    v_rcp_f32 v228, v228
    v_rcp_f32 v229, v229
    v_rcp_f32 v230, v230
    v_rcp_f32 v231, v231
    v_rcp_f32 v232, v232
    v_rcp_f32 v233, v233
    v_rcp_f32 v234, v234
    v_rcp_f32 v235, v235
    v_rcp_f32 v236, v236
    v_rcp_f32 v237, v237
    v_rcp_f32 v238, v238
    v_rcp_f32 v239, v239
    v_pk_mul_f32 v[240:241], v[240:241], v[224:225]
    v_pk_mul_f32 v[242:243], v[242:243], v[226:227]
    v_pk_mul_f32 v[244:245], v[244:245], v[228:229]
    v_pk_mul_f32 v[246:247], v[246:247], v[230:231]
    v_pk_mul_f32 v[248:249], v[248:249], v[232:233]
    v_pk_mul_f32 v[250:251], v[250:251], v[234:235]
    v_pk_mul_f32 v[252:253], v[252:253], v[236:237]
    v_pk_mul_f32 v[254:255], v[254:255], v[238:239]
    v_cvt_pk_bf16_f32 v224, v240, v241
    v_cvt_pk_bf16_f32 v225, v242, v243
    v_cvt_pk_bf16_f32 v226, v244, v245
    v_cvt_pk_bf16_f32 v227, v246, v247
    v_cvt_pk_bf16_f32 v228, v248, v249
    v_cvt_pk_bf16_f32 v229, v250, v251
    v_cvt_pk_bf16_f32 v230, v252, v253
    v_cvt_pk_bf16_f32 v231, v254, v255
    buffer_store_dwordx4 v[224:227], v6, s[28:31], s58 offen offset:256 sc1
    buffer_store_dwordx4 v[228:231], v6, s[28:31], s58 offen offset:2304 sc1
L_ffn_next:
L_p3:
    s_setprio 0
    s_and_b32 s67, s48, 1
    s_lshr_b32 s63, s48, 1
    s_lshl1_add_u32 s66, s67, s73
    s_mul_i32 s52, s73, 43
    s_lshr_b32 s52, s52, 8
    s_add_u32 s54, s73, 3
    s_mul_i32 s54, s54, 43
    s_lshr_b32 s54, s54, 8
    s_sub_u32 s52, s54, s52
    s_lshl_b32 s52, s52, 6
    v_lshrrev_b32 v16, 5, v1
    v_mul_u32_u24 v16, s52, v16
    v_and_b32 v17, 31, v1
    v_min_u32 v17, 13, v17
    v_lshl_add_u32 v17, v17, 2, v16
    s_lshr_b32 s52, s73, 2
    s_mul_i32 s52, s52, 10
    s_add_u32 s52, s52, s74
    s_mul_i32 s52, s52, 4352
    v_add_u32 v17, s52, v17
    s_cmp_eq_u32 s68, 1
    s_movk_i32 s52, 192
    s_cselect_b32 s52, 176, s52
    s_mul_i32 s53, s49, s52
    s_add_u32 s52, s52, s53
    s_sub_u32 s52, s52, 1
    s_min_u32 s52, s52, 2047
    s_lshr_b32 s53, s53, 7
    s_lshr_b32 s52, s52, 7
    v_lshrrev_b32 v19, 4, v1
    v_add_u32 v19, s53, v19
    v_cmp_ge_u32 vcc, s52, v19
    v_and_b32 v20, 15, v1
    v_cmp_gt_u32 s[56:57], 10, v20
    v_mad_u32_u24 v18, v19, 10, v20
    v_mul_u32_u24 v18, 4352, v18
    s_and_b64 vcc, vcc, s[56:57]
    v_lshlrev_b32 v19, 2, v19
    s_cmp_eq_u32 s68, 1
    s_mov_b32 s52, 176128
    s_cselect_b32 s52, 190656, s52
    s_cselect_b32 s53, 5, 6
    v_mul_u32_u24 v19, s52, v19
    v_lshrrev_b32 v19, 20, v19
    v_sub_u32 v19, s49, v19
    v_lshlrev_b32 v19, s53, v19
    v_add_u32 v18, v18, v19
    v_mov_b32 v20, 0x40000000
    v_cndmask_b32 v18, v20, v18, vcc
    s_lshl_b32 s52, s68, 8
    s_lshl2_add_u32 s52, s50, s52
    s_add_u32 s69, s52, 0xe00000
    s_cmp_ge_u32 s50, 14
    s_cselect_b32 s69, 0x40000000, s69
    s_mov_b32 s52, 0
    s_mul_i32 s60, s52, 122880
    s_mul_i32 s61, s52, 6144
    v_lshrrev_b32 v7, 5, v1
    v_bfe_u32 v6, v1, 2, 2
    v_lshl_add_u32 v6, v7, 2, v6
    v_lshlrev_b32 v6, 7, v6
    v_bfe_u32 v7, v1, 3, 1
    v_lshl_add_u32 v6, v7, 6, v6
    v_bfe_u32 v7, v1, 4, 1
    v_lshl_add_u32 v6, v7, 5, v6
    v_and_b32 v7, 3, v1
    v_lshl_add_u32 v6, v7, 3, v6
    s_mul_i32 s52, s63, 77824
    v_add_u32 v4, s52, v6
    v_xor_b32 v5, 64, v4
    s_mul_i32 s54, s67, 16896
    s_add_u32 s52, s52, s54
    v_lshl_add_u32 v6, v1, 4, s52
    v_lshlrev_b32 v10, 4, v1
    v_add_u32 v11, 151552, v10
    s_mul_i32 s54, s66, 148
    s_add_u32 s54, s54, 4
    s_mul_i32 s52, s63, 54
    s_add_u32 s58, s54, s52
    s_lshl_b32 s58, s58, 10
    s_mul_i32 s52, s63, 20
    s_add_u32 s65, s54, s52
    s_add_u32 s65, s65, 108
    s_lshl_b32 s65, s65, 10
    s_lshl_b32 s52, s63, 6
    s_add_u32 s53, s52, 0x26c40
    v_mov_b32 v2, s53
    s_sub_u32 s53, 0x26c80, s52
    v_mov_b32 v3, s53
    v_mov_b32 v14, 0x26c00
    v_mov_b32 v15, 1
    s_lshl_b32 s52, s67, 2
    v_add_u32 v13, s52, v2
    s_waitcnt vmcnt(0)
    s_mov_b64 exec, 1
    ds_add_rtn_u32 v19, v14, v15
    s_waitcnt lgkmcnt(0)
    v_readfirstlane_b32 s54, v19
    s_nop 1
    s_cmp_lt_u32 s54, 3
    s_cbranch_scc1 L_n2_14
    s_mov_b64 exec, -1
    buffer_store_dword v15, v18, s[28:31], s69 offen sc1
    s_cmp_eq_u32 s68, 1
    s_cbranch_scc1 L_n2_14
    s_mov_b32 s52, 0xe00000
    s_mov_b32 s3, 0x40000
L_ssp_16:
    buffer_load_dword v16, v17, s[28:31], s52 offen sc1
    s_waitcnt vmcnt(0)
L_sck_17:
    v_cmp_gt_u32 vcc, 1, v16
    s_nop 1
    s_cmp_eq_u64 vcc, 0
    s_cbranch_scc1 L_sok_15
    s_sleep 1
    s_sub_u32 s3, s3, 1
    s_cbranch_scc0 L_ssp_16
L_sok_15:
    s_mov_b64 exec, 1
    ds_add_u32 v14, v15 offset:40
    s_mov_b64 exec, -1
L_n2_14:
    s_mov_b64 exec, -1
    s_cmp_ge_u32 s74, 10
    s_cbranch_scc1 L_done
    s_mov_b32 s100, 0x400000
L_cl_18:
    s_sleep 1
    ds_read_b32 v0, v14 offset:40
    s_sub_u32 s100, s100, 1
    s_cbranch_scc1 L_cx_19
    s_waitcnt lgkmcnt(0)
    v_readfirstlane_b32 s3, v0
    s_nop 1
    s_cmp_lt_u32 s3, 5
    s_cbranch_scc1 L_cl_18
L_cx_19:
    s_add_u32 s55, s58, s61
    s_add_u32 s61, s61, 0x1800
    s_cmp_ge_u32 s61, 0xd800
    s_cselect_b32 s61, 0, s61
    buffer_load_dwordx4 v[176:179], v10, s[28:31], s55 offen offset:0 sc1
    buffer_load_dwordx4 v[180:183], v11, s[28:31], s55 offen offset:0 sc1
    buffer_load_dwordx4 v[184:187], v10, s[28:31], s55 offen offset:1024 sc1
    buffer_load_dwordx4 v[188:191], v11, s[28:31], s55 offen offset:1024 sc1
    buffer_load_dwordx4 v[192:195], v10, s[28:31], s55 offen offset:2048 sc1
    buffer_load_dwordx4 v[196:199], v11, s[28:31], s55 offen offset:2048 sc1
    buffer_load_dwordx4 v[200:203], v10, s[28:31], s55 offen offset:3072 sc1
    buffer_load_dwordx4 v[204:207], v11, s[28:31], s55 offen offset:3072 sc1
    s_add_u32 s55, s55, 4096
    buffer_load_dwordx4 v[208:211], v10, s[28:31], s55 offen offset:0 sc1
    buffer_load_dwordx4 v[212:215], v11, s[28:31], s55 offen offset:0 sc1
    buffer_load_dwordx4 v[216:219], v10, s[28:31], s55 offen offset:1024 sc1
    buffer_load_dwordx4 v[220:223], v11, s[28:31], s55 offen offset:1024 sc1
    ds_read_b64_tr_b16 v[16:17], v4 offset:0
    ds_read_b64_tr_b16 v[18:19], v4 offset:2048
    ds_read_b64_tr_b16 v[20:21], v5 offset:0
    ds_read_b64_tr_b16 v[22:23], v5 offset:2048
    ds_read_b64_tr_b16 v[24:25], v4 offset:1024
    ds_read_b64_tr_b16 v[26:27], v4 offset:3072
    ds_read_b64_tr_b16 v[28:29], v5 offset:1024
    ds_read_b64_tr_b16 v[30:31], v5 offset:3072
    ds_read_b64_tr_b16 v[32:33], v4 offset:4096
    ds_read_b64_tr_b16 v[34:35], v4 offset:6144
    ds_read_b64_tr_b16 v[36:37], v5 offset:4096
    ds_read_b64_tr_b16 v[38:39], v5 offset:6144
    s_waitcnt vmcnt(10) lgkmcnt(8)
    v_mfma_f32_32x32x16_bf16 v[48:63], v[16:19], v[176:179], 0
    s_add_u32 s55, s58, s61
    s_add_u32 s61, s61, 0x1800
    s_cmp_ge_u32 s61, 0xd800
    s_cselect_b32 s61, 0, s61
    buffer_load_dwordx4 v[224:227], v10, s[28:31], s55 offen offset:0 sc1
    v_mfma_f32_32x32x16_bf16 v[64:79], v[20:23], v[176:179], 0
    ds_read_b64_tr_b16 v[40:41], v4 offset:5120
    ds_read_b64_tr_b16 v[42:43], v4 offset:7168
    v_mfma_f32_32x32x16_bf16 v[112:127], v[16:19], v[180:183], 0
    buffer_load_dwordx4 v[228:231], v11, s[28:31], s55 offen offset:0 sc1
    v_mfma_f32_32x32x16_bf16 v[128:143], v[20:23], v[180:183], 0
    ds_read_b64_tr_b16 v[44:45], v5 offset:5120
    ds_read_b64_tr_b16 v[46:47], v5 offset:7168
    s_waitcnt vmcnt(10) lgkmcnt(8)
    v_mfma_f32_32x32x16_bf16 v[48:63], v[24:27], v[184:187], v[48:63]
    buffer_load_dwordx4 v[232:235], v10, s[28:31], s55 offen offset:1024 sc1
    v_mfma_f32_32x32x16_bf16 v[64:79], v[28:31], v[184:187], v[64:79]
    ds_read_b64_tr_b16 v[16:17], v4 offset:8192
    ds_read_b64_tr_b16 v[18:19], v4 offset:10240
    v_mfma_f32_32x32x16_bf16 v[112:127], v[24:27], v[188:191], v[112:127]
    buffer_load_dwordx4 v[236:239], v11, s[28:31], s55 offen offset:1024 sc1
    v_mfma_f32_32x32x16_bf16 v[128:143], v[28:31], v[188:191], v[128:143]
    ds_read_b64_tr_b16 v[20:21], v5 offset:8192
    ds_read_b64_tr_b16 v[22:23], v5 offset:10240
    s_waitcnt vmcnt(10) lgkmcnt(8)
    v_mfma_f32_32x32x16_bf16 v[48:63], v[32:35], v[192:195], v[48:63]
    buffer_load_dwordx4 v[240:243], v10, s[28:31], s55 offen offset:2048 sc1
    ds_read_b64_tr_b16 v[24:25], v4 offset:9216
    v_mfma_f32_32x32x16_bf16 v[64:79], v[36:39], v[192:195], v[64:79]
    ds_read_b64_tr_b16 v[26:27], v4 offset:11264
    buffer_load_dwordx4 v[244:247], v11, s[28:31], s55 offen offset:2048 sc1
    v_mfma_f32_32x32x16_bf16 v[112:127], v[32:35], v[196:199], v[112:127]
    ds_read_b64_tr_b16 v[28:29], v5 offset:9216
    ds_read_b64_tr_b16 v[30:31], v5 offset:11264
    s_mov_b64 exec, 1
    ds_add_u32 v13, v15 offset:24
    s_mov_b64 exec, -1
    v_mfma_f32_32x32x16_bf16 v[128:143], v[36:39], v[196:199], v[128:143]
    s_waitcnt vmcnt(10) lgkmcnt(9)
    v_mfma_f32_32x32x16_bf16 v[48:63], v[40:43], v[200:203], v[48:63]
    buffer_load_dwordx4 v[248:251], v10, s[28:31], s55 offen offset:3072 sc1
    v_mfma_f32_32x32x16_bf16 v[64:79], v[44:47], v[200:203], v[64:79]
    ds_read_b64_tr_b16 v[32:33], v4 offset:12288
    ds_read_b64_tr_b16 v[34:35], v4 offset:14336
    v_mfma_f32_32x32x16_bf16 v[112:127], v[40:43], v[204:207], v[112:127]
    buffer_load_dwordx4 v[252:255], v11, s[28:31], s55 offen offset:3072 sc1
    v_mfma_f32_32x32x16_bf16 v[128:143], v[44:47], v[204:207], v[128:143]
    ds_read_b64_tr_b16 v[36:37], v5 offset:12288
    ds_read_b64_tr_b16 v[38:39], v5 offset:14336
    s_waitcnt vmcnt(10) lgkmcnt(9)
    v_mfma_f32_32x32x16_bf16 v[48:63], v[16:19], v[208:211], v[48:63]
    s_add_u32 s55, s55, 4096
    buffer_load_dwordx4 v[176:179], v10, s[28:31], s55 offen offset:0 sc1
    v_mfma_f32_32x32x16_bf16 v[64:79], v[20:23], v[208:211], v[64:79]
    ds_read_b64_tr_b16 v[40:41], v4 offset:13312
    ds_read_b64_tr_b16 v[42:43], v4 offset:15360
    v_mfma_f32_32x32x16_bf16 v[112:127], v[16:19], v[212:215], v[112:127]
    buffer_load_dwordx4 v[180:183], v11, s[28:31], s55 offen offset:0 sc1
    v_mfma_f32_32x32x16_bf16 v[128:143], v[20:23], v[212:215], v[128:143]
    ds_read_b64_tr_b16 v[44:45], v5 offset:13312
    ds_read_b64_tr_b16 v[46:47], v5 offset:15360
    s_waitcnt vmcnt(10) lgkmcnt(9)
    v_mfma_f32_32x32x16_bf16 v[48:63], v[24:27], v[216:219], v[48:63]
    buffer_load_dwordx4 v[184:187], v10, s[28:31], s55 offen offset:1024 sc1
    v_mfma_f32_32x32x16_bf16 v[64:79], v[28:31], v[216:219], v[64:79]
    ds_read_b64_tr_b16 v[16:17], v4 offset:16384
    ds_read_b64_tr_b16 v[18:19], v4 offset:18432
    v_mfma_f32_32x32x16_bf16 v[112:127], v[24:27], v[220:223], v[112:127]
    buffer_load_dwordx4 v[188:191], v11, s[28:31], s55 offen offset:1024 sc1
    v_mfma_f32_32x32x16_bf16 v[128:143], v[28:31], v[220:223], v[128:143]
    ds_read_b64_tr_b16 v[20:21], v5 offset:16384
    ds_read_b64_tr_b16 v[22:23], v5 offset:18432
    s_waitcnt vmcnt(10) lgkmcnt(8)
    v_mfma_f32_32x32x16_bf16 v[48:63], v[32:35], v[224:227], v[48:63]
    s_add_u32 s55, s58, s61
    s_add_u32 s61, s61, 0x1800
    s_cmp_ge_u32 s61, 0xd800
    s_cselect_b32 s61, 0, s61
    buffer_load_dwordx4 v[192:195], v10, s[28:31], s55 offen offset:0 sc1
    v_mfma_f32_32x32x16_bf16 v[64:79], v[36:39], v[224:227], v[64:79]
    ds_read_b64_tr_b16 v[24:25], v4 offset:17408
    ds_read_b64_tr_b16 v[26:27], v4 offset:19456
    v_mfma_f32_32x32x16_bf16 v[112:127], v[32:35], v[228:231], v[112:127]
    buffer_load_dwordx4 v[196:199], v11, s[28:31], s55 offen offset:0 sc1
    v_mfma_f32_32x32x16_bf16 v[128:143], v[36:39], v[228:231], v[128:143]
    ds_read_b64_tr_b16 v[28:29], v5 offset:17408
    ds_read_b64_tr_b16 v[30:31], v5 offset:19456
    s_waitcnt vmcnt(10) lgkmcnt(8)
    v_mfma_f32_32x32x16_bf16 v[48:63], v[40:43], v[232:235], v[48:63]
    buffer_load_dwordx4 v[200:203], v10, s[28:31], s55 offen offset:1024 sc1
    v_mfma_f32_32x32x16_bf16 v[64:79], v[44:47], v[232:235], v[64:79]
    ds_read_b64_tr_b16 v[32:33], v4 offset:20480
    ds_read_b64_tr_b16 v[34:35], v4 offset:22528
    v_mfma_f32_32x32x16_bf16 v[112:127], v[40:43], v[236:239], v[112:127]
    buffer_load_dwordx4 v[204:207], v11, s[28:31], s55 offen offset:1024 sc1
    v_mfma_f32_32x32x16_bf16 v[128:143], v[44:47], v[236:239], v[128:143]
    ds_read_b64_tr_b16 v[36:37], v5 offset:20480
    ds_read_b64_tr_b16 v[38:39], v5 offset:22528
    s_waitcnt vmcnt(10) lgkmcnt(8)
    v_mfma_f32_32x32x16_bf16 v[48:63], v[16:19], v[240:243], v[48:63]
    buffer_load_dwordx4 v[208:211], v10, s[28:31], s55 offen offset:2048 sc1
    ds_read_b64_tr_b16 v[40:41], v4 offset:21504
    v_mfma_f32_32x32x16_bf16 v[64:79], v[20:23], v[240:243], v[64:79]
    ds_read_b64_tr_b16 v[42:43], v4 offset:23552
    buffer_load_dwordx4 v[212:215], v11, s[28:31], s55 offen offset:2048 sc1
    v_mfma_f32_32x32x16_bf16 v[112:127], v[16:19], v[244:247], v[112:127]
    ds_read_b64_tr_b16 v[44:45], v5 offset:21504
    ds_read_b64_tr_b16 v[46:47], v5 offset:23552
    s_mov_b64 exec, 1
    ds_add_u32 v13, v15 offset:24
    s_mov_b64 exec, -1
    v_mfma_f32_32x32x16_bf16 v[128:143], v[20:23], v[244:247], v[128:143]
    s_waitcnt vmcnt(10) lgkmcnt(9)
    v_mfma_f32_32x32x16_bf16 v[48:63], v[24:27], v[248:251], v[48:63]
    buffer_load_dwordx4 v[216:219], v10, s[28:31], s55 offen offset:3072 sc1
    v_mfma_f32_32x32x16_bf16 v[64:79], v[28:31], v[248:251], v[64:79]
    ds_read_b64_tr_b16 v[16:17], v4 offset:24576
    ds_read_b64_tr_b16 v[18:19], v4 offset:26624
    v_mfma_f32_32x32x16_bf16 v[112:127], v[24:27], v[252:255], v[112:127]
    buffer_load_dwordx4 v[220:223], v11, s[28:31], s55 offen offset:3072 sc1
    v_mfma_f32_32x32x16_bf16 v[128:143], v[28:31], v[252:255], v[128:143]
    ds_read_b64_tr_b16 v[20:21], v5 offset:24576
    ds_read_b64_tr_b16 v[22:23], v5 offset:26624
    s_waitcnt vmcnt(10) lgkmcnt(9)
    v_mfma_f32_32x32x16_bf16 v[48:63], v[32:35], v[176:179], v[48:63]
    s_add_u32 s55, s55, 4096
    buffer_load_dwordx4 v[224:227], v10, s[28:31], s55 offen offset:0 sc1
    v_mfma_f32_32x32x16_bf16 v[64:79], v[36:39], v[176:179], v[64:79]
    ds_read_b64_tr_b16 v[24:25], v4 offset:25600
    ds_read_b64_tr_b16 v[26:27], v4 offset:27648
    v_mfma_f32_32x32x16_bf16 v[112:127], v[32:35], v[180:183], v[112:127]
    buffer_load_dwordx4 v[228:231], v11, s[28:31], s55 offen offset:0 sc1
    v_mfma_f32_32x32x16_bf16 v[128:143], v[36:39], v[180:183], v[128:143]
    ds_read_b64_tr_b16 v[28:29], v5 offset:25600
    ds_read_b64_tr_b16 v[30:31], v5 offset:27648
    s_waitcnt vmcnt(10) lgkmcnt(9)
    v_mfma_f32_32x32x16_bf16 v[48:63], v[40:43], v[184:187], v[48:63]
    buffer_load_dwordx4 v[232:235], v10, s[28:31], s55 offen offset:1024 sc1
    v_mfma_f32_32x32x16_bf16 v[64:79], v[44:47], v[184:187], v[64:79]
    ds_read_b64_tr_b16 v[32:33], v4 offset:28672
    ds_read_b64_tr_b16 v[34:35], v4 offset:30720
    v_mfma_f32_32x32x16_bf16 v[112:127], v[40:43], v[188:191], v[112:127]
    buffer_load_dwordx4 v[236:239], v11, s[28:31], s55 offen offset:1024 sc1
    v_mfma_f32_32x32x16_bf16 v[128:143], v[44:47], v[188:191], v[128:143]
    ds_read_b64_tr_b16 v[36:37], v5 offset:28672
    ds_read_b64_tr_b16 v[38:39], v5 offset:30720
    s_waitcnt vmcnt(10) lgkmcnt(8)
    v_mfma_f32_32x32x16_bf16 v[48:63], v[16:19], v[192:195], v[48:63]
    s_add_u32 s55, s58, s61
    s_add_u32 s61, s61, 0x1800
    s_cmp_ge_u32 s61, 0xd800
    s_cselect_b32 s61, 0, s61
    buffer_load_dwordx4 v[240:243], v10, s[28:31], s55 offen offset:0 sc1
    v_mfma_f32_32x32x16_bf16 v[64:79], v[20:23], v[192:195], v[64:79]
    ds_read_b64_tr_b16 v[40:41], v4 offset:29696
    ds_read_b64_tr_b16 v[42:43], v4 offset:31744
    v_mfma_f32_32x32x16_bf16 v[112:127], v[16:19], v[196:199], v[112:127]
    buffer_load_dwordx4 v[244:247], v11, s[28:31], s55 offen offset:0 sc1
    v_mfma_f32_32x32x16_bf16 v[128:143], v[20:23], v[196:199], v[128:143]
    ds_read_b64_tr_b16 v[44:45], v5 offset:29696
    ds_read_b64_tr_b16 v[46:47], v5 offset:31744
    s_waitcnt vmcnt(10) lgkmcnt(8)
    v_mfma_f32_32x32x16_bf16 v[48:63], v[24:27], v[200:203], v[48:63]
    buffer_load_dwordx4 v[248:251], v10, s[28:31], s55 offen offset:1024 sc1
    v_mfma_f32_32x32x16_bf16 v[64:79], v[28:31], v[200:203], v[64:79]
    ds_read_b64_tr_b16 v[16:17], v4 offset:32768
    ds_read_b64_tr_b16 v[18:19], v4 offset:34816
    v_mfma_f32_32x32x16_bf16 v[112:127], v[24:27], v[204:207], v[112:127]
    buffer_load_dwordx4 v[252:255], v11, s[28:31], s55 offen offset:1024 sc1
    v_mfma_f32_32x32x16_bf16 v[128:143], v[28:31], v[204:207], v[128:143]
    ds_read_b64_tr_b16 v[20:21], v5 offset:32768
    ds_read_b64_tr_b16 v[22:23], v5 offset:34816
    s_waitcnt vmcnt(10) lgkmcnt(8)
    v_mfma_f32_32x32x16_bf16 v[48:63], v[32:35], v[208:211], v[48:63]
    buffer_load_dwordx4 v[176:179], v10, s[28:31], s55 offen offset:2048 sc1
    ds_read_b64_tr_b16 v[24:25], v4 offset:33792
    v_mfma_f32_32x32x16_bf16 v[64:79], v[36:39], v[208:211], v[64:79]
    ds_read_b64_tr_b16 v[26:27], v4 offset:35840
    buffer_load_dwordx4 v[180:183], v11, s[28:31], s55 offen offset:2048 sc1
    v_mfma_f32_32x32x16_bf16 v[112:127], v[32:35], v[212:215], v[112:127]
    ds_read_b64_tr_b16 v[28:29], v5 offset:33792
    ds_read_b64_tr_b16 v[30:31], v5 offset:35840
    s_mov_b64 exec, 1
    ds_add_u32 v13, v15 offset:24
    s_mov_b64 exec, -1
    v_mfma_f32_32x32x16_bf16 v[128:143], v[36:39], v[212:215], v[128:143]
    s_waitcnt vmcnt(10) lgkmcnt(9)
    v_mfma_f32_32x32x16_bf16 v[48:63], v[40:43], v[216:219], v[48:63]
    buffer_load_dwordx4 v[184:187], v10, s[28:31], s55 offen offset:3072 sc1
    v_add_u32 v4, 36864, v4
    v_add_u32 v5, 36864, v5
    v_mfma_f32_32x32x16_bf16 v[64:79], v[44:47], v[216:219], v[64:79]
    ds_read_b64_tr_b16 v[32:33], v4 offset:0
    buffer_load_dwordx4 v[188:191], v11, s[28:31], s55 offen offset:3072 sc1
    v_mfma_f32_32x32x16_bf16 v[112:127], v[40:43], v[220:223], v[112:127]
    ds_read_b64_tr_b16 v[34:35], v4 offset:2048
    ds_read_b64_tr_b16 v[36:37], v5 offset:0
    v_mfma_f32_32x32x16_bf16 v[128:143], v[44:47], v[220:223], v[128:143]
    ds_read_b64_tr_b16 v[38:39], v5 offset:2048
    s_waitcnt vmcnt(10) lgkmcnt(9)
    v_mfma_f32_32x32x16_bf16 v[48:63], v[16:19], v[224:227], v[48:63]
    s_add_u32 s55, s55, 4096
    buffer_load_dwordx4 v[192:195], v10, s[28:31], s55 offen offset:0 sc1
    v_mfma_f32_32x32x16_bf16 v[64:79], v[20:23], v[224:227], v[64:79]
    ds_read_b64_tr_b16 v[40:41], v4 offset:1024
    ds_read_b64_tr_b16 v[42:43], v4 offset:3072
    v_mfma_f32_32x32x16_bf16 v[112:127], v[16:19], v[228:231], v[112:127]
    buffer_load_dwordx4 v[196:199], v11, s[28:31], s55 offen offset:0 sc1
    v_mfma_f32_32x32x16_bf16 v[128:143], v[20:23], v[228:231], v[128:143]
    ds_read_b64_tr_b16 v[44:45], v5 offset:1024
    ds_read_b64_tr_b16 v[46:47], v5 offset:3072
    s_waitcnt vmcnt(10) lgkmcnt(9)
    v_mfma_f32_32x32x16_bf16 v[48:63], v[24:27], v[232:235], v[48:63]
    buffer_load_dwordx4 v[200:203], v10, s[28:31], s55 offen offset:1024 sc1
    v_mfma_f32_32x32x16_bf16 v[64:79], v[28:31], v[232:235], v[64:79]
    ds_read_b64_tr_b16 v[16:17], v4 offset:4096
    ds_read_b64_tr_b16 v[18:19], v4 offset:6144
    v_mfma_f32_32x32x16_bf16 v[112:127], v[24:27], v[236:239], v[112:127]
    buffer_load_dwordx4 v[204:207], v11, s[28:31], s55 offen offset:1024 sc1
    v_mfma_f32_32x32x16_bf16 v[128:143], v[28:31], v[236:239], v[128:143]
    ds_read_b64_tr_b16 v[20:21], v5 offset:4096
    ds_read_b64_tr_b16 v[22:23], v5 offset:6144
    s_waitcnt vmcnt(10) lgkmcnt(8)
    v_mfma_f32_32x32x16_bf16 v[48:63], v[32:35], v[240:243], v[48:63]
    s_add_u32 s55, s58, s61
    s_add_u32 s61, s61, 0x1800
    s_cmp_ge_u32 s61, 0xd800
    s_cselect_b32 s61, 0, s61
    buffer_load_dwordx4 v[208:211], v10, s[28:31], s55 offen offset:0 sc1
    v_mfma_f32_32x32x16_bf16 v[64:79], v[36:39], v[240:243], v[64:79]
    ds_read_b64_tr_b16 v[24:25], v4 offset:5120
    ds_read_b64_tr_b16 v[26:27], v4 offset:7168
    v_mfma_f32_32x32x16_bf16 v[112:127], v[32:35], v[244:247], v[112:127]
    buffer_load_dwordx4 v[212:215], v11, s[28:31], s55 offen offset:0 sc1
    v_mfma_f32_32x32x16_bf16 v[128:143], v[36:39], v[244:247], v[128:143]
    ds_read_b64_tr_b16 v[28:29], v5 offset:5120
    ds_read_b64_tr_b16 v[30:31], v5 offset:7168
    s_waitcnt vmcnt(10) lgkmcnt(8)
    v_mfma_f32_32x32x16_bf16 v[48:63], v[40:43], v[248:251], v[48:63]
    buffer_load_dwordx4 v[216:219], v10, s[28:31], s55 offen offset:1024 sc1
    v_mfma_f32_32x32x16_bf16 v[64:79], v[44:47], v[248:251], v[64:79]
    ds_read_b64_tr_b16 v[32:33], v4 offset:8192
    ds_read_b64_tr_b16 v[34:35], v4 offset:10240
    v_mfma_f32_32x32x16_bf16 v[112:127], v[40:43], v[252:255], v[112:127]
    buffer_load_dwordx4 v[220:223], v11, s[28:31], s55 offen offset:1024 sc1
    v_mfma_f32_32x32x16_bf16 v[128:143], v[44:47], v[252:255], v[128:143]
    ds_read_b64_tr_b16 v[36:37], v5 offset:8192
    ds_read_b64_tr_b16 v[38:39], v5 offset:10240
    s_waitcnt vmcnt(10) lgkmcnt(8)
    v_mfma_f32_32x32x16_bf16 v[48:63], v[16:19], v[176:179], v[48:63]
    buffer_load_dwordx4 v[224:227], v10, s[28:31], s55 offen offset:2048 sc1
    ds_read_b64_tr_b16 v[40:41], v4 offset:9216
    v_mfma_f32_32x32x16_bf16 v[64:79], v[20:23], v[176:179], v[64:79]
    ds_read_b64_tr_b16 v[42:43], v4 offset:11264
    buffer_load_dwordx4 v[228:231], v11, s[28:31], s55 offen offset:2048 sc1
    v_mfma_f32_32x32x16_bf16 v[112:127], v[16:19], v[180:183], v[112:127]
    ds_read_b64_tr_b16 v[44:45], v5 offset:9216
    ds_read_b64_tr_b16 v[46:47], v5 offset:11264
    s_mov_b64 exec, 1
    ds_add_u32 v13, v15 offset:24
    s_mov_b64 exec, -1
    v_mfma_f32_32x32x16_bf16 v[128:143], v[20:23], v[180:183], v[128:143]
    s_waitcnt vmcnt(10) lgkmcnt(9)
    v_mfma_f32_32x32x16_bf16 v[48:63], v[24:27], v[184:187], v[48:63]
    buffer_load_dwordx4 v[232:235], v10, s[28:31], s55 offen offset:3072 sc1
    v_mfma_f32_32x32x16_bf16 v[64:79], v[28:31], v[184:187], v[64:79]
    ds_read_b64_tr_b16 v[16:17], v4 offset:12288
    ds_read_b64_tr_b16 v[18:19], v4 offset:14336
    v_mfma_f32_32x32x16_bf16 v[112:127], v[24:27], v[188:191], v[112:127]
    buffer_load_dwordx4 v[236:239], v11, s[28:31], s55 offen offset:3072 sc1
    v_mfma_f32_32x32x16_bf16 v[128:143], v[28:31], v[188:191], v[128:143]
    ds_read_b64_tr_b16 v[20:21], v5 offset:12288
    ds_read_b64_tr_b16 v[22:23], v5 offset:14336
    s_waitcnt vmcnt(10) lgkmcnt(9)
    v_mfma_f32_32x32x16_bf16 v[48:63], v[32:35], v[192:195], v[48:63]
    s_add_u32 s55, s55, 4096
    buffer_load_dwordx4 v[240:243], v10, s[28:31], s55 offen offset:0 sc1
    v_mfma_f32_32x32x16_bf16 v[64:79], v[36:39], v[192:195], v[64:79]
    ds_read_b64_tr_b16 v[24:25], v4 offset:13312
    ds_read_b64_tr_b16 v[26:27], v4 offset:15360
    v_mfma_f32_32x32x16_bf16 v[112:127], v[32:35], v[196:199], v[112:127]
    buffer_load_dwordx4 v[244:247], v11, s[28:31], s55 offen offset:0 sc1
    v_mfma_f32_32x32x16_bf16 v[128:143], v[36:39], v[196:199], v[128:143]
    ds_read_b64_tr_b16 v[28:29], v5 offset:13312
    ds_read_b64_tr_b16 v[30:31], v5 offset:15360
    s_waitcnt vmcnt(10) lgkmcnt(9)
    v_mfma_f32_32x32x16_bf16 v[48:63], v[40:43], v[200:203], v[48:63]
    buffer_load_dwordx4 v[248:251], v10, s[28:31], s55 offen offset:1024 sc1
    v_mfma_f32_32x32x16_bf16 v[64:79], v[44:47], v[200:203], v[64:79]
    ds_read_b64_tr_b16 v[32:33], v4 offset:16384
    ds_read_b64_tr_b16 v[34:35], v4 offset:18432
    v_mfma_f32_32x32x16_bf16 v[112:127], v[40:43], v[204:207], v[112:127]
    buffer_load_dwordx4 v[252:255], v11, s[28:31], s55 offen offset:1024 sc1
    v_mfma_f32_32x32x16_bf16 v[128:143], v[44:47], v[204:207], v[128:143]
    ds_read_b64_tr_b16 v[36:37], v5 offset:16384
    ds_read_b64_tr_b16 v[38:39], v5 offset:18432
    s_waitcnt vmcnt(10) lgkmcnt(8)
    v_mfma_f32_32x32x16_bf16 v[48:63], v[16:19], v[208:211], v[48:63]
    s_add_u32 s55, s58, s61
    s_add_u32 s61, s61, 0x1800
    s_cmp_ge_u32 s61, 0xd800
    s_cselect_b32 s61, 0, s61
    buffer_load_dwordx4 v[176:179], v10, s[28:31], s55 offen offset:0 sc1
    v_mfma_f32_32x32x16_bf16 v[64:79], v[20:23], v[208:211], v[64:79]
    ds_read_b64_tr_b16 v[40:41], v4 offset:17408
    ds_read_b64_tr_b16 v[42:43], v4 offset:19456
    v_mfma_f32_32x32x16_bf16 v[112:127], v[16:19], v[212:215], v[112:127]
    buffer_load_dwordx4 v[180:183], v11, s[28:31], s55 offen offset:0 sc1
    v_mfma_f32_32x32x16_bf16 v[128:143], v[20:23], v[212:215], v[128:143]
    ds_read_b64_tr_b16 v[44:45], v5 offset:17408
    ds_read_b64_tr_b16 v[46:47], v5 offset:19456
    s_waitcnt vmcnt(10) lgkmcnt(8)
    v_mfma_f32_32x32x16_bf16 v[48:63], v[24:27], v[216:219], v[48:63]
    buffer_load_dwordx4 v[184:187], v10, s[28:31], s55 offen offset:1024 sc1
    v_mfma_f32_32x32x16_bf16 v[64:79], v[28:31], v[216:219], v[64:79]
    ds_read_b64_tr_b16 v[16:17], v4 offset:20480
    ds_read_b64_tr_b16 v[18:19], v4 offset:22528
    v_mfma_f32_32x32x16_bf16 v[112:127], v[24:27], v[220:223], v[112:127]
    buffer_load_dwordx4 v[188:191], v11, s[28:31], s55 offen offset:1024 sc1
    v_mfma_f32_32x32x16_bf16 v[128:143], v[28:31], v[220:223], v[128:143]
    ds_read_b64_tr_b16 v[20:21], v5 offset:20480
    ds_read_b64_tr_b16 v[22:23], v5 offset:22528
    s_waitcnt vmcnt(10) lgkmcnt(8)
    v_mfma_f32_32x32x16_bf16 v[48:63], v[32:35], v[224:227], v[48:63]
    buffer_load_dwordx4 v[192:195], v10, s[28:31], s55 offen offset:2048 sc1
    ds_read_b64_tr_b16 v[24:25], v4 offset:21504
    v_mfma_f32_32x32x16_bf16 v[64:79], v[36:39], v[224:227], v[64:79]
    ds_read_b64_tr_b16 v[26:27], v4 offset:23552
    buffer_load_dwordx4 v[196:199], v11, s[28:31], s55 offen offset:2048 sc1
    v_mfma_f32_32x32x16_bf16 v[112:127], v[32:35], v[228:231], v[112:127]
    ds_read_b64_tr_b16 v[28:29], v5 offset:21504
    ds_read_b64_tr_b16 v[30:31], v5 offset:23552
    s_mov_b64 exec, 1
    ds_add_u32 v13, v15 offset:24
    s_mov_b64 exec, -1
    v_mfma_f32_32x32x16_bf16 v[128:143], v[36:39], v[228:231], v[128:143]
    s_waitcnt vmcnt(10) lgkmcnt(9)
    v_mfma_f32_32x32x16_bf16 v[48:63], v[40:43], v[232:235], v[48:63]
    buffer_load_dwordx4 v[200:203], v10, s[28:31], s55 offen offset:3072 sc1
    v_mfma_f32_32x32x16_bf16 v[64:79], v[44:47], v[232:235], v[64:79]
    ds_read_b64_tr_b16 v[32:33], v4 offset:24576
    ds_read_b64_tr_b16 v[34:35], v4 offset:26624
    v_mfma_f32_32x32x16_bf16 v[112:127], v[40:43], v[236:239], v[112:127]
    buffer_load_dwordx4 v[204:207], v11, s[28:31], s55 offen offset:3072 sc1
    v_mfma_f32_32x32x16_bf16 v[128:143], v[44:47], v[236:239], v[128:143]
    ds_read_b64_tr_b16 v[36:37], v5 offset:24576
    ds_read_b64_tr_b16 v[38:39], v5 offset:26624
    s_waitcnt vmcnt(10) lgkmcnt(9)
    v_mfma_f32_32x32x16_bf16 v[48:63], v[16:19], v[240:243], v[48:63]
    s_add_u32 s55, s55, 4096
    buffer_load_dwordx4 v[208:211], v10, s[28:31], s55 offen offset:0 sc1
    v_mfma_f32_32x32x16_bf16 v[64:79], v[20:23], v[240:243], v[64:79]
    ds_read_b64_tr_b16 v[40:41], v4 offset:25600
    ds_read_b64_tr_b16 v[42:43], v4 offset:27648
    v_mfma_f32_32x32x16_bf16 v[112:127], v[16:19], v[244:247], v[112:127]
    buffer_load_dwordx4 v[212:215], v11, s[28:31], s55 offen offset:0 sc1
    v_mfma_f32_32x32x16_bf16 v[128:143], v[20:23], v[244:247], v[128:143]
    ds_read_b64_tr_b16 v[44:45], v5 offset:25600
    ds_read_b64_tr_b16 v[46:47], v5 offset:27648
    s_waitcnt vmcnt(10) lgkmcnt(9)
    v_mfma_f32_32x32x16_bf16 v[48:63], v[24:27], v[248:251], v[48:63]
    buffer_load_dwordx4 v[216:219], v10, s[28:31], s55 offen offset:1024 sc1
    v_mfma_f32_32x32x16_bf16 v[64:79], v[28:31], v[248:251], v[64:79]
    ds_read_b64_tr_b16 v[16:17], v4 offset:28672
    ds_read_b64_tr_b16 v[18:19], v4 offset:30720
    v_mfma_f32_32x32x16_bf16 v[112:127], v[24:27], v[252:255], v[112:127]
    buffer_load_dwordx4 v[220:223], v11, s[28:31], s55 offen offset:1024 sc1
    v_mfma_f32_32x32x16_bf16 v[128:143], v[28:31], v[252:255], v[128:143]
    ds_read_b64_tr_b16 v[20:21], v5 offset:28672
    ds_read_b64_tr_b16 v[22:23], v5 offset:30720
    s_waitcnt vmcnt(10) lgkmcnt(8)
    v_mfma_f32_32x32x16_bf16 v[48:63], v[32:35], v[176:179], v[48:63]
    s_add_u32 s55, s58, s61
    s_add_u32 s61, s61, 0x1800
    s_cmp_ge_u32 s61, 0xd800
    s_cselect_b32 s61, 0, s61
    buffer_load_dwordx4 v[224:227], v10, s[28:31], s55 offen offset:0 sc1
    v_mfma_f32_32x32x16_bf16 v[64:79], v[36:39], v[176:179], v[64:79]
    ds_read_b64_tr_b16 v[24:25], v4 offset:29696
    ds_read_b64_tr_b16 v[26:27], v4 offset:31744
    v_mfma_f32_32x32x16_bf16 v[112:127], v[32:35], v[180:183], v[112:127]
    buffer_load_dwordx4 v[228:231], v11, s[28:31], s55 offen offset:0 sc1
    v_mfma_f32_32x32x16_bf16 v[128:143], v[36:39], v[180:183], v[128:143]
    ds_read_b64_tr_b16 v[28:29], v5 offset:29696
    ds_read_b64_tr_b16 v[30:31], v5 offset:31744
    s_waitcnt vmcnt(10) lgkmcnt(8)
    v_mfma_f32_32x32x16_bf16 v[48:63], v[40:43], v[184:187], v[48:63]
    buffer_load_dwordx4 v[232:235], v10, s[28:31], s55 offen offset:1024 sc1
    ds_read_b64_tr_b16 v[32:33], v4 offset:32768
    v_mfma_f32_32x32x16_bf16 v[64:79], v[44:47], v[184:187], v[64:79]
    ds_read_b64_tr_b16 v[34:35], v4 offset:34816
    buffer_load_dwordx4 v[236:239], v11, s[28:31], s55 offen offset:1024 sc1
    v_mfma_f32_32x32x16_bf16 v[112:127], v[40:43], v[188:191], v[112:127]
    ds_read_b64_tr_b16 v[36:37], v5 offset:32768
    ds_read_b64_tr_b16 v[38:39], v5 offset:34816
    v_mfma_f32_32x32x16_bf16 v[128:143], v[44:47], v[188:191], v[128:143]
    ds_read_b32 v0, v2 offset:8
    s_waitcnt vmcnt(10) lgkmcnt(9)
    v_mfma_f32_32x32x16_bf16 v[48:63], v[16:19], v[192:195], v[48:63]
    buffer_load_dwordx4 v[240:243], v10, s[28:31], s55 offen offset:2048 sc1
    ds_read_b64_tr_b16 v[40:41], v4 offset:33792
    v_mfma_f32_32x32x16_bf16 v[64:79], v[20:23], v[192:195], v[64:79]
    ds_read_b64_tr_b16 v[42:43], v4 offset:35840
    buffer_load_dwordx4 v[244:247], v11, s[28:31], s55 offen offset:2048 sc1
    v_mfma_f32_32x32x16_bf16 v[112:127], v[16:19], v[196:199], v[112:127]
    ds_read_b64_tr_b16 v[44:45], v5 offset:33792
    ds_read_b64_tr_b16 v[46:47], v5 offset:35840
    s_mov_b64 exec, 1
    ds_add_u32 v13, v15 offset:24
    s_mov_b64 exec, -1
    v_mfma_f32_32x32x16_bf16 v[128:143], v[20:23], v[196:199], v[128:143]
    s_waitcnt vmcnt(10) lgkmcnt(5)
    v_mfma_f32_32x32x16_bf16 v[48:63], v[24:27], v[200:203], v[48:63]
    v_readfirstlane_b32 s3, v0
    s_nop 0
    s_cmp_lt_u32 s3, 2
    s_cbranch_scc1 L_sl_20
L_bk_21:
    v_mfma_f32_32x32x16_bf16 v[64:79], v[28:31], v[200:203], v[64:79]
    buffer_load_dwordx4 v[248:251], v10, s[28:31], s55 offen offset:3072 sc1
    v_subrev_u32 v4, 36864, v4
    v_subrev_u32 v5, 36864, v5
    v_mfma_f32_32x32x16_bf16 v[112:127], v[24:27], v[204:207], v[112:127]
    ds_read_b64_tr_b16 v[16:17], v4 offset:0
    buffer_load_dwordx4 v[252:255], v11, s[28:31], s55 offen offset:3072 sc1
    v_mfma_f32_32x32x16_bf16 v[128:143], v[28:31], v[204:207], v[128:143]
    ds_read_b64_tr_b16 v[18:19], v4 offset:2048
    ds_read_b64_tr_b16 v[20:21], v5 offset:0
    ds_read_b64_tr_b16 v[22:23], v5 offset:2048
    s_waitcnt vmcnt(10) lgkmcnt(10)
    v_mfma_f32_32x32x16_bf16 v[48:63], v[32:35], v[208:211], v[48:63]
    s_add_u32 s55, s55, 4096
    buffer_load_dwordx4 v[176:179], v10, s[28:31], s55 offen offset:0 sc1
    v_mfma_f32_32x32x16_bf16 v[64:79], v[36:39], v[208:211], v[64:79]
    ds_read_b64_tr_b16 v[24:25], v4 offset:1024
    ds_read_b64_tr_b16 v[26:27], v4 offset:3072
    v_mfma_f32_32x32x16_bf16 v[112:127], v[32:35], v[212:215], v[112:127]
    buffer_load_dwordx4 v[180:183], v11, s[28:31], s55 offen offset:0 sc1
    v_mfma_f32_32x32x16_bf16 v[128:143], v[36:39], v[212:215], v[128:143]
    ds_read_b64_tr_b16 v[28:29], v5 offset:1024
    ds_read_b64_tr_b16 v[30:31], v5 offset:3072
    s_waitcnt vmcnt(10) lgkmcnt(9)
    v_mfma_f32_32x32x16_bf16 v[48:63], v[40:43], v[216:219], v[48:63]
    buffer_load_dwordx4 v[184:187], v10, s[28:31], s55 offen offset:1024 sc1
    v_mfma_f32_32x32x16_bf16 v[64:79], v[44:47], v[216:219], v[64:79]
    ds_read_b64_tr_b16 v[32:33], v4 offset:4096
    ds_read_b64_tr_b16 v[34:35], v4 offset:6144
    v_mfma_f32_32x32x16_bf16 v[112:127], v[40:43], v[220:223], v[112:127]
    buffer_load_dwordx4 v[188:191], v11, s[28:31], s55 offen offset:1024 sc1
    v_mfma_f32_32x32x16_bf16 v[128:143], v[44:47], v[220:223], v[128:143]
    ds_read_b64_tr_b16 v[36:37], v5 offset:4096
    ds_read_b64_tr_b16 v[38:39], v5 offset:6144
    s_waitcnt vmcnt(10) lgkmcnt(8)
    v_mfma_f32_32x32x16_bf16 v[48:63], v[16:19], v[224:227], v[48:63]
    s_add_u32 s55, s58, s61
    s_add_u32 s61, s61, 0x1800
    s_cmp_ge_u32 s61, 0xd800
    s_cselect_b32 s61, 0, s61
    buffer_load_dwordx4 v[192:195], v10, s[28:31], s55 offen offset:0 sc1
    v_mfma_f32_32x32x16_bf16 v[64:79], v[20:23], v[224:227], v[64:79]
    ds_read_b64_tr_b16 v[40:41], v4 offset:5120
    ds_read_b64_tr_b16 v[42:43], v4 offset:7168
    v_mfma_f32_32x32x16_bf16 v[112:127], v[16:19], v[228:231], v[112:127]
    buffer_load_dwordx4 v[196:199], v11, s[28:31], s55 offen offset:0 sc1
    v_mfma_f32_32x32x16_bf16 v[128:143], v[20:23], v[228:231], v[128:143]
    ds_read_b64_tr_b16 v[44:45], v5 offset:5120
    ds_read_b64_tr_b16 v[46:47], v5 offset:7168
    s_waitcnt vmcnt(10) lgkmcnt(8)
    v_mfma_f32_32x32x16_bf16 v[48:63], v[24:27], v[232:235], v[48:63]
    buffer_load_dwordx4 v[200:203], v10, s[28:31], s55 offen offset:1024 sc1
    v_mfma_f32_32x32x16_bf16 v[64:79], v[28:31], v[232:235], v[64:79]
    ds_read_b64_tr_b16 v[16:17], v4 offset:8192
    ds_read_b64_tr_b16 v[18:19], v4 offset:10240
    v_mfma_f32_32x32x16_bf16 v[112:127], v[24:27], v[236:239], v[112:127]
    buffer_load_dwordx4 v[204:207], v11, s[28:31], s55 offen offset:1024 sc1
    v_mfma_f32_32x32x16_bf16 v[128:143], v[28:31], v[236:239], v[128:143]
    ds_read_b64_tr_b16 v[20:21], v5 offset:8192
    ds_read_b64_tr_b16 v[22:23], v5 offset:10240
    s_waitcnt vmcnt(10) lgkmcnt(8)
    v_mfma_f32_32x32x16_bf16 v[48:63], v[32:35], v[240:243], v[48:63]
    buffer_load_dwordx4 v[208:211], v10, s[28:31], s55 offen offset:2048 sc1
    v_mfma_f32_32x32x16_bf16 v[64:79], v[36:39], v[240:243], v[64:79]
    ds_read_b64_tr_b16 v[24:25], v4 offset:9216
    ds_read_b64_tr_b16 v[26:27], v4 offset:11264
    v_mfma_f32_32x32x16_bf16 v[112:127], v[32:35], v[244:247], v[112:127]
    buffer_load_dwordx4 v[212:215], v11, s[28:31], s55 offen offset:2048 sc1
    v_mfma_f32_32x32x16_bf16 v[128:143], v[36:39], v[244:247], v[128:143]
    ds_read_b64_tr_b16 v[28:29], v5 offset:9216
    ds_read_b64_tr_b16 v[30:31], v5 offset:11264
    s_waitcnt vmcnt(10) lgkmcnt(8)
    v_mfma_f32_32x32x16_bf16 v[48:63], v[40:43], v[248:251], v[48:63]
    buffer_load_dwordx4 v[216:219], v10, s[28:31], s55 offen offset:3072 sc1
    v_mfma_f32_32x32x16_bf16 v[64:79], v[44:47], v[248:251], v[64:79]
    ds_read_b64_tr_b16 v[32:33], v4 offset:12288
    ds_read_b64_tr_b16 v[34:35], v4 offset:14336
    v_mfma_f32_32x32x16_bf16 v[112:127], v[40:43], v[252:255], v[112:127]
    buffer_load_dwordx4 v[220:223], v11, s[28:31], s55 offen offset:3072 sc1
    v_mfma_f32_32x32x16_bf16 v[128:143], v[44:47], v[252:255], v[128:143]
    ds_read_b64_tr_b16 v[36:37], v5 offset:12288
    ds_read_b64_tr_b16 v[38:39], v5 offset:14336
    s_waitcnt vmcnt(10) lgkmcnt(8)
    v_mfma_f32_32x32x16_bf16 v[48:63], v[16:19], v[176:179], v[48:63]
    s_add_u32 s55, s55, 4096
    buffer_load_dwordx4 v[224:227], v10, s[28:31], s55 offen offset:0 sc1
    v_mfma_f32_32x32x16_bf16 v[64:79], v[20:23], v[176:179], v[64:79]
    ds_read_b64_tr_b16 v[40:41], v4 offset:13312
    ds_read_b64_tr_b16 v[42:43], v4 offset:15360
    v_mfma_f32_32x32x16_bf16 v[112:127], v[16:19], v[180:183], v[112:127]
    buffer_load_dwordx4 v[228:231], v11, s[28:31], s55 offen offset:0 sc1
    v_mfma_f32_32x32x16_bf16 v[128:143], v[20:23], v[180:183], v[128:143]
    ds_read_b64_tr_b16 v[44:45], v5 offset:13312
    ds_read_b64_tr_b16 v[46:47], v5 offset:15360
    s_waitcnt vmcnt(10) lgkmcnt(8)
    v_mfma_f32_32x32x16_bf16 v[48:63], v[24:27], v[184:187], v[48:63]
    buffer_load_dwordx4 v[232:235], v10, s[28:31], s55 offen offset:1024 sc1
    v_mfma_f32_32x32x16_bf16 v[64:79], v[28:31], v[184:187], v[64:79]
    ds_read_b64_tr_b16 v[16:17], v4 offset:16384
    ds_read_b64_tr_b16 v[18:19], v4 offset:18432
    v_mfma_f32_32x32x16_bf16 v[112:127], v[24:27], v[188:191], v[112:127]
    buffer_load_dwordx4 v[236:239], v11, s[28:31], s55 offen offset:1024 sc1
    v_mfma_f32_32x32x16_bf16 v[128:143], v[28:31], v[188:191], v[128:143]
    ds_read_b64_tr_b16 v[20:21], v5 offset:16384
    ds_read_b64_tr_b16 v[22:23], v5 offset:18432
    s_waitcnt vmcnt(10) lgkmcnt(8)
    v_mfma_f32_32x32x16_bf16 v[48:63], v[32:35], v[192:195], v[48:63]
    s_add_u32 s55, s58, s61
    s_add_u32 s61, s61, 0x1800
    s_cmp_ge_u32 s61, 0xd800
    s_cselect_b32 s61, 0, s61
    buffer_load_dwordx4 v[240:243], v10, s[28:31], s55 offen offset:0 sc1
    v_mfma_f32_32x32x16_bf16 v[64:79], v[36:39], v[192:195], v[64:79]
    ds_read_b64_tr_b16 v[24:25], v4 offset:17408
    ds_read_b64_tr_b16 v[26:27], v4 offset:19456
    v_mfma_f32_32x32x16_bf16 v[112:127], v[32:35], v[196:199], v[112:127]
    buffer_load_dwordx4 v[244:247], v11, s[28:31], s55 offen offset:0 sc1
    v_mfma_f32_32x32x16_bf16 v[128:143], v[36:39], v[196:199], v[128:143]
    ds_read_b64_tr_b16 v[28:29], v5 offset:17408
    ds_read_b64_tr_b16 v[30:31], v5 offset:19456
    s_waitcnt vmcnt(10) lgkmcnt(8)
    v_mfma_f32_32x32x16_bf16 v[48:63], v[40:43], v[200:203], v[48:63]
    buffer_load_dwordx4 v[248:251], v10, s[28:31], s55 offen offset:1024 sc1
    v_mfma_f32_32x32x16_bf16 v[64:79], v[44:47], v[200:203], v[64:79]
    ds_read_b64_tr_b16 v[32:33], v4 offset:20480
    ds_read_b64_tr_b16 v[34:35], v4 offset:22528
    v_mfma_f32_32x32x16_bf16 v[112:127], v[40:43], v[204:207], v[112:127]
    buffer_load_dwordx4 v[252:255], v11, s[28:31], s55 offen offset:1024 sc1
    v_mfma_f32_32x32x16_bf16 v[128:143], v[44:47], v[204:207], v[128:143]
    ds_read_b64_tr_b16 v[36:37], v5 offset:20480
    ds_read_b64_tr_b16 v[38:39], v5 offset:22528
    s_waitcnt vmcnt(10) lgkmcnt(8)
    v_mfma_f32_32x32x16_bf16 v[48:63], v[16:19], v[208:211], v[48:63]
    buffer_load_dwordx4 v[176:179], v10, s[28:31], s55 offen offset:2048 sc1
    v_mfma_f32_32x32x16_bf16 v[64:79], v[20:23], v[208:211], v[64:79]
    ds_read_b64_tr_b16 v[40:41], v4 offset:21504
    ds_read_b64_tr_b16 v[42:43], v4 offset:23552
    v_mfma_f32_32x32x16_bf16 v[112:127], v[16:19], v[212:215], v[112:127]
    buffer_load_dwordx4 v[180:183], v11, s[28:31], s55 offen offset:2048 sc1
    v_mfma_f32_32x32x16_bf16 v[128:143], v[20:23], v[212:215], v[128:143]
    ds_read_b64_tr_b16 v[44:45], v5 offset:21504
    ds_read_b64_tr_b16 v[46:47], v5 offset:23552
    s_waitcnt vmcnt(10) lgkmcnt(8)
    v_mfma_f32_32x32x16_bf16 v[48:63], v[24:27], v[216:219], v[48:63]
    buffer_load_dwordx4 v[184:187], v10, s[28:31], s55 offen offset:3072 sc1
    v_mfma_f32_32x32x16_bf16 v[64:79], v[28:31], v[216:219], v[64:79]
    ds_read_b64_tr_b16 v[16:17], v4 offset:24576
    ds_read_b64_tr_b16 v[18:19], v4 offset:26624
    v_mfma_f32_32x32x16_bf16 v[112:127], v[24:27], v[220:223], v[112:127]
    buffer_load_dwordx4 v[188:191], v11, s[28:31], s55 offen offset:3072 sc1
    v_mfma_f32_32x32x16_bf16 v[128:143], v[28:31], v[220:223], v[128:143]
    ds_read_b64_tr_b16 v[20:21], v5 offset:24576
    ds_read_b64_tr_b16 v[22:23], v5 offset:26624
    s_waitcnt vmcnt(10) lgkmcnt(8)
    v_mfma_f32_32x32x16_bf16 v[48:63], v[32:35], v[224:227], v[48:63]
    s_add_u32 s55, s55, 4096
    buffer_load_dwordx4 v[192:195], v10, s[28:31], s55 offen offset:0 sc1
    ds_read_b64_tr_b16 v[24:25], v4 offset:25600
    v_mfma_f32_32x32x16_bf16 v[64:79], v[36:39], v[224:227], v[64:79]
    ds_read_b64_tr_b16 v[26:27], v4 offset:27648
    buffer_load_dwordx4 v[196:199], v11, s[28:31], s55 offen offset:0 sc1
    v_mfma_f32_32x32x16_bf16 v[112:127], v[32:35], v[228:231], v[112:127]
    ds_read_b64_tr_b16 v[28:29], v5 offset:25600
    ds_read_b64_tr_b16 v[30:31], v5 offset:27648
    v_mfma_f32_32x32x16_bf16 v[128:143], v[36:39], v[228:231], v[128:143]
    ds_read_b32 v0, v14 offset:32
    s_waitcnt vmcnt(10) lgkmcnt(9)
    v_mfma_f32_32x32x16_bf16 v[48:63], v[40:43], v[232:235], v[48:63]
    buffer_load_dwordx4 v[200:203], v10, s[28:31], s55 offen offset:1024 sc1
    v_mfma_f32_32x32x16_bf16 v[64:79], v[44:47], v[232:235], v[64:79]
    ds_read_b64_tr_b16 v[32:33], v4 offset:28672
    ds_read_b64_tr_b16 v[34:35], v4 offset:30720
    v_mfma_f32_32x32x16_bf16 v[112:127], v[40:43], v[236:239], v[112:127]
    buffer_load_dwordx4 v[204:207], v11, s[28:31], s55 offen offset:1024 sc1
    v_mfma_f32_32x32x16_bf16 v[128:143], v[44:47], v[236:239], v[128:143]
    ds_read_b64_tr_b16 v[36:37], v5 offset:28672
    ds_read_b64_tr_b16 v[38:39], v5 offset:30720
    s_waitcnt vmcnt(10) lgkmcnt(4)
    v_mfma_f32_32x32x16_bf16 v[48:63], v[16:19], v[240:243], v[48:63]
    v_readfirstlane_b32 s3, v0
    s_nop 0
    s_cmp_lt_u32 s3, 1
    s_cbranch_scc1 L_sl_22
L_bk_23:
    v_mfma_f32_32x32x16_bf16 v[64:79], v[20:23], v[240:243], v[64:79]
    s_add_u32 s55, s65, 0
    buffer_load_dwordx4 v[208:211], v10, s[28:31], s55 offen offset:0 sc1
    ds_read_b64_tr_b16 v[40:41], v4 offset:29696
    v_mfma_f32_32x32x16_bf16 v[112:127], v[16:19], v[244:247], v[112:127]
    ds_read_b64_tr_b16 v[42:43], v4 offset:31744
    buffer_load_dwordx4 v[212:215], v11, s[28:31], s55 offen offset:0 sc1
    v_mfma_f32_32x32x16_bf16 v[128:143], v[20:23], v[244:247], v[128:143]
    ds_read_b64_tr_b16 v[44:45], v5 offset:29696
    ds_read_b64_tr_b16 v[46:47], v5 offset:31744
    s_waitcnt vmcnt(10) lgkmcnt(9)
    v_mfma_f32_32x32x16_bf16 v[48:63], v[24:27], v[248:251], v[48:63]
    buffer_load_dwordx4 v[216:219], v10, s[28:31], s55 offen offset:1024 sc1
    ds_read_b64_tr_b16 v[16:17], v4 offset:32768
    v_mfma_f32_32x32x16_bf16 v[64:79], v[28:31], v[248:251], v[64:79]
    ds_read_b64_tr_b16 v[18:19], v4 offset:34816
    buffer_load_dwordx4 v[220:223], v11, s[28:31], s55 offen offset:1024 sc1
    v_mfma_f32_32x32x16_bf16 v[112:127], v[24:27], v[252:255], v[112:127]
    ds_read_b64_tr_b16 v[20:21], v5 offset:32768
    ds_read_b64_tr_b16 v[22:23], v5 offset:34816
    v_mfma_f32_32x32x16_bf16 v[128:143], v[28:31], v[252:255], v[128:143]
    ds_read_b32 v0, v2 offset:16
    s_waitcnt vmcnt(10) lgkmcnt(9)
    v_mfma_f32_32x32x16_bf16 v[48:63], v[32:35], v[176:179], v[48:63]
    buffer_load_dwordx4 v[224:227], v10, s[28:31], s55 offen offset:2048 sc1
    ds_read_b64_tr_b16 v[24:25], v4 offset:33792
    v_mfma_f32_32x32x16_bf16 v[64:79], v[36:39], v[176:179], v[64:79]
    ds_read_b64_tr_b16 v[26:27], v4 offset:35840
    buffer_load_dwordx4 v[228:231], v11, s[28:31], s55 offen offset:2048 sc1
    v_mfma_f32_32x32x16_bf16 v[112:127], v[32:35], v[180:183], v[112:127]
    ds_read_b64_tr_b16 v[28:29], v5 offset:33792
    ds_read_b64_tr_b16 v[30:31], v5 offset:35840
    s_mov_b64 exec, 1
    ds_add_u32 v2, v15 offset:20
    s_mov_b64 exec, -1
    v_mfma_f32_32x32x16_bf16 v[128:143], v[36:39], v[180:183], v[128:143]
    s_waitcnt vmcnt(10) lgkmcnt(5)
    v_mfma_f32_32x32x16_bf16 v[48:63], v[40:43], v[184:187], v[48:63]
    v_readfirstlane_b32 s3, v0
    s_nop 0
    s_cmp_lt_u32 s3, 2
    s_cbranch_scc1 L_sl_24
L_bk_25:
    v_mfma_f32_32x32x16_bf16 v[64:79], v[44:47], v[184:187], v[64:79]
    buffer_load_dwordx4 v[232:235], v10, s[28:31], s55 offen offset:3072 sc1
    v_add_u32 v4, 36864, v4
    v_add_u32 v5, 36864, v5
    v_mfma_f32_32x32x16_bf16 v[112:127], v[40:43], v[188:191], v[112:127]
    ds_read_b64_tr_b16 v[32:33], v4 offset:0
    buffer_load_dwordx4 v[236:239], v11, s[28:31], s55 offen offset:3072 sc1
    v_mfma_f32_32x32x16_bf16 v[128:143], v[44:47], v[188:191], v[128:143]
    ds_read_b64_tr_b16 v[34:35], v4 offset:1024
    ds_read_b64_tr_b16 v[36:37], v5 offset:0
    ds_read_b64_tr_b16 v[38:39], v5 offset:1024
    s_waitcnt vmcnt(10) lgkmcnt(10)
    v_mfma_f32_32x32x16_bf16 v[48:63], v[16:19], v[192:195], v[48:63]
    s_add_u32 s55, s65, 4096
    buffer_load_dwordx4 v[240:243], v10, s[28:31], s55 offen offset:0 sc1
    v_mfma_f32_32x32x16_bf16 v[64:79], v[20:23], v[192:195], v[64:79]
    ds_read_b64_tr_b16 v[40:41], v4 offset:2048
    ds_read_b64_tr_b16 v[42:43], v4 offset:3072
    v_mfma_f32_32x32x16_bf16 v[112:127], v[16:19], v[196:199], v[112:127]
    buffer_load_dwordx4 v[244:247], v11, s[28:31], s55 offen offset:0 sc1
    v_mfma_f32_32x32x16_bf16 v[128:143], v[20:23], v[196:199], v[128:143]
    ds_read_b64_tr_b16 v[44:45], v5 offset:2048
    ds_read_b64_tr_b16 v[46:47], v5 offset:3072
    s_waitcnt vmcnt(10) lgkmcnt(9)
    v_mfma_f32_32x32x16_bf16 v[48:63], v[24:27], v[200:203], v[48:63]
    buffer_load_dwordx4 v[248:251], v10, s[28:31], s55 offen offset:1024 sc1
    ds_read_b64_tr_b16 v[16:17], v4 offset:4096
    v_mfma_f32_32x32x16_bf16 v[64:79], v[28:31], v[200:203], v[64:79]
    ds_read_b64_tr_b16 v[18:19], v4 offset:5120
    buffer_load_dwordx4 v[252:255], v11, s[28:31], s55 offen offset:1024 sc1
    v_mfma_f32_32x32x16_bf16 v[112:127], v[24:27], v[204:207], v[112:127]
    ds_read_b64_tr_b16 v[20:21], v5 offset:4096
    ds_read_b64_tr_b16 v[22:23], v5 offset:5120
    v_mfma_f32_32x32x16_bf16 v[128:143], v[28:31], v[204:207], v[128:143]
    ds_read_b32 v0, v2 offset:20
    s_waitcnt vmcnt(10) lgkmcnt(9)
    v_mfma_f32_32x32x16_bf16 v[80:95], v[32:35], v[208:211], 0
    buffer_load_dwordx4 v[176:179], v10, s[28:31], s55 offen offset:2048 sc1
    v_mfma_f32_32x32x16_bf16 v[96:111], v[36:39], v[208:211], 0
    ds_read_b64_tr_b16 v[24:25], v4 offset:6144
    ds_read_b64_tr_b16 v[26:27], v4 offset:7168
    v_mfma_f32_32x32x16_bf16 v[144:159], v[32:35], v[212:215], 0
    buffer_load_dwordx4 v[180:183], v11, s[28:31], s55 offen offset:2048 sc1
    v_mfma_f32_32x32x16_bf16 v[160:175], v[36:39], v[212:215], 0
    ds_read_b64_tr_b16 v[28:29], v5 offset:6144
    ds_read_b64_tr_b16 v[30:31], v5 offset:7168
    s_waitcnt vmcnt(10) lgkmcnt(4)
    v_mfma_f32_32x32x16_bf16 v[80:95], v[40:43], v[216:219], v[80:95]
    v_readfirstlane_b32 s3, v0
    s_nop 0
    s_cmp_lt_u32 s3, 2
    s_cbranch_scc1 L_sl_26
L_bk_27:
    v_mfma_f32_32x32x16_bf16 v[96:111], v[44:47], v[216:219], v[96:111]
    buffer_load_dwordx4 v[184:187], v10, s[28:31], s55 offen offset:3072 sc1
    ds_read_b64_tr_b16 v[32:33], v4 offset:8192
    v_mfma_f32_32x32x16_bf16 v[144:159], v[40:43], v[220:223], v[144:159]
    ds_read_b64_tr_b16 v[34:35], v4 offset:9216
    buffer_load_dwordx4 v[188:191], v11, s[28:31], s55 offen offset:3072 sc1
    ds_write_b128 v6, v[112:115] offset:8448
    v_mfma_f32_32x32x16_bf16 v[160:175], v[44:47], v[220:223], v[160:175]
    ds_read_b64_tr_b16 v[36:37], v5 offset:8192
    ds_read_b64_tr_b16 v[38:39], v5 offset:9216
    s_waitcnt vmcnt(10) lgkmcnt(10)
    v_mfma_f32_32x32x16_bf16 v[80:95], v[16:19], v[224:227], v[80:95]
    s_add_u32 s55, s65, 8192
    buffer_load_dwordx4 v[192:195], v10, s[28:31], s55 offen offset:0 sc1
    ds_write_b128 v6, v[116:119] offset:9504
    v_mfma_f32_32x32x16_bf16 v[96:111], v[20:23], v[224:227], v[96:111]
    ds_read_b64_tr_b16 v[40:41], v4 offset:10240
    ds_read_b64_tr_b16 v[42:43], v4 offset:11264
    v_mfma_f32_32x32x16_bf16 v[144:159], v[16:19], v[228:231], v[144:159]
    buffer_load_dwordx4 v[196:199], v11, s[28:31], s55 offen offset:0 sc1
    ds_write_b128 v6, v[120:123] offset:10560
    v_mfma_f32_32x32x16_bf16 v[160:175], v[20:23], v[228:231], v[160:175]
    ds_read_b64_tr_b16 v[44:45], v5 offset:10240
    ds_read_b64_tr_b16 v[46:47], v5 offset:11264
    s_waitcnt vmcnt(10) lgkmcnt(11)
    v_mfma_f32_32x32x16_bf16 v[80:95], v[24:27], v[232:235], v[80:95]
    buffer_load_dwordx4 v[200:203], v10, s[28:31], s55 offen offset:1024 sc1
    ds_write_b128 v6, v[124:127] offset:11616
    v_mfma_f32_32x32x16_bf16 v[96:111], v[28:31], v[232:235], v[96:111]
    ds_read_b64_tr_b16 v[16:17], v4 offset:12288
    ds_read_b64_tr_b16 v[18:19], v4 offset:13312
    v_mfma_f32_32x32x16_bf16 v[144:159], v[24:27], v[236:239], v[144:159]
    buffer_load_dwordx4 v[204:207], v11, s[28:31], s55 offen offset:1024 sc1
    v_mfma_f32_32x32x16_bf16 v[160:175], v[28:31], v[236:239], v[160:175]
    ds_read_b64_tr_b16 v[20:21], v5 offset:12288
    ds_read_b64_tr_b16 v[22:23], v5 offset:13312
    ds_write_b128 v6, v[128:131] offset:12672
    s_waitcnt vmcnt(10) lgkmcnt(12)
    v_mfma_f32_32x32x16_bf16 v[80:95], v[32:35], v[240:243], v[80:95]
    buffer_load_dwordx4 v[208:211], v11, s[28:31], s55 offen offset:2048 sc1
    v_mfma_f32_32x32x16_bf16 v[96:111], v[36:39], v[240:243], v[96:111]
    ds_read_b64_tr_b16 v[24:25], v4 offset:14336
    ds_read_b64_tr_b16 v[26:27], v4 offset:15360
    ds_write_b128 v6, v[132:135] offset:13728
    v_mfma_f32_32x32x16_bf16 v[144:159], v[32:35], v[244:247], v[144:159]
    buffer_load_dwordx4 v[212:215], v11, s[28:31], s55 offen offset:3072 sc1
    v_mfma_f32_32x32x16_bf16 v[160:175], v[36:39], v[244:247], v[160:175]
    ds_read_b64_tr_b16 v[28:29], v5 offset:14336
    ds_read_b64_tr_b16 v[30:31], v5 offset:15360
    ds_write_b128 v6, v[136:139] offset:14784
    s_waitcnt vmcnt(10) lgkmcnt(12)
    v_mfma_f32_32x32x16_bf16 v[80:95], v[40:43], v[248:251], v[80:95]
    s_add_u32 s55, s65, 12288
    buffer_load_dwordx4 v[216:219], v11, s[28:31], s55 offen offset:0 sc1
    v_mfma_f32_32x32x16_bf16 v[96:111], v[44:47], v[248:251], v[96:111]
    ds_read_b64_tr_b16 v[32:33], v4 offset:16384
    ds_read_b64_tr_b16 v[34:35], v4 offset:17408
    ds_write_b128 v6, v[140:143] offset:15840
    s_mov_b64 exec, 1
    ds_add_u32 v14, v15 offset:56
    s_mov_b64 exec, -1
    v_mfma_f32_32x32x16_bf16 v[144:159], v[40:43], v[252:255], v[144:159]
    buffer_load_dwordx4 v[220:223], v11, s[28:31], s55 offen offset:1024 sc1
    v_mfma_f32_32x32x16_bf16 v[160:175], v[44:47], v[252:255], v[160:175]
    ds_read_b64_tr_b16 v[36:37], v5 offset:16384
    ds_read_b64_tr_b16 v[38:39], v5 offset:17408
    s_waitcnt vmcnt(10) lgkmcnt(13)
    v_mfma_f32_32x32x16_bf16 v[80:95], v[16:19], v[176:179], v[80:95]
    buffer_load_dwordx4 v[224:227], v11, s[28:31], s55 offen offset:2048 sc1
    ds_write_b128 v6, v[48:51] offset:0
    v_mfma_f32_32x32x16_bf16 v[96:111], v[20:23], v[176:179], v[96:111]
    ds_read_b64_tr_b16 v[40:41], v4 offset:18432
    ds_read_b64_tr_b16 v[42:43], v4 offset:19456
    v_mfma_f32_32x32x16_bf16 v[144:159], v[16:19], v[180:183], v[144:159]
    buffer_load_dwordx4 v[228:231], v11, s[28:31], s55 offen offset:3072 sc1
    ds_write_b128 v6, v[52:55] offset:1056
    v_mfma_f32_32x32x16_bf16 v[160:175], v[20:23], v[180:183], v[160:175]
    ds_read_b64_tr_b16 v[44:45], v5 offset:18432
    ds_read_b64_tr_b16 v[46:47], v5 offset:19456
    s_waitcnt vmcnt(10) lgkmcnt(13)
    v_mfma_f32_32x32x16_bf16 v[80:95], v[24:27], v[184:187], v[80:95]
    s_add_u32 s55, s65, 16384
    buffer_load_dwordx4 v[232:235], v11, s[28:31], s55 offen offset:0 sc1
    ds_write_b128 v6, v[56:59] offset:2112
    v_mfma_f32_32x32x16_bf16 v[96:111], v[28:31], v[184:187], v[96:111]
    ds_read_b64_tr_b16 v[16:17], v4 offset:20480
    ds_read_b64_tr_b16 v[18:19], v4 offset:21504
    v_mfma_f32_32x32x16_bf16 v[144:159], v[24:27], v[188:191], v[144:159]
    buffer_load_dwordx4 v[236:239], v11, s[28:31], s55 offen offset:1024 sc1
    ds_write_b128 v6, v[60:63] offset:3168
    v_mfma_f32_32x32x16_bf16 v[160:175], v[28:31], v[188:191], v[160:175]
    ds_read_b64_tr_b16 v[20:21], v5 offset:20480
    ds_read_b64_tr_b16 v[22:23], v5 offset:21504
    s_waitcnt vmcnt(10) lgkmcnt(12)
    v_mfma_f32_32x32x16_bf16 v[80:95], v[32:35], v[192:195], v[80:95]
    buffer_load_dwordx4 v[240:243], v11, s[28:31], s55 offen offset:2048 sc1
    ds_write_b128 v6, v[64:67] offset:4224
    v_mfma_f32_32x32x16_bf16 v[96:111], v[36:39], v[192:195], v[96:111]
    ds_read_b64_tr_b16 v[24:25], v4 offset:22528
    ds_read_b64_tr_b16 v[26:27], v4 offset:23552
    v_mfma_f32_32x32x16_bf16 v[144:159], v[32:35], v[196:199], v[144:159]
    buffer_load_dwordx4 v[244:247], v11, s[28:31], s55 offen offset:3072 sc1
    v_mfma_f32_32x32x16_bf16 v[160:175], v[36:39], v[196:199], v[160:175]
    ds_read_b64_tr_b16 v[28:29], v5 offset:22528
    ds_read_b64_tr_b16 v[30:31], v5 offset:23552
    ds_write_b128 v6, v[68:71] offset:5280
    s_waitcnt vmcnt(10) lgkmcnt(12)
    v_mfma_f32_32x32x16_bf16 v[80:95], v[40:43], v[200:203], v[80:95]
    s_add_u32 s55, s65, 8192
    buffer_load_dwordx4 v[248:251], v10, s[28:31], s55 offen offset:2048 sc1
    v_mfma_f32_32x32x16_bf16 v[96:111], v[44:47], v[200:203], v[96:111]
    ds_read_b64_tr_b16 v[32:33], v4 offset:24576
    ds_read_b64_tr_b16 v[34:35], v4 offset:25600
    ds_write_b128 v6, v[72:75] offset:6336
    v_mfma_f32_32x32x16_bf16 v[144:159], v[40:43], v[204:207], v[144:159]
    buffer_load_dwordx4 v[252:255], v10, s[28:31], s55 offen offset:3072 sc1
    v_mfma_f32_32x32x16_bf16 v[160:175], v[44:47], v[204:207], v[160:175]
    ds_read_b64_tr_b16 v[36:37], v5 offset:24576
    ds_read_b64_tr_b16 v[38:39], v5 offset:25600
    ds_write_b128 v6, v[76:79] offset:7392
    s_mov_b64 exec, 1
    ds_add_u32 v14, v15 offset:44
    s_mov_b64 exec, -1
    s_waitcnt vmcnt(11) lgkmcnt(13)
    v_mfma_f32_32x32x16_bf16 v[144:159], v[16:19], v[208:211], v[144:159]
    s_add_u32 s55, s65, 12288
    buffer_load_dwordx4 v[176:179], v10, s[28:31], s55 offen offset:0 sc1
    ds_read_b64_tr_b16 v[40:41], v4 offset:26624
    v_mfma_f32_32x32x16_bf16 v[160:175], v[20:23], v[208:211], v[160:175]
    ds_read_b64_tr_b16 v[42:43], v4 offset:27648
    ds_read_b64_tr_b16 v[44:45], v5 offset:26624
    ds_read_b64_tr_b16 v[46:47], v5 offset:27648
    s_waitcnt vmcnt(11) lgkmcnt(12)
    v_mfma_f32_32x32x16_bf16 v[144:159], v[24:27], v[212:215], v[144:159]
    buffer_load_dwordx4 v[180:183], v10, s[28:31], s55 offen offset:1024 sc1
    ds_read_b64_tr_b16 v[16:17], v4 offset:28672
    v_mfma_f32_32x32x16_bf16 v[160:175], v[28:31], v[212:215], v[160:175]
    ds_read_b64_tr_b16 v[18:19], v4 offset:29696
    ds_read_b64_tr_b16 v[20:21], v5 offset:28672
    ds_read_b64_tr_b16 v[22:23], v5 offset:29696
    s_waitcnt vmcnt(11) lgkmcnt(10)
    v_mfma_f32_32x32x16_bf16 v[144:159], v[32:35], v[216:219], v[144:159]
    buffer_load_dwordx4 v[184:187], v10, s[28:31], s55 offen offset:2048 sc1
    ds_read_b64_tr_b16 v[24:25], v4 offset:30720
    v_mfma_f32_32x32x16_bf16 v[160:175], v[36:39], v[216:219], v[160:175]
    ds_read_b64_tr_b16 v[26:27], v4 offset:31744
    ds_read_b64_tr_b16 v[28:29], v5 offset:30720
    ds_read_b64_tr_b16 v[30:31], v5 offset:31744
    s_waitcnt vmcnt(11) lgkmcnt(8)
    v_mfma_f32_32x32x16_bf16 v[144:159], v[40:43], v[220:223], v[144:159]
    buffer_load_dwordx4 v[188:191], v10, s[28:31], s55 offen offset:3072 sc1
    ds_read_b64_tr_b16 v[32:33], v4 offset:32768
    v_mfma_f32_32x32x16_bf16 v[160:175], v[44:47], v[220:223], v[160:175]
    ds_read_b64_tr_b16 v[34:35], v4 offset:33792
    ds_read_b64_tr_b16 v[36:37], v5 offset:32768
    ds_read_b64_tr_b16 v[38:39], v5 offset:33792
    s_waitcnt vmcnt(11) lgkmcnt(8)
    v_mfma_f32_32x32x16_bf16 v[144:159], v[16:19], v[224:227], v[144:159]
    s_add_u32 s55, s65, 16384
    buffer_load_dwordx4 v[192:195], v10, s[28:31], s55 offen offset:0 sc1
    ds_read_b64_tr_b16 v[40:41], v4 offset:34816
    v_mfma_f32_32x32x16_bf16 v[160:175], v[20:23], v[224:227], v[160:175]
    ds_read_b64_tr_b16 v[42:43], v4 offset:35840
    ds_read_b64_tr_b16 v[44:45], v5 offset:34816
    ds_read_b64_tr_b16 v[46:47], v5 offset:35840
    s_waitcnt vmcnt(11) lgkmcnt(8)
    v_mfma_f32_32x32x16_bf16 v[144:159], v[24:27], v[228:231], v[144:159]
    buffer_load_dwordx4 v[196:199], v10, s[28:31], s55 offen offset:1024 sc1
    ds_read_b64_tr_b16 v[16:17], v4 offset:36864
    v_mfma_f32_32x32x16_bf16 v[160:175], v[28:31], v[228:231], v[160:175]
    ds_read_b64_tr_b16 v[18:19], v4 offset:37888
    ds_read_b64_tr_b16 v[20:21], v5 offset:36864
    ds_read_b64_tr_b16 v[22:23], v5 offset:37888
    s_waitcnt vmcnt(11) lgkmcnt(8)
    v_mfma_f32_32x32x16_bf16 v[144:159], v[32:35], v[232:235], v[144:159]
    buffer_load_dwordx4 v[200:203], v10, s[28:31], s55 offen offset:2048 sc1
    ds_read_b64_tr_b16 v[24:25], v4 offset:38912
    v_mfma_f32_32x32x16_bf16 v[160:175], v[36:39], v[232:235], v[160:175]
    ds_read_b64_tr_b16 v[26:27], v4 offset:39936
    ds_read_b64_tr_b16 v[28:29], v5 offset:38912
    ds_read_b64_tr_b16 v[30:31], v5 offset:39936
    s_waitcnt vmcnt(11) lgkmcnt(8)
    v_mfma_f32_32x32x16_bf16 v[144:159], v[40:43], v[236:239], v[144:159]
    buffer_load_dwordx4 v[204:207], v10, s[28:31], s55 offen offset:3072 sc1
    ds_read_b64_tr_b16 v[32:33], v4 offset:20480
    v_mfma_f32_32x32x16_bf16 v[160:175], v[44:47], v[236:239], v[160:175]
    ds_read_b64_tr_b16 v[34:35], v4 offset:21504
    ds_read_b64_tr_b16 v[36:37], v5 offset:20480
    ds_read_b64_tr_b16 v[38:39], v5 offset:21504
    s_waitcnt vmcnt(11) lgkmcnt(8)
    v_mfma_f32_32x32x16_bf16 v[144:159], v[16:19], v[240:243], v[144:159]
    ds_read_b64_tr_b16 v[40:41], v4 offset:22528
    ds_read_b64_tr_b16 v[42:43], v4 offset:23552
    v_mfma_f32_32x32x16_bf16 v[160:175], v[20:23], v[240:243], v[160:175]
    ds_read_b64_tr_b16 v[44:45], v5 offset:22528
    ds_read_b64_tr_b16 v[46:47], v5 offset:23552
    s_waitcnt vmcnt(10) lgkmcnt(8)
    v_mfma_f32_32x32x16_bf16 v[144:159], v[24:27], v[244:247], v[144:159]
    ds_read_b64_tr_b16 v[16:17], v4 offset:24576
    ds_read_b64_tr_b16 v[18:19], v4 offset:25600
    ds_read_b64_tr_b16 v[20:21], v5 offset:24576
    v_mfma_f32_32x32x16_bf16 v[160:175], v[28:31], v[244:247], v[160:175]
    ds_read_b64_tr_b16 v[22:23], v5 offset:25600
    ds_read_b32 v0, v14 offset:60
    s_waitcnt vmcnt(9) lgkmcnt(9)
    v_mfma_f32_32x32x16_bf16 v[80:95], v[32:35], v[248:251], v[80:95]
    ds_read_b64_tr_b16 v[24:25], v4 offset:26624
    ds_read_b64_tr_b16 v[26:27], v4 offset:27648
    v_mfma_f32_32x32x16_bf16 v[96:111], v[36:39], v[248:251], v[96:111]
    ds_read_b64_tr_b16 v[28:29], v5 offset:26624
    ds_read_b64_tr_b16 v[30:31], v5 offset:27648
    s_waitcnt vmcnt(8) lgkmcnt(4)
    v_mfma_f32_32x32x16_bf16 v[80:95], v[40:43], v[252:255], v[80:95]
    v_readfirstlane_b32 s3, v0
    s_nop 0
    s_cmp_lt_u32 s3, 4
    s_cbranch_scc1 L_sl_28
L_bk_29:
    ds_read_b64_tr_b16 v[32:33], v4 offset:28672
    v_mfma_f32_32x32x16_bf16 v[96:111], v[44:47], v[252:255], v[96:111]
    ds_read_b64_tr_b16 v[34:35], v4 offset:29696
    ds_read_b64_tr_b16 v[36:37], v5 offset:28672
    ds_read_b64_tr_b16 v[38:39], v5 offset:29696
    ds_write_b128 v6, v[144:147] offset:8448
    s_waitcnt vmcnt(7) lgkmcnt(10)
    v_mfma_f32_32x32x16_bf16 v[80:95], v[16:19], v[176:179], v[80:95]
    ds_read_b64_tr_b16 v[40:41], v4 offset:30720
    ds_read_b64_tr_b16 v[42:43], v4 offset:31744
    v_mfma_f32_32x32x16_bf16 v[96:111], v[20:23], v[176:179], v[96:111]
    ds_read_b64_tr_b16 v[44:45], v5 offset:30720
    ds_read_b64_tr_b16 v[46:47], v5 offset:31744
    ds_write_b128 v6, v[148:151] offset:9504
    s_waitcnt vmcnt(6) lgkmcnt(10)
    v_mfma_f32_32x32x16_bf16 v[80:95], v[24:27], v[180:183], v[80:95]
    ds_read_b64_tr_b16 v[16:17], v4 offset:32768
    ds_read_b64_tr_b16 v[18:19], v4 offset:33792
    v_mfma_f32_32x32x16_bf16 v[96:111], v[28:31], v[180:183], v[96:111]
    ds_read_b64_tr_b16 v[20:21], v5 offset:32768
    ds_read_b64_tr_b16 v[22:23], v5 offset:33792
    ds_write_b128 v6, v[152:155] offset:10560
    s_waitcnt vmcnt(5) lgkmcnt(11)
    v_mfma_f32_32x32x16_bf16 v[80:95], v[32:35], v[184:187], v[80:95]
    ds_read_b64_tr_b16 v[24:25], v4 offset:34816
    ds_read_b64_tr_b16 v[26:27], v4 offset:35840
    v_mfma_f32_32x32x16_bf16 v[96:111], v[36:39], v[184:187], v[96:111]
    ds_read_b64_tr_b16 v[28:29], v5 offset:34816
    ds_read_b64_tr_b16 v[30:31], v5 offset:35840
    ds_write_b128 v6, v[156:159] offset:11616
    s_waitcnt vmcnt(4) lgkmcnt(11)
    v_mfma_f32_32x32x16_bf16 v[80:95], v[40:43], v[188:191], v[80:95]
    ds_read_b64_tr_b16 v[32:33], v4 offset:36864
    ds_read_b64_tr_b16 v[34:35], v4 offset:37888
    v_mfma_f32_32x32x16_bf16 v[96:111], v[44:47], v[188:191], v[96:111]
    ds_read_b64_tr_b16 v[36:37], v5 offset:36864
    ds_read_b64_tr_b16 v[38:39], v5 offset:37888
    ds_write_b128 v6, v[160:163] offset:12672
    s_waitcnt vmcnt(3) lgkmcnt(11)
    v_mfma_f32_32x32x16_bf16 v[80:95], v[16:19], v[192:195], v[80:95]
    ds_read_b64_tr_b16 v[40:41], v4 offset:38912
    ds_read_b64_tr_b16 v[42:43], v4 offset:39936
    v_mfma_f32_32x32x16_bf16 v[96:111], v[20:23], v[192:195], v[96:111]
    ds_read_b64_tr_b16 v[44:45], v5 offset:38912
    ds_read_b64_tr_b16 v[46:47], v5 offset:39936
    ds_write_b128 v6, v[164:167] offset:13728
    s_waitcnt vmcnt(2) lgkmcnt(11)
    v_mfma_f32_32x32x16_bf16 v[80:95], v[24:27], v[196:199], v[80:95]
    ds_read_b32 v0, v14 offset:36
    v_mfma_f32_32x32x16_bf16 v[96:111], v[28:31], v[196:199], v[96:111]
    ds_write_b128 v6, v[168:171] offset:14784
    s_waitcnt vmcnt(1) lgkmcnt(8)
    v_mfma_f32_32x32x16_bf16 v[80:95], v[32:35], v[200:203], v[80:95]
    v_mfma_f32_32x32x16_bf16 v[96:111], v[36:39], v[200:203], v[96:111]
    ds_write_b128 v6, v[172:175] offset:15840
    s_mov_b64 exec, 1
    ds_add_u32 v14, v15 offset:52
    s_mov_b64 exec, -1
    s_waitcnt vmcnt(0) lgkmcnt(3)
    v_mfma_f32_32x32x16_bf16 v[80:95], v[40:43], v[204:207], v[80:95]
    v_readfirstlane_b32 s3, v0
    s_nop 0
    s_cmp_lt_u32 s3, 4
    s_cbranch_scc1 L_sl_30
L_bk_31:
    v_mfma_f32_32x32x16_bf16 v[96:111], v[44:47], v[204:207], v[96:111]
    s_nop 7
    s_nop 3
    ds_write_b128 v6, v[80:83] offset:0
    ds_write_b128 v6, v[84:87] offset:1056
    ds_write_b128 v6, v[88:91] offset:2112
    ds_write_b128 v6, v[92:95] offset:3168
    ds_write_b128 v6, v[96:99] offset:4224
    ds_write_b128 v6, v[100:103] offset:5280
    ds_write_b128 v6, v[104:107] offset:6336
    ds_write_b128 v6, v[108:111] offset:7392
    s_mov_b64 exec, 1
    ds_add_u32 v14, v15 offset:48
    s_mov_b64 exec, -1
L_done:
    s_endpgm
L_sl_20:
    s_mov_b32 s100, 0x400000
L_cl_32:
    ds_read_b32 v0, v2 offset:8
    s_sub_u32 s100, s100, 1
    s_cbranch_scc1 L_cx_33
    s_waitcnt lgkmcnt(0)
    v_readfirstlane_b32 s3, v0
    s_nop 1
    s_cmp_lt_u32 s3, 2
    s_cbranch_scc1 L_cl_32
L_cx_33:
    s_branch L_bk_21
L_sl_22:
    s_mov_b32 s100, 0x400000
L_cl_34:
    ds_read_b32 v0, v14 offset:32
    s_sub_u32 s100, s100, 1
    s_cbranch_scc1 L_cx_35
    s_waitcnt lgkmcnt(0)
    v_readfirstlane_b32 s3, v0
    s_nop 1
    s_cmp_lt_u32 s3, 1
    s_cbranch_scc1 L_cl_34
L_cx_35:
    s_branch L_bk_23
L_sl_24:
    s_mov_b32 s100, 0x400000
L_cl_36:
    ds_read_b32 v0, v2 offset:16
    s_sub_u32 s100, s100, 1
    s_cbranch_scc1 L_cx_37
    s_waitcnt lgkmcnt(0)
    v_readfirstlane_b32 s3, v0
    s_nop 1
    s_cmp_lt_u32 s3, 2
    s_cbranch_scc1 L_cl_36
L_cx_37:
    s_branch L_bk_25
L_sl_26:
    s_mov_b32 s100, 0x400000
L_cl_38:
    ds_read_b32 v0, v2 offset:20
    s_sub_u32 s100, s100, 1
    s_cbranch_scc1 L_cx_39
    s_waitcnt lgkmcnt(0)
    v_readfirstlane_b32 s3, v0
    s_nop 1
    s_cmp_lt_u32 s3, 2
    s_cbranch_scc1 L_cl_38
L_cx_39:
    s_branch L_bk_27
L_sl_28:
    s_mov_b32 s100, 0x400000
L_cl_40:
    ds_read_b32 v0, v14 offset:60
    s_sub_u32 s100, s100, 1
    s_cbranch_scc1 L_cx_41
    s_waitcnt lgkmcnt(0)
    v_readfirstlane_b32 s3, v0
    s_nop 1
    s_cmp_lt_u32 s3, 4
    s_cbranch_scc1 L_cl_40
L_cx_41:
    s_branch L_bk_29
L_sl_30:
    s_mov_b32 s100, 0x400000
L_cl_42:
    ds_read_b32 v0, v14 offset:36
    s_sub_u32 s100, s100, 1
    s_cbranch_scc1 L_cx_43
    s_waitcnt lgkmcnt(0)
    v_readfirstlane_b32 s3, v0
    s_nop 1
    s_cmp_lt_u32 s3, 4
    s_cbranch_scc1 L_cl_42
L_cx_43:
    s_branch L_bk_31
L_aux:
    s_mul_i32 s52, s63, 77824
    s_mul_i32 s53, s71, 6144
    s_add_u32 s53, s53, s52
    v_lshl_add_u32 v12, v1, 4, s53
    s_mul_i32 s53, s71, 1024
    s_add_u32 s53, s53, s52
    s_add_u32 s53, s53, 36864
    v_lshl_add_u32 v13, v1, 4, s53
    s_mul_i32 s52, s73, 190656
    s_add_u32 s53, s52, 756666
    s_lshr_b32 s52, s52, 20
    s_lshr_b32 s53, s53, 20
    s_sub_u32 s52, s53, s52
    s_lshl_b32 s52, s52, 3
    s_add_u32 s52, s52, 7
    v_and_b32 v9, s52, v1
    v_lshlrev_b32 v9, 2, v9
    s_lshr_b32 s70, s73, 2
    s_mul_i32 s70, s70, 10
    s_add_u32 s70, s70, s74
    s_mul_i32 s70, s70, 4352
    s_add_u32 s70, s70, 0xe00100
    s_mov_b32 s40, s18
    s_and_b32 s41, s19, 0xffff
    s_mov_b32 s42, 0x280000
    s_mov_b32 s43, 0x20000
    v_lshrrev_b32 v6, 3, v1
    v_and_b32 v7, 7, v1
    s_lshl1_add_u32 s52, s71, s73
    s_lshl_b32 s52, s52, 5
    s_lshl4_add_u32 s52, s63, s52
    v_add_u32 v10, s52, v6
    v_mul_u32_u24 v10, 1280, v10
    v_lshl_add_u32 v10, v7, 4, v10
    s_lshl_b32 s52, s74, 7
    v_add_u32 v10, s52, v10
    v_add_u32 v11, 10240, v10
    s_mov_b32 s66, 40960
    buffer_load_dwordx4 v[32:35], v10, s[24:27], 0 offen
    buffer_load_dwordx4 v[36:39], v11, s[24:27], 0 offen
    buffer_load_dwordx4 v[40:43], v10, s[24:27], s66 offen
    buffer_load_dwordx4 v[44:47], v11, s[24:27], s66 offen
    v_mul_u32_u24 v7, 1056, v7
    v_lshl_add_u32 v7, v6, 4, v7
    s_mul_i32 s52, s71, 16896
    s_lshl_b32 s53, s63, 8
    s_add_u32 s52, s52, s53
    v_add_u32 v4, s52, v7
    v_add_u32 v5, 77824, v4
    s_waitcnt vmcnt(4)
    s_mov_b32 s100, 0x400000
L_cl_44:
    s_sleep 1
    ds_read_b64 v[16:17], v2 offset:24
    s_sub_u32 s100, s100, 1
    s_cbranch_scc1 L_cx_45
    s_waitcnt lgkmcnt(0)
    v_min_u32 v16, v16, v17
    s_nop 0
    v_readfirstlane_b32 s3, v16
    s_nop 1
    s_cmp_lt_u32 s3, 1
    s_cbranch_scc1 L_cl_44
L_cx_45:
    ds_write_b128 v12, v[104:107] offset:0
    ds_write_b128 v12, v[108:111] offset:1024
    ds_write_b128 v12, v[112:115] offset:2048
    ds_write_b128 v12, v[116:119] offset:3072
    ds_write_b128 v12, v[120:123] offset:4096
    ds_write_b128 v12, v[124:127] offset:5120
    s_mov_b32 s100, 0x400000
L_cl_46:
    s_sleep 1
    ds_read_b64 v[16:17], v2 offset:24
    s_sub_u32 s100, s100, 1
    s_cbranch_scc1 L_cx_47
    s_waitcnt lgkmcnt(0)
    v_min_u32 v16, v16, v17
    s_nop 0
    v_readfirstlane_b32 s3, v16
    s_nop 1
    s_cmp_lt_u32 s3, 2
    s_cbranch_scc1 L_cl_46
L_cx_47:
    ds_write_b128 v12, v[128:131] offset:12288
    ds_write_b128 v12, v[132:135] offset:13312
    ds_write_b128 v12, v[136:139] offset:14336
    ds_write_b128 v12, v[140:143] offset:15360
    ds_write_b128 v12, v[144:147] offset:16384
    ds_write_b128 v12, v[148:151] offset:17408
    s_mov_b32 s100, 0x400000
L_cl_48:
    s_sleep 1
    ds_read_b64 v[16:17], v2 offset:24
    s_sub_u32 s100, s100, 1
    s_cbranch_scc1 L_cx_49
    s_waitcnt lgkmcnt(0)
    v_min_u32 v16, v16, v17
    s_nop 0
    v_readfirstlane_b32 s3, v16
    s_nop 1
    s_cmp_lt_u32 s3, 3
    s_cbranch_scc1 L_cl_48
L_cx_49:
    ds_write_b128 v12, v[152:155] offset:24576
    ds_write_b128 v12, v[156:159] offset:25600
    ds_write_b128 v12, v[160:163] offset:26624
    ds_write_b128 v12, v[164:167] offset:27648
    ds_write_b128 v12, v[168:171] offset:28672
    ds_write_b128 v12, v[172:175] offset:29696
    s_mov_b64 exec, 1
    ds_add_u32 v2, v15 offset:8
    s_mov_b64 exec, -1
    s_waitcnt vmcnt(0)
    buffer_load_dword v8, v9, s[28:31], s70 offen sc1
    ds_write_b128 v13, v[248:251] offset:36864
    ds_write_b128 v13, v[252:255] offset:38912
    s_mov_b32 s100, 0x400000
L_cl_50:
    s_sleep 1
    ds_read_b64 v[16:17], v2 offset:24
    s_sub_u32 s100, s100, 1
    s_cbranch_scc1 L_cx_51
    s_waitcnt lgkmcnt(0)
    v_min_u32 v16, v16, v17
    s_nop 0
    v_readfirstlane_b32 s3, v16
    s_nop 1
    s_cmp_lt_u32 s3, 4
    s_cbranch_scc1 L_cl_50
L_cx_51:
    ds_write_b128 v13, v[176:179] offset:0
    ds_write_b128 v13, v[180:183] offset:2048
    ds_write_b128 v13, v[184:187] offset:4096
    ds_write_b128 v13, v[188:191] offset:6144
    ds_write_b128 v13, v[192:195] offset:8192
    ds_write_b128 v13, v[196:199] offset:10240
    s_mov_b32 s100, 0x400000
L_cl_52:
    s_sleep 1
    ds_read_b64 v[16:17], v2 offset:24
    s_sub_u32 s100, s100, 1
    s_cbranch_scc1 L_cx_53
    s_waitcnt lgkmcnt(0)
    v_min_u32 v16, v16, v17
    s_nop 0
    v_readfirstlane_b32 s3, v16
    s_nop 1
    s_cmp_lt_u32 s3, 5
    s_cbranch_scc1 L_cl_52
L_cx_53:
    ds_write_b128 v13, v[200:203] offset:12288
    ds_write_b128 v13, v[204:207] offset:14336
    ds_write_b128 v13, v[208:211] offset:16384
    ds_write_b128 v13, v[212:215] offset:18432
    ds_write_b128 v13, v[216:219] offset:20480
    ds_write_b128 v13, v[220:223] offset:22528
    s_cmp_lg_u32 s51, 0
    s_cbranch_scc1 L_npo_54
    s_waitcnt vmcnt(0)
    s_mov_b32 s3, 0x40000
    s_branch L_sck_57
L_ssp_56:
    buffer_load_dword v8, v9, s[28:31], s70 offen sc1
    s_waitcnt vmcnt(0)
L_sck_57:
    v_cmp_gt_u32 vcc, 1, v8
    s_nop 1
    s_cmp_eq_u64 vcc, 0
    s_cbranch_scc1 L_sok_55
    s_sleep 1
    s_sub_u32 s3, s3, 1
    s_cbranch_scc0 L_ssp_56
L_sok_55:
    s_mov_b64 exec, 1
    ds_add_u32 v14, v15 offset:32
    s_mov_b64 exec, -1
L_npo_54:
    s_mov_b32 s100, 0x400000
L_cl_58:
    s_sleep 1
    ds_read_b64 v[16:17], v2 offset:24
    s_sub_u32 s100, s100, 1
    s_cbranch_scc1 L_cx_59
    s_waitcnt lgkmcnt(0)
    v_min_u32 v16, v16, v17
    s_nop 0
    v_readfirstlane_b32 s3, v16
    s_nop 1
    s_cmp_lt_u32 s3, 6
    s_cbranch_scc1 L_cl_58
L_cx_59:
    ds_write_b128 v13, v[224:227] offset:24576
    ds_write_b128 v13, v[228:231] offset:26624
    ds_write_b128 v13, v[232:235] offset:28672
    ds_write_b128 v13, v[236:239] offset:30720
    ds_write_b128 v13, v[240:243] offset:32768
    ds_write_b128 v13, v[244:247] offset:34816
    s_mov_b64 exec, 1
    ds_add_u32 v2, v15 offset:16
    s_mov_b64 exec, -1
    s_waitcnt vmcnt(0)
    v_lshlrev_b32 v48, 16, v32
    v_and_b32 v49, 0xffff0000, v32
    v_lshlrev_b32 v50, 16, v33
    v_and_b32 v51, 0xffff0000, v33
    v_lshlrev_b32 v52, 16, v34
    v_and_b32 v53, 0xffff0000, v34
    v_lshlrev_b32 v54, 16, v35
    v_and_b32 v55, 0xffff0000, v35
    v_lshlrev_b32 v56, 16, v36
    v_and_b32 v57, 0xffff0000, v36
    v_lshlrev_b32 v58, 16, v37
    v_and_b32 v59, 0xffff0000, v37
    v_lshlrev_b32 v60, 16, v38
    v_and_b32 v61, 0xffff0000, v38
    v_lshlrev_b32 v62, 16, v39
    v_and_b32 v63, 0xffff0000, v39
    v_lshlrev_b32 v64, 16, v40
    v_and_b32 v65, 0xffff0000, v40
    v_lshlrev_b32 v66, 16, v41
    v_and_b32 v67, 0xffff0000, v41
    v_lshlrev_b32 v68, 16, v42
    v_and_b32 v69, 0xffff0000, v42
    v_lshlrev_b32 v70, 16, v43
    v_and_b32 v71, 0xffff0000, v43
    v_lshlrev_b32 v72, 16, v44
    v_and_b32 v73, 0xffff0000, v44
    v_lshlrev_b32 v74, 16, v45
    v_and_b32 v75, 0xffff0000, v45
    v_lshlrev_b32 v76, 16, v46
    v_and_b32 v77, 0xffff0000, v46
    v_lshlrev_b32 v78, 16, v47
    v_and_b32 v79, 0xffff0000, v47
    s_mov_b32 s100, 0x400000
L_cl_60:
    s_sleep 1
    ds_read_b32 v0, v14 offset:56
    s_sub_u32 s100, s100, 1
    s_cbranch_scc1 L_cx_61
    s_waitcnt lgkmcnt(0)
    v_readfirstlane_b32 s3, v0
    s_nop 1
    s_cmp_lt_u32 s3, 4
    s_cbranch_scc1 L_cl_60
L_cx_61:
    ds_read_b128 v[104:107], v4 offset:8448
    ds_read_b128 v[108:111], v4 offset:8960
    ds_read_b128 v[120:123], v5 offset:8448
    ds_read_b128 v[124:127], v5 offset:8960
    ds_read_b128 v[112:115], v4 offset:8576
    ds_read_b128 v[116:119], v4 offset:9088
    ds_read_b128 v[128:131], v5 offset:8576
    ds_read_b128 v[132:135], v5 offset:9088
    s_mov_b64 exec, 1
    ds_add_u32 v14, v15 offset:60
    s_mov_b64 exec, -1
    s_waitcnt lgkmcnt(0)
    v_pk_add_f32 v[168:169], v[104:105], v[120:121]
    v_pk_add_f32 v[170:171], v[106:107], v[122:123]
    v_pk_add_f32 v[172:173], v[108:109], v[124:125]
    v_pk_add_f32 v[174:175], v[110:111], v[126:127]
    v_pk_add_f32 v[176:177], v[112:113], v[128:129]
    v_pk_add_f32 v[178:179], v[114:115], v[130:131]
    v_pk_add_f32 v[180:181], v[116:117], v[132:133]
    v_pk_add_f32 v[182:183], v[118:119], v[134:135]
    v_mul_f32 v136, 0xbfb8aa3b, v168
    v_mul_f32 v137, 0xbfb8aa3b, v169
    v_mul_f32 v138, 0xbfb8aa3b, v170
    v_mul_f32 v139, 0xbfb8aa3b, v171
    v_mul_f32 v140, 0xbfb8aa3b, v172
    v_mul_f32 v141, 0xbfb8aa3b, v173
    v_mul_f32 v142, 0xbfb8aa3b, v174
    v_mul_f32 v143, 0xbfb8aa3b, v175
    v_mul_f32 v144, 0xbfb8aa3b, v176
    v_mul_f32 v145, 0xbfb8aa3b, v177
    v_mul_f32 v146, 0xbfb8aa3b, v178
    v_mul_f32 v147, 0xbfb8aa3b, v179
    v_mul_f32 v148, 0xbfb8aa3b, v180
    v_mul_f32 v149, 0xbfb8aa3b, v181
    v_mul_f32 v150, 0xbfb8aa3b, v182
    v_mul_f32 v151, 0xbfb8aa3b, v183
    v_exp_f32 v136, v136
    v_exp_f32 v137, v137
    v_exp_f32 v138, v138
    v_exp_f32 v139, v139
    v_exp_f32 v140, v140
    v_exp_f32 v141, v141
    v_exp_f32 v142, v142
    v_exp_f32 v143, v143
    v_exp_f32 v144, v144
    v_exp_f32 v145, v145
    v_exp_f32 v146, v146
    v_exp_f32 v147, v147
    v_exp_f32 v148, v148
    v_exp_f32 v149, v149
    v_exp_f32 v150, v150
    v_exp_f32 v151, v151
    v_add_f32 v136, 1.0, v136
    v_add_f32 v137, 1.0, v137
    v_add_f32 v138, 1.0, v138
    v_add_f32 v139, 1.0, v139
    v_add_f32 v140, 1.0, v140
    v_add_f32 v141, 1.0, v141
    v_add_f32 v142, 1.0, v142
    v_add_f32 v143, 1.0, v143
    v_add_f32 v144, 1.0, v144
    v_add_f32 v145, 1.0, v145
    v_add_f32 v146, 1.0, v146
    v_add_f32 v147, 1.0, v147
    v_add_f32 v148, 1.0, v148
    v_add_f32 v149, 1.0, v149
    v_add_f32 v150, 1.0, v150
    v_add_f32 v151, 1.0, v151
    v_rcp_f32 v136, v136
    v_rcp_f32 v137, v137
    v_rcp_f32 v138, v138
    v_rcp_f32 v139, v139
    v_rcp_f32 v140, v140
    v_rcp_f32 v141, v141
    v_rcp_f32 v142, v142
    v_rcp_f32 v143, v143
    v_rcp_f32 v144, v144
    v_rcp_f32 v145, v145
    v_rcp_f32 v146, v146
    v_rcp_f32 v147, v147
    v_rcp_f32 v148, v148
    v_rcp_f32 v149, v149
    v_rcp_f32 v150, v150
    v_rcp_f32 v151, v151
    v_mul_f32 v168, v168, v136
    v_mul_f32 v169, v169, v137
    v_mul_f32 v170, v170, v138
    v_mul_f32 v171, v171, v139
    v_mul_f32 v172, v172, v140
    v_mul_f32 v173, v173, v141
    v_mul_f32 v174, v174, v142
    v_mul_f32 v175, v175, v143
    v_mul_f32 v176, v176, v144
    v_mul_f32 v177, v177, v145
    v_mul_f32 v178, v178, v146
    v_mul_f32 v179, v179, v147
    v_mul_f32 v180, v180, v148
    v_mul_f32 v181, v181, v149
    v_mul_f32 v182, v182, v150
    v_mul_f32 v183, v183, v151
    s_mov_b32 s100, 0x400000
L_cl_62:
    s_sleep 1
    ds_read_b32 v0, v14 offset:44
    s_sub_u32 s100, s100, 1
    s_cbranch_scc1 L_cx_63
    s_waitcnt lgkmcnt(0)
    v_readfirstlane_b32 s3, v0
    s_nop 1
    s_cmp_lt_u32 s3, 4
    s_cbranch_scc1 L_cl_62
L_cx_63:
    ds_read_b128 v[104:107], v4 offset:0
    ds_read_b128 v[108:111], v4 offset:512
    ds_read_b128 v[120:123], v5 offset:0
    ds_read_b128 v[124:127], v5 offset:512
    ds_read_b128 v[112:115], v4 offset:128
    ds_read_b128 v[116:119], v4 offset:640
    ds_read_b128 v[128:131], v5 offset:128
    ds_read_b128 v[132:135], v5 offset:640
    s_mov_b64 exec, 1
    ds_add_u32 v14, v15 offset:36
    s_mov_b64 exec, -1
    s_waitcnt lgkmcnt(0)
    v_pk_add_f32 v[152:153], v[104:105], v[120:121]
    v_pk_add_f32 v[154:155], v[106:107], v[122:123]
    v_pk_add_f32 v[156:157], v[108:109], v[124:125]
    v_pk_add_f32 v[158:159], v[110:111], v[126:127]
    v_pk_add_f32 v[160:161], v[112:113], v[128:129]
    v_pk_add_f32 v[162:163], v[114:115], v[130:131]
    v_pk_add_f32 v[164:165], v[116:117], v[132:133]
    v_pk_add_f32 v[166:167], v[118:119], v[134:135]
    v_mul_f32 v136, 0xbfb8aa3b, v152
    v_mul_f32 v137, 0xbfb8aa3b, v153
    v_mul_f32 v138, 0xbfb8aa3b, v154
    v_mul_f32 v139, 0xbfb8aa3b, v155
    v_mul_f32 v140, 0xbfb8aa3b, v156
    v_mul_f32 v141, 0xbfb8aa3b, v157
    v_mul_f32 v142, 0xbfb8aa3b, v158
    v_mul_f32 v143, 0xbfb8aa3b, v159
    v_mul_f32 v144, 0xbfb8aa3b, v160
    v_mul_f32 v145, 0xbfb8aa3b, v161
    v_mul_f32 v146, 0xbfb8aa3b, v162
    v_mul_f32 v147, 0xbfb8aa3b, v163
    v_mul_f32 v148, 0xbfb8aa3b, v164
    v_mul_f32 v149, 0xbfb8aa3b, v165
    v_mul_f32 v150, 0xbfb8aa3b, v166
    v_mul_f32 v151, 0xbfb8aa3b, v167
    v_exp_f32 v136, v136
    v_exp_f32 v137, v137
    v_exp_f32 v138, v138
    v_exp_f32 v139, v139
    v_exp_f32 v140, v140
    v_exp_f32 v141, v141
    v_exp_f32 v142, v142
    v_exp_f32 v143, v143
    v_exp_f32 v144, v144
    v_exp_f32 v145, v145
    v_exp_f32 v146, v146
    v_exp_f32 v147, v147
    v_exp_f32 v148, v148
    v_exp_f32 v149, v149
    v_exp_f32 v150, v150
    v_exp_f32 v151, v151
    v_add_f32 v136, 1.0, v136
    v_add_f32 v137, 1.0, v137
    v_add_f32 v138, 1.0, v138
    v_add_f32 v139, 1.0, v139
    v_add_f32 v140, 1.0, v140
    v_add_f32 v141, 1.0, v141
    v_add_f32 v142, 1.0, v142
    v_add_f32 v143, 1.0, v143
    v_add_f32 v144, 1.0, v144
    v_add_f32 v145, 1.0, v145
    v_add_f32 v146, 1.0, v146
    v_add_f32 v147, 1.0, v147
    v_add_f32 v148, 1.0, v148
    v_add_f32 v149, 1.0, v149
    v_add_f32 v150, 1.0, v150
    v_add_f32 v151, 1.0, v151
    v_rcp_f32 v136, v136
    v_rcp_f32 v137, v137
    v_rcp_f32 v138, v138
    v_rcp_f32 v139, v139
    v_rcp_f32 v140, v140
    v_rcp_f32 v141, v141
    v_rcp_f32 v142, v142
    v_rcp_f32 v143, v143
    v_rcp_f32 v144, v144
    v_rcp_f32 v145, v145
    v_rcp_f32 v146, v146
    v_rcp_f32 v147, v147
    v_rcp_f32 v148, v148
    v_rcp_f32 v149, v149
    v_rcp_f32 v150, v150
    v_rcp_f32 v151, v151
    v_mul_f32 v152, v152, v136
    v_mul_f32 v153, v153, v137
    v_mul_f32 v154, v154, v138
    v_mul_f32 v155, v155, v139
    v_mul_f32 v156, v156, v140
    v_mul_f32 v157, v157, v141
    v_mul_f32 v158, v158, v142
    v_mul_f32 v159, v159, v143
    v_mul_f32 v160, v160, v144
    v_mul_f32 v161, v161, v145
    v_mul_f32 v162, v162, v146
    v_mul_f32 v163, v163, v147
    v_mul_f32 v164, v164, v148
    v_mul_f32 v165, v165, v149
    v_mul_f32 v166, v166, v150
    v_mul_f32 v167, v167, v151
    s_mov_b32 s100, 0x400000
L_cl_64:
    s_sleep 1
    ds_read_b32 v0, v14 offset:52
    s_sub_u32 s100, s100, 1
    s_cbranch_scc1 L_cx_65
    s_waitcnt lgkmcnt(0)
    v_readfirstlane_b32 s3, v0
    s_nop 1
    s_cmp_lt_u32 s3, 4
    s_cbranch_scc1 L_cl_64
L_cx_65:
    ds_read_b128 v[104:107], v4 offset:8448
    ds_read_b128 v[108:111], v4 offset:8960
    ds_read_b128 v[120:123], v5 offset:8448
    ds_read_b128 v[124:127], v5 offset:8960
    ds_read_b128 v[112:115], v4 offset:8576
    ds_read_b128 v[116:119], v4 offset:9088
    ds_read_b128 v[128:131], v5 offset:8576
    ds_read_b128 v[132:135], v5 offset:9088
    s_waitcnt lgkmcnt(4)
    v_pk_fma_f32 v[64:65], v[168:169], v[104:105], v[64:65]
    v_pk_fma_f32 v[66:67], v[170:171], v[106:107], v[66:67]
    v_pk_fma_f32 v[68:69], v[172:173], v[108:109], v[68:69]
    v_pk_fma_f32 v[70:71], v[174:175], v[110:111], v[70:71]
    v_pk_fma_f32 v[64:65], v[168:169], v[120:121], v[64:65]
    v_pk_fma_f32 v[66:67], v[170:171], v[122:123], v[66:67]
    v_pk_fma_f32 v[68:69], v[172:173], v[124:125], v[68:69]
    v_pk_fma_f32 v[70:71], v[174:175], v[126:127], v[70:71]
    v_cvt_pk_bf16_f32 v40, v64, v65
    v_cvt_pk_bf16_f32 v41, v66, v67
    v_cvt_pk_bf16_f32 v42, v68, v69
    v_cvt_pk_bf16_f32 v43, v70, v71
    buffer_store_dwordx4 v[40:43], v10, s[40:43], s66 offen sc1
    s_waitcnt lgkmcnt(0)
    v_pk_fma_f32 v[72:73], v[176:177], v[112:113], v[72:73]
    v_pk_fma_f32 v[74:75], v[178:179], v[114:115], v[74:75]
    v_pk_fma_f32 v[76:77], v[180:181], v[116:117], v[76:77]
    v_pk_fma_f32 v[78:79], v[182:183], v[118:119], v[78:79]
    v_pk_fma_f32 v[72:73], v[176:177], v[128:129], v[72:73]
    v_pk_fma_f32 v[74:75], v[178:179], v[130:131], v[74:75]
    v_pk_fma_f32 v[76:77], v[180:181], v[132:133], v[76:77]
    v_pk_fma_f32 v[78:79], v[182:183], v[134:135], v[78:79]
    v_cvt_pk_bf16_f32 v44, v72, v73
    v_cvt_pk_bf16_f32 v45, v74, v75
    v_cvt_pk_bf16_f32 v46, v76, v77
    v_cvt_pk_bf16_f32 v47, v78, v79
    buffer_store_dwordx4 v[44:47], v11, s[40:43], s66 offen sc1
    s_mov_b32 s100, 0x400000
L_cl_66:
    ds_read_b32 v0, v14 offset:48
    s_sub_u32 s100, s100, 1
    s_cbranch_scc1 L_cx_67
    s_waitcnt lgkmcnt(0)
    v_readfirstlane_b32 s3, v0
    s_nop 1
    s_cmp_lt_u32 s3, 4
    s_cbranch_scc1 L_cl_66
L_cx_67:
    ds_read_b128 v[104:107], v4 offset:0
    ds_read_b128 v[108:111], v4 offset:512
    ds_read_b128 v[120:123], v5 offset:0
    ds_read_b128 v[124:127], v5 offset:512
    ds_read_b128 v[112:115], v4 offset:128
    ds_read_b128 v[116:119], v4 offset:640
    ds_read_b128 v[128:131], v5 offset:128
    ds_read_b128 v[132:135], v5 offset:640
    s_waitcnt lgkmcnt(4)
    v_pk_fma_f32 v[48:49], v[152:153], v[104:105], v[48:49]
    v_pk_fma_f32 v[50:51], v[154:155], v[106:107], v[50:51]
    v_pk_fma_f32 v[52:53], v[156:157], v[108:109], v[52:53]
    v_pk_fma_f32 v[54:55], v[158:159], v[110:111], v[54:55]
    v_pk_fma_f32 v[48:49], v[152:153], v[120:121], v[48:49]
    v_pk_fma_f32 v[50:51], v[154:155], v[122:123], v[50:51]
    v_pk_fma_f32 v[52:53], v[156:157], v[124:125], v[52:53]
    v_pk_fma_f32 v[54:55], v[158:159], v[126:127], v[54:55]
    v_cvt_pk_bf16_f32 v32, v48, v49
    v_cvt_pk_bf16_f32 v33, v50, v51
    v_cvt_pk_bf16_f32 v34, v52, v53
    v_cvt_pk_bf16_f32 v35, v54, v55
    buffer_store_dwordx4 v[32:35], v10, s[40:43], 0 offen sc1
    s_waitcnt lgkmcnt(0)
    v_pk_fma_f32 v[56:57], v[160:161], v[112:113], v[56:57]
    v_pk_fma_f32 v[58:59], v[162:163], v[114:115], v[58:59]
    v_pk_fma_f32 v[60:61], v[164:165], v[116:117], v[60:61]
    v_pk_fma_f32 v[62:63], v[166:167], v[118:119], v[62:63]
    v_pk_fma_f32 v[56:57], v[160:161], v[128:129], v[56:57]
    v_pk_fma_f32 v[58:59], v[162:163], v[130:131], v[58:59]
    v_pk_fma_f32 v[60:61], v[164:165], v[132:133], v[60:61]
    v_pk_fma_f32 v[62:63], v[166:167], v[134:135], v[62:63]
    v_cvt_pk_bf16_f32 v36, v56, v57
    v_cvt_pk_bf16_f32 v37, v58, v59
    v_cvt_pk_bf16_f32 v38, v60, v61
    v_cvt_pk_bf16_f32 v39, v62, v63
    buffer_store_dwordx4 v[36:39], v11, s[40:43], 0 offen sc1
    s_branch L_done
L_qkv_compute:
    s_lshr_b32 s52, s49, 1
    s_mul_i32 s52, s52, 10
    s_add_u32 s52, s52, s50
    s_lshr_b32 s53, s50, 2
    s_add_u32 s52, s52, s53
    s_and_b32 s53, s49, 1
    s_add_u32 s52, s52, s53
    s_mul_i32 s53, s50, 43
    s_lshr_b32 s53, s53, 7
    s_mul_i32 s54, s50, 3
    s_add_u32 s53, s53, s54
    s_add_u32 s53, s53, s49
    s_cmp_ge_u32 s49, 9
    s_cselect_b32 s54, 48, 24
    s_add_u32 s53, s53, s54
    s_cmp_lt_u32 s49, 6
    s_cselect_b32 s69, s52, s53
    s_waitcnt lgkmcnt(0)
    s_cmp_lt_u32 s69, 57
    s_cselect_b64 s[44:45], s[12:13], s[14:15]
    s_cselect_b32 s52, 30, 57
    s_mov_b32 s46, 2211840
    s_movk_i32 s53, 3456
    s_cmp_lt_u32 s69, 30
    s_cselect_b64 s[44:45], s[6:7], s[44:45]
    s_cselect_b32 s52, 0, s52
    s_cselect_b32 s46, 2457600, s46
    s_cselect_b32 s53, 3840, s53
    s_and_b32 s45, s45, 0xffff
    s_mov_b32 s47, 0x20000
    s_sub_u32 s52, s69, s52
    s_lshl_b32 s52, s52, 7
    s_cmp_lt_u32 s69, 84
    s_cselect_b32 s52, s52, 0x40000000
    v_lshrrev_b32 v8, 3, v0
    v_mul_u32_u24 v8, s53, v8
    v_and_b32 v9, 7, v1
    v_lshl_add_u32 v8, v9, 4, v8
    v_add_u32 v10, s52, v8
    s_lshl_b32 s53, s53, 5
    s_mov_b32 s52, 0
    buffer_load_dwordx4 v[80:83], v10, s[44:47], s52 offen
    s_add_u32 s52, s52, s53
    buffer_load_dwordx4 v[84:87], v10, s[44:47], s52 offen
    s_add_u32 s52, s52, s53
    buffer_load_dwordx4 v[88:91], v10, s[44:47], s52 offen
    s_add_u32 s52, s52, s53
    buffer_load_dwordx4 v[92:95], v10, s[44:47], s52 offen
    s_add_u32 s52, s52, s53
    buffer_load_dwordx4 v[96:99], v10, s[44:47], s52 offen
    s_add_u32 s52, s52, s53
    buffer_load_dwordx4 v[100:103], v10, s[44:47], s52 offen
    s_add_u32 s52, s52, s53
    buffer_load_dwordx4 v[104:107], v10, s[44:47], s52 offen
    s_add_u32 s52, s52, s53
    buffer_load_dwordx4 v[108:111], v10, s[44:47], s52 offen
    s_add_u32 s52, s52, s53
    buffer_load_dwordx4 v[112:115], v10, s[44:47], s52 offen
    s_add_u32 s52, s52, s53
    buffer_load_dwordx4 v[116:119], v10, s[44:47], s52 offen
    s_add_u32 s52, s52, s53
    buffer_load_dwordx4 v[120:123], v10, s[44:47], s52 offen
    s_add_u32 s52, s52, s53
    buffer_load_dwordx4 v[124:127], v10, s[44:47], s52 offen
    s_add_u32 s52, s52, s53
    buffer_load_dwordx4 v[128:131], v10, s[44:47], s52 offen
    s_add_u32 s52, s52, s53
    buffer_load_dwordx4 v[132:135], v10, s[44:47], s52 offen
    s_add_u32 s52, s52, s53
    buffer_load_dwordx4 v[136:139], v10, s[44:47], s52 offen
    s_add_u32 s52, s52, s53
    buffer_load_dwordx4 v[140:143], v10, s[44:47], s52 offen
    s_add_u32 s52, s52, s53
    buffer_load_dwordx4 v[144:147], v10, s[44:47], s52 offen
    s_add_u32 s52, s52, s53
    buffer_load_dwordx4 v[148:151], v10, s[44:47], s52 offen
    s_add_u32 s52, s52, s53
    buffer_load_dwordx4 v[152:155], v10, s[44:47], s52 offen
    s_add_u32 s52, s52, s53
    buffer_load_dwordx4 v[156:159], v10, s[44:47], s52 offen
    s_add_u32 s52, s52, s53
    s_mov_b32 s65, 9
    v_and_b32 v5, 15, v1
    s_mul_i32 s52, s48, 48
    v_add_u32 v5, s52, v5
    v_lshlrev_b32 v5, 7, v5
    v_lshrrev_b32 v6, 4, v1
    v_bfe_u32 v7, v1, 1, 3
    v_xor_b32 v7, v7, v6
    v_lshl_add_u32 v2, v7, 4, v5
    v_xor_b32 v3, 64, v2
    v_lshrrev_b32 v5, 2, v1
    v_mul_u32_u24 v5, 480, v5
    v_and_b32 v6, 3, v1
    v_mul_u32_u24 v6, 40, v6
    v_add_u32 v4, v5, v6
    v_add_u32 v4, 0x12000, v4
    v_mov_b64 v[76:77], 0
    v_mov_b64 v[78:79], 0
    v_mov_b64 v[160:161], 0
    v_mov_b64 v[162:163], 0
    v_mov_b64 v[164:165], 0
    v_mov_b64 v[166:167], 0
    v_mov_b64 v[168:169], 0
    v_mov_b64 v[170:171], 0
    v_mov_b64 v[172:173], 0
    v_mov_b64 v[174:175], 0
    v_mov_b64 v[176:177], 0
    v_mov_b64 v[178:179], 0
    v_mov_b64 v[180:181], 0
    v_mov_b64 v[182:183], 0
    v_mov_b64 v[184:185], 0
    v_mov_b64 v[186:187], 0
    v_mov_b64 v[188:189], 0
    v_mov_b64 v[190:191], 0
    v_mov_b64 v[192:193], 0
    v_mov_b64 v[194:195], 0
    v_mov_b64 v[196:197], 0
    v_mov_b64 v[198:199], 0
    v_mov_b64 v[200:201], 0
    v_mov_b64 v[202:203], 0
    v_mov_b64 v[204:205], 0
    v_mov_b64 v[206:207], 0
    v_mov_b64 v[208:209], 0
    v_mov_b64 v[210:211], 0
    v_mov_b64 v[212:213], 0
    v_mov_b64 v[214:215], 0
    v_mov_b64 v[216:217], 0
    v_mov_b64 v[218:219], 0
    v_mov_b64 v[220:221], 0
    v_mov_b64 v[222:223], 0
    v_mov_b64 v[224:225], 0
    v_mov_b64 v[226:227], 0
    v_mov_b64 v[228:229], 0
    v_mov_b64 v[230:231], 0
    v_mov_b64 v[232:233], 0
    v_mov_b64 v[234:235], 0
    v_mov_b64 v[236:237], 0
    v_mov_b64 v[238:239], 0
    v_mov_b64 v[240:241], 0
    v_mov_b64 v[242:243], 0
    v_mov_b64 v[244:245], 0
    v_mov_b64 v[246:247], 0
    v_mov_b64 v[248:249], 0
    v_mov_b64 v[250:251], 0
    v_mov_b64 v[252:253], 0
    v_mov_b64 v[254:255], 0
    s_mov_b32 s60, 0
    s_mov_b32 s63, 0
    s_mov_b32 s62, 0x8000
    s_mov_b32 s55, 0x6000
    s_waitcnt lgkmcnt(0)
    s_mov_b32 s32, s20
    s_and_b32 s33, s21, 0xffff
    s_mov_b32 s34, 0x100
    s_mov_b32 s35, 0x20000
    s_mov_b32 s28, s22
    s_and_b32 s29, s23, 0xffff
    s_mov_b32 s30, 0xf20000
    s_mov_b32 s31, 0x20000
    s_mov_b32 s24, s4
    s_and_b32 s25, s5, 0xffff
    s_mov_b32 s26, 0x280000
    s_mov_b32 s27, 0x20000
    s_waitcnt vmcnt(19)
    v_lshlrev_b32 v40, 16, v80
    v_and_b32 v41, 0xffff0000, v80
    v_lshlrev_b32 v42, 16, v81
    v_and_b32 v43, 0xffff0000, v81
    v_lshlrev_b32 v44, 16, v82
    v_and_b32 v45, 0xffff0000, v82
    v_lshlrev_b32 v46, 16, v83
    v_and_b32 v47, 0xffff0000, v83
    v_mov_b64 v[80:81], 0
    v_mov_b64 v[82:83], 0
    s_waitcnt vmcnt(18)
    v_lshlrev_b32 v48, 16, v84
    v_and_b32 v49, 0xffff0000, v84
    v_lshlrev_b32 v50, 16, v85
    v_and_b32 v51, 0xffff0000, v85
    v_lshlrev_b32 v52, 16, v86
    v_and_b32 v53, 0xffff0000, v86
    v_lshlrev_b32 v54, 16, v87
    v_and_b32 v55, 0xffff0000, v87
    v_pk_add_f32 v[40:41], v[40:41], v[48:49]
    v_pk_add_f32 v[42:43], v[42:43], v[50:51]
    v_pk_add_f32 v[44:45], v[44:45], v[52:53]
    v_pk_add_f32 v[46:47], v[46:47], v[54:55]
    v_mov_b64 v[84:85], 0
    v_mov_b64 v[86:87], 0
    s_waitcnt vmcnt(17)
    v_lshlrev_b32 v48, 16, v88
    v_and_b32 v49, 0xffff0000, v88
    v_lshlrev_b32 v50, 16, v89
    v_and_b32 v51, 0xffff0000, v89
    v_lshlrev_b32 v52, 16, v90
    v_and_b32 v53, 0xffff0000, v90
    v_lshlrev_b32 v54, 16, v91
    v_and_b32 v55, 0xffff0000, v91
    v_pk_add_f32 v[40:41], v[40:41], v[48:49]
    v_pk_add_f32 v[42:43], v[42:43], v[50:51]
    v_pk_add_f32 v[44:45], v[44:45], v[52:53]
    v_pk_add_f32 v[46:47], v[46:47], v[54:55]
    v_mov_b64 v[88:89], 0
    v_mov_b64 v[90:91], 0
    s_waitcnt vmcnt(16)
    v_lshlrev_b32 v48, 16, v92
    v_and_b32 v49, 0xffff0000, v92
    v_lshlrev_b32 v50, 16, v93
    v_and_b32 v51, 0xffff0000, v93
    v_lshlrev_b32 v52, 16, v94
    v_and_b32 v53, 0xffff0000, v94
    v_lshlrev_b32 v54, 16, v95
    v_and_b32 v55, 0xffff0000, v95
    v_pk_add_f32 v[40:41], v[40:41], v[48:49]
    v_pk_add_f32 v[42:43], v[42:43], v[50:51]
    v_pk_add_f32 v[44:45], v[44:45], v[52:53]
    v_pk_add_f32 v[46:47], v[46:47], v[54:55]
    v_mov_b64 v[92:93], 0
    v_mov_b64 v[94:95], 0
    s_waitcnt vmcnt(15)
    v_lshlrev_b32 v48, 16, v96
    v_and_b32 v49, 0xffff0000, v96
    v_lshlrev_b32 v50, 16, v97
    v_and_b32 v51, 0xffff0000, v97
    v_lshlrev_b32 v52, 16, v98
    v_and_b32 v53, 0xffff0000, v98
    v_lshlrev_b32 v54, 16, v99
    v_and_b32 v55, 0xffff0000, v99
    v_pk_add_f32 v[40:41], v[40:41], v[48:49]
    v_pk_add_f32 v[42:43], v[42:43], v[50:51]
    v_pk_add_f32 v[44:45], v[44:45], v[52:53]
    v_pk_add_f32 v[46:47], v[46:47], v[54:55]
    v_mov_b64 v[96:97], 0
    v_mov_b64 v[98:99], 0
    s_waitcnt vmcnt(14)
    v_lshlrev_b32 v48, 16, v100
    v_and_b32 v49, 0xffff0000, v100
    v_lshlrev_b32 v50, 16, v101
    v_and_b32 v51, 0xffff0000, v101
    v_lshlrev_b32 v52, 16, v102
    v_and_b32 v53, 0xffff0000, v102
    v_lshlrev_b32 v54, 16, v103
    v_and_b32 v55, 0xffff0000, v103
    v_pk_add_f32 v[40:41], v[40:41], v[48:49]
    v_pk_add_f32 v[42:43], v[42:43], v[50:51]
    v_pk_add_f32 v[44:45], v[44:45], v[52:53]
    v_pk_add_f32 v[46:47], v[46:47], v[54:55]
    v_mov_b64 v[100:101], 0
    v_mov_b64 v[102:103], 0
    s_waitcnt vmcnt(13)
    v_lshlrev_b32 v48, 16, v104
    v_and_b32 v49, 0xffff0000, v104
    v_lshlrev_b32 v50, 16, v105
    v_and_b32 v51, 0xffff0000, v105
    v_lshlrev_b32 v52, 16, v106
    v_and_b32 v53, 0xffff0000, v106
    v_lshlrev_b32 v54, 16, v107
    v_and_b32 v55, 0xffff0000, v107
    v_pk_add_f32 v[40:41], v[40:41], v[48:49]
    v_pk_add_f32 v[42:43], v[42:43], v[50:51]
    v_pk_add_f32 v[44:45], v[44:45], v[52:53]
    v_pk_add_f32 v[46:47], v[46:47], v[54:55]
    v_mov_b64 v[104:105], 0
    v_mov_b64 v[106:107], 0
    s_waitcnt vmcnt(12)
    v_lshlrev_b32 v48, 16, v108
    v_and_b32 v49, 0xffff0000, v108
    v_lshlrev_b32 v50, 16, v109
    v_and_b32 v51, 0xffff0000, v109
    v_lshlrev_b32 v52, 16, v110
    v_and_b32 v53, 0xffff0000, v110
    v_lshlrev_b32 v54, 16, v111
    v_and_b32 v55, 0xffff0000, v111
    v_pk_add_f32 v[40:41], v[40:41], v[48:49]
    v_pk_add_f32 v[42:43], v[42:43], v[50:51]
    v_pk_add_f32 v[44:45], v[44:45], v[52:53]
    v_pk_add_f32 v[46:47], v[46:47], v[54:55]
    v_mov_b64 v[108:109], 0
    v_mov_b64 v[110:111], 0
    s_waitcnt vmcnt(11)
    v_lshlrev_b32 v48, 16, v112
    v_and_b32 v49, 0xffff0000, v112
    v_lshlrev_b32 v50, 16, v113
    v_and_b32 v51, 0xffff0000, v113
    v_lshlrev_b32 v52, 16, v114
    v_and_b32 v53, 0xffff0000, v114
    v_lshlrev_b32 v54, 16, v115
    v_and_b32 v55, 0xffff0000, v115
    v_pk_add_f32 v[40:41], v[40:41], v[48:49]
    v_pk_add_f32 v[42:43], v[42:43], v[50:51]
    v_pk_add_f32 v[44:45], v[44:45], v[52:53]
    v_pk_add_f32 v[46:47], v[46:47], v[54:55]
    v_mov_b64 v[112:113], 0
    v_mov_b64 v[114:115], 0
    s_waitcnt vmcnt(10)
    v_lshlrev_b32 v48, 16, v116
    v_and_b32 v49, 0xffff0000, v116
    v_lshlrev_b32 v50, 16, v117
    v_and_b32 v51, 0xffff0000, v117
    v_lshlrev_b32 v52, 16, v118
    v_and_b32 v53, 0xffff0000, v118
    v_lshlrev_b32 v54, 16, v119
    v_and_b32 v55, 0xffff0000, v119
    v_pk_add_f32 v[40:41], v[40:41], v[48:49]
    v_pk_add_f32 v[42:43], v[42:43], v[50:51]
    v_pk_add_f32 v[44:45], v[44:45], v[52:53]
    v_pk_add_f32 v[46:47], v[46:47], v[54:55]
    v_mov_b64 v[116:117], 0
    v_mov_b64 v[118:119], 0
    s_waitcnt vmcnt(9)
    v_lshlrev_b32 v48, 16, v120
    v_and_b32 v49, 0xffff0000, v120
    v_lshlrev_b32 v50, 16, v121
    v_and_b32 v51, 0xffff0000, v121
    v_lshlrev_b32 v52, 16, v122
    v_and_b32 v53, 0xffff0000, v122
    v_lshlrev_b32 v54, 16, v123
    v_and_b32 v55, 0xffff0000, v123
    v_pk_add_f32 v[40:41], v[40:41], v[48:49]
    v_pk_add_f32 v[42:43], v[42:43], v[50:51]
    v_pk_add_f32 v[44:45], v[44:45], v[52:53]
    v_pk_add_f32 v[46:47], v[46:47], v[54:55]
    v_mov_b64 v[120:121], 0
    v_mov_b64 v[122:123], 0
    s_waitcnt vmcnt(8)
    v_lshlrev_b32 v48, 16, v124
    v_and_b32 v49, 0xffff0000, v124
    v_lshlrev_b32 v50, 16, v125
    v_and_b32 v51, 0xffff0000, v125
    v_lshlrev_b32 v52, 16, v126
    v_and_b32 v53, 0xffff0000, v126
    v_lshlrev_b32 v54, 16, v127
    v_and_b32 v55, 0xffff0000, v127
    v_pk_add_f32 v[40:41], v[40:41], v[48:49]
    v_pk_add_f32 v[42:43], v[42:43], v[50:51]
    v_pk_add_f32 v[44:45], v[44:45], v[52:53]
    v_pk_add_f32 v[46:47], v[46:47], v[54:55]
    v_mov_b64 v[124:125], 0
    v_mov_b64 v[126:127], 0
    s_waitcnt vmcnt(7)
    v_lshlrev_b32 v48, 16, v128
    v_and_b32 v49, 0xffff0000, v128
    v_lshlrev_b32 v50, 16, v129
    v_and_b32 v51, 0xffff0000, v129
    v_lshlrev_b32 v52, 16, v130
    v_and_b32 v53, 0xffff0000, v130
    v_lshlrev_b32 v54, 16, v131
    v_and_b32 v55, 0xffff0000, v131
    v_pk_add_f32 v[40:41], v[40:41], v[48:49]
    v_pk_add_f32 v[42:43], v[42:43], v[50:51]
    v_pk_add_f32 v[44:45], v[44:45], v[52:53]
    v_pk_add_f32 v[46:47], v[46:47], v[54:55]
    v_mov_b64 v[128:129], 0
    v_mov_b64 v[130:131], 0
    s_waitcnt vmcnt(6)
    v_lshlrev_b32 v48, 16, v132
    v_and_b32 v49, 0xffff0000, v132
    v_lshlrev_b32 v50, 16, v133
    v_and_b32 v51, 0xffff0000, v133
    v_lshlrev_b32 v52, 16, v134
    v_and_b32 v53, 0xffff0000, v134
    v_lshlrev_b32 v54, 16, v135
    v_and_b32 v55, 0xffff0000, v135
    v_pk_add_f32 v[40:41], v[40:41], v[48:49]
    v_pk_add_f32 v[42:43], v[42:43], v[50:51]
    v_pk_add_f32 v[44:45], v[44:45], v[52:53]
    v_pk_add_f32 v[46:47], v[46:47], v[54:55]
    v_mov_b64 v[132:133], 0
    v_mov_b64 v[134:135], 0
    s_waitcnt vmcnt(5)
    v_lshlrev_b32 v48, 16, v136
    v_and_b32 v49, 0xffff0000, v136
    v_lshlrev_b32 v50, 16, v137
    v_and_b32 v51, 0xffff0000, v137
    v_lshlrev_b32 v52, 16, v138
    v_and_b32 v53, 0xffff0000, v138
    v_lshlrev_b32 v54, 16, v139
    v_and_b32 v55, 0xffff0000, v139
    v_pk_add_f32 v[40:41], v[40:41], v[48:49]
    v_pk_add_f32 v[42:43], v[42:43], v[50:51]
    v_pk_add_f32 v[44:45], v[44:45], v[52:53]
    v_pk_add_f32 v[46:47], v[46:47], v[54:55]
    v_mov_b64 v[136:137], 0
    v_mov_b64 v[138:139], 0
    s_waitcnt vmcnt(4)
    v_lshlrev_b32 v48, 16, v140
    v_and_b32 v49, 0xffff0000, v140
    v_lshlrev_b32 v50, 16, v141
    v_and_b32 v51, 0xffff0000, v141
    v_lshlrev_b32 v52, 16, v142
    v_and_b32 v53, 0xffff0000, v142
    v_lshlrev_b32 v54, 16, v143
    v_and_b32 v55, 0xffff0000, v143
    v_pk_add_f32 v[40:41], v[40:41], v[48:49]
    v_pk_add_f32 v[42:43], v[42:43], v[50:51]
    v_pk_add_f32 v[44:45], v[44:45], v[52:53]
    v_pk_add_f32 v[46:47], v[46:47], v[54:55]
    v_mov_b64 v[140:141], 0
    v_mov_b64 v[142:143], 0
    s_waitcnt vmcnt(3)
    v_lshlrev_b32 v48, 16, v144
    v_and_b32 v49, 0xffff0000, v144
    v_lshlrev_b32 v50, 16, v145
    v_and_b32 v51, 0xffff0000, v145
    v_lshlrev_b32 v52, 16, v146
    v_and_b32 v53, 0xffff0000, v146
    v_lshlrev_b32 v54, 16, v147
    v_and_b32 v55, 0xffff0000, v147
    v_pk_add_f32 v[40:41], v[40:41], v[48:49]
    v_pk_add_f32 v[42:43], v[42:43], v[50:51]
    v_pk_add_f32 v[44:45], v[44:45], v[52:53]
    v_pk_add_f32 v[46:47], v[46:47], v[54:55]
    v_mov_b64 v[144:145], 0
    v_mov_b64 v[146:147], 0
    s_waitcnt vmcnt(2)
    v_lshlrev_b32 v48, 16, v148
    v_and_b32 v49, 0xffff0000, v148
    v_lshlrev_b32 v50, 16, v149
    v_and_b32 v51, 0xffff0000, v149
    v_lshlrev_b32 v52, 16, v150
    v_and_b32 v53, 0xffff0000, v150
    v_lshlrev_b32 v54, 16, v151
    v_and_b32 v55, 0xffff0000, v151
    v_pk_add_f32 v[40:41], v[40:41], v[48:49]
    v_pk_add_f32 v[42:43], v[42:43], v[50:51]
    v_pk_add_f32 v[44:45], v[44:45], v[52:53]
    v_pk_add_f32 v[46:47], v[46:47], v[54:55]
    v_mov_b64 v[148:149], 0
    v_mov_b64 v[150:151], 0
    s_waitcnt vmcnt(1)
    v_lshlrev_b32 v48, 16, v152
    v_and_b32 v49, 0xffff0000, v152
    v_lshlrev_b32 v50, 16, v153
    v_and_b32 v51, 0xffff0000, v153
    v_lshlrev_b32 v52, 16, v154
    v_and_b32 v53, 0xffff0000, v154
    v_lshlrev_b32 v54, 16, v155
    v_and_b32 v55, 0xffff0000, v155
    v_pk_add_f32 v[40:41], v[40:41], v[48:49]
    v_pk_add_f32 v[42:43], v[42:43], v[50:51]
    v_pk_add_f32 v[44:45], v[44:45], v[52:53]
    v_pk_add_f32 v[46:47], v[46:47], v[54:55]
    v_mov_b64 v[152:153], 0
    v_mov_b64 v[154:155], 0
    s_waitcnt vmcnt(0)
    v_lshlrev_b32 v48, 16, v156
    v_and_b32 v49, 0xffff0000, v156
    v_lshlrev_b32 v50, 16, v157
    v_and_b32 v51, 0xffff0000, v157
    v_lshlrev_b32 v52, 16, v158
    v_and_b32 v53, 0xffff0000, v158
    v_lshlrev_b32 v54, 16, v159
    v_and_b32 v55, 0xffff0000, v159
    v_pk_add_f32 v[40:41], v[40:41], v[48:49]
    v_pk_add_f32 v[42:43], v[42:43], v[50:51]
    v_pk_add_f32 v[44:45], v[44:45], v[52:53]
    v_pk_add_f32 v[46:47], v[46:47], v[54:55]
    v_mov_b64 v[156:157], 0
    v_mov_b64 v[158:159], 0
    v_permlane32_swap_b32 v40, v44
    v_permlane32_swap_b32 v41, v45
    v_permlane32_swap_b32 v42, v46
    v_permlane32_swap_b32 v43, v47
    s_nop 0
    v_pk_add_f32 v[40:41], v[40:41], v[44:45]
    v_pk_add_f32 v[42:43], v[42:43], v[46:47]
    s_nop 1
    v_permlane16_swap_b32 v40, v42
    v_permlane16_swap_b32 v41, v43
    s_nop 0
    v_pk_add_f32 v[40:41], v[40:41], v[42:43]
    v_and_b32 v8, 7, v1
    v_lshlrev_b32 v8, 5, v8
    v_lshrrev_b32 v9, 4, v1
    v_lshl_add_u32 v8, v9, 3, v8
    v_add_f32_dpp v40, v40, v40 row_ror:8 row_mask:0xf bank_mask:0xf
    v_add_f32_dpp v41, v41, v41 row_ror:8 row_mask:0xf bank_mask:0xf
    s_mul_i32 s53, s48, 21504
    s_lshl_b32 s54, s69, 8
    s_add_u32 s53, s53, s54
    s_add_u32 s53, s53, 0xa10000
    buffer_store_dwordx2 v[40:41], v8, s[28:31], s53 offen sc1
    s_waitcnt vmcnt(0)
    s_barrier
    s_mul_i32 s53, s48, 3072
    s_add_u32 s53, s53, 139264
    v_lshl_add_u32 v5, v1, 4, s53
    ds_read_b32 v0, v5 offset:12
    ds_read_b32 v11, v5 offset:1036
    s_cmp_lg_u32 s48, 3
    s_cbranch_scc1 L_nsig_68
    v_cmp_eq_u32 vcc, 0, v1
    v_mov_b32 v7, 0x40000000
    v_mov_b32 v6, 0
    v_cndmask_b32 v6, v7, v6, vcc
    v_mov_b32 v7, 1
    s_lshr_b32 s54, s2, 3
    s_lshl2_add_u32 s54, s54, 128
    buffer_atomic_add v7, v6, s[32:35], s54 offen sc1
L_nsig_68:
    ds_read_b128 v[12:15], v2 offset:0
    ds_read_b128 v[16:19], v2 offset:2048
    ds_read_b128 v[20:23], v2 offset:4096
    ds_read_b64_tr_b16 v[36:37], v4 offset:0
    ds_read_b64_tr_b16 v[38:39], v4 offset:7680
    ds_read_b64_tr_b16 v[40:41], v4 offset:8
    ds_read_b64_tr_b16 v[42:43], v4 offset:7688
    ds_read_b64_tr_b16 v[44:45], v4 offset:16
    ds_read_b64_tr_b16 v[46:47], v4 offset:7696
    ds_read_b64_tr_b16 v[48:49], v4 offset:24
    ds_read_b64_tr_b16 v[50:51], v4 offset:7704
    ds_read_b64_tr_b16 v[52:53], v4 offset:32
    ds_read_b64_tr_b16 v[54:55], v4 offset:7712
    ds_read_b64_tr_b16 v[56:57], v4 offset:160
    ds_read_b64_tr_b16 v[58:59], v4 offset:7840
L_qkv_loop_69:
    s_waitcnt lgkmcnt(10)
    v_mfma_f32_16x16x32_bf16 v[76:79], v[36:39], v[12:15], v[76:79]
    ds_read_b64_tr_b16 v[60:61], v4 offset:168
    v_mfma_f32_16x16x32_bf16 v[136:139], v[36:39], v[16:19], v[136:139]
    ds_read_b64_tr_b16 v[62:63], v4 offset:7848
    v_mfma_f32_16x16x32_bf16 v[196:199], v[36:39], v[20:23], v[196:199]
    ds_read_b64_tr_b16 v[64:65], v4 offset:176
    s_waitcnt lgkmcnt(10)
    v_mfma_f32_16x16x32_bf16 v[200:203], v[40:43], v[20:23], v[200:203]
    ds_read_b64_tr_b16 v[66:67], v4 offset:7856
    v_mfma_f32_16x16x32_bf16 v[140:143], v[40:43], v[16:19], v[140:143]
    ds_read_b64_tr_b16 v[68:69], v4 offset:184
    v_mfma_f32_16x16x32_bf16 v[80:83], v[40:43], v[12:15], v[80:83]
    ds_read_b64_tr_b16 v[70:71], v4 offset:7864
    s_waitcnt lgkmcnt(10)
    v_mfma_f32_16x16x32_bf16 v[84:87], v[44:47], v[12:15], v[84:87]
    ds_read_b64_tr_b16 v[72:73], v4 offset:192
    v_mfma_f32_16x16x32_bf16 v[144:147], v[44:47], v[16:19], v[144:147]
    ds_read_b64_tr_b16 v[74:75], v4 offset:7872
    v_mfma_f32_16x16x32_bf16 v[204:207], v[44:47], v[20:23], v[204:207]
    ds_read_b64_tr_b16 v[36:37], v4 offset:320
    v_mfma_f32_16x16x32_bf16 v[208:211], v[48:51], v[20:23], v[208:211]
    ds_read_b64_tr_b16 v[38:39], v4 offset:8000
    v_mfma_f32_16x16x32_bf16 v[148:151], v[48:51], v[16:19], v[148:151]
    ds_read_b64_tr_b16 v[40:41], v4 offset:328
    v_mfma_f32_16x16x32_bf16 v[88:91], v[48:51], v[12:15], v[88:91]
    ds_read_b64_tr_b16 v[42:43], v4 offset:8008
    s_waitcnt lgkmcnt(10)
    v_mfma_f32_16x16x32_bf16 v[92:95], v[52:55], v[12:15], v[92:95]
    ds_read_b64_tr_b16 v[44:45], v4 offset:336
    v_mfma_f32_16x16x32_bf16 v[152:155], v[52:55], v[16:19], v[152:155]
    ds_read_b64_tr_b16 v[46:47], v4 offset:8016
    v_mfma_f32_16x16x32_bf16 v[212:215], v[52:55], v[20:23], v[212:215]
    ds_read_b64_tr_b16 v[48:49], v4 offset:344
    v_mfma_f32_16x16x32_bf16 v[216:219], v[56:59], v[20:23], v[216:219]
    ds_read_b64_tr_b16 v[50:51], v4 offset:8024
    v_mfma_f32_16x16x32_bf16 v[156:159], v[56:59], v[16:19], v[156:159]
    ds_read_b64_tr_b16 v[52:53], v4 offset:352
    v_mfma_f32_16x16x32_bf16 v[96:99], v[56:59], v[12:15], v[96:99]
    ds_read_b64_tr_b16 v[54:55], v4 offset:8032
    v_mfma_f32_16x16x32_bf16 v[100:103], v[60:63], v[12:15], v[100:103]
    v_mfma_f32_16x16x32_bf16 v[160:163], v[60:63], v[16:19], v[160:163]
    v_mfma_f32_16x16x32_bf16 v[220:223], v[60:63], v[20:23], v[220:223]
    s_waitcnt lgkmcnt(7)
    v_mfma_f32_16x16x32_bf16 v[224:227], v[64:67], v[20:23], v[224:227]
    v_mfma_f32_16x16x32_bf16 v[164:167], v[64:67], v[16:19], v[164:167]
    v_mfma_f32_16x16x32_bf16 v[104:107], v[64:67], v[12:15], v[104:107]
    v_mfma_f32_16x16x32_bf16 v[108:111], v[68:71], v[12:15], v[108:111]
    v_mfma_f32_16x16x32_bf16 v[168:171], v[68:71], v[16:19], v[168:171]
    v_mfma_f32_16x16x32_bf16 v[228:231], v[68:71], v[20:23], v[228:231]
    v_mfma_f32_16x16x32_bf16 v[232:235], v[72:75], v[20:23], v[232:235]
    v_mfma_f32_16x16x32_bf16 v[172:175], v[72:75], v[16:19], v[172:175]
    v_mfma_f32_16x16x32_bf16 v[112:115], v[72:75], v[12:15], v[112:115]
    s_waitcnt lgkmcnt(0)
    s_barrier
    v_mfma_f32_16x16x32_bf16 v[116:119], v[36:39], v[12:15], v[116:119]
    ds_read_b128 v[24:27], v3 offset:0
    v_mfma_f32_16x16x32_bf16 v[176:179], v[36:39], v[16:19], v[176:179]
    ds_read_b128 v[28:31], v3 offset:2048
    v_mfma_f32_16x16x32_bf16 v[236:239], v[36:39], v[20:23], v[236:239]
    ds_read_b128 v[32:35], v3 offset:4096
    v_mfma_f32_16x16x32_bf16 v[240:243], v[40:43], v[20:23], v[240:243]
    ds_read_b64_tr_b16 v[56:57], v4 offset:16384
    v_mfma_f32_16x16x32_bf16 v[180:183], v[40:43], v[16:19], v[180:183]
    ds_read_b64_tr_b16 v[58:59], v4 offset:24064
    v_mfma_f32_16x16x32_bf16 v[120:123], v[40:43], v[12:15], v[120:123]
    ds_read_b64_tr_b16 v[60:61], v4 offset:16392
    v_mfma_f32_16x16x32_bf16 v[124:127], v[44:47], v[12:15], v[124:127]
    ds_read_b64_tr_b16 v[62:63], v4 offset:24072
    v_mfma_f32_16x16x32_bf16 v[184:187], v[44:47], v[16:19], v[184:187]
    ds_read_b64_tr_b16 v[64:65], v4 offset:16400
    v_mfma_f32_16x16x32_bf16 v[244:247], v[44:47], v[20:23], v[244:247]
    ds_read_b64_tr_b16 v[66:67], v4 offset:24080
    v_mfma_f32_16x16x32_bf16 v[248:251], v[48:51], v[20:23], v[248:251]
    ds_read_b64_tr_b16 v[68:69], v4 offset:16408
    v_mfma_f32_16x16x32_bf16 v[188:191], v[48:51], v[16:19], v[188:191]
    ds_read_b64_tr_b16 v[70:71], v4 offset:24088
    v_mfma_f32_16x16x32_bf16 v[128:131], v[48:51], v[12:15], v[128:131]
    ds_read_b64_tr_b16 v[72:73], v4 offset:16416
    v_mfma_f32_16x16x32_bf16 v[132:135], v[52:55], v[12:15], v[132:135]
    ds_read_b64_tr_b16 v[74:75], v4 offset:24096
    v_mfma_f32_16x16x32_bf16 v[192:195], v[52:55], v[16:19], v[192:195]
    ds_read_b64_tr_b16 v[36:37], v4 offset:16544
    v_mfma_f32_16x16x32_bf16 v[252:255], v[52:55], v[20:23], v[252:255]
    ds_read_b64_tr_b16 v[38:39], v4 offset:24224
    s_waitcnt lgkmcnt(10)
    v_mfma_f32_16x16x32_bf16 v[76:79], v[56:59], v[24:27], v[76:79]
    ds_read_b64_tr_b16 v[40:41], v4 offset:16552
    v_mfma_f32_16x16x32_bf16 v[136:139], v[56:59], v[28:31], v[136:139]
    ds_read_b64_tr_b16 v[42:43], v4 offset:24232
    v_mfma_f32_16x16x32_bf16 v[196:199], v[56:59], v[32:35], v[196:199]
    ds_read_b64_tr_b16 v[44:45], v4 offset:16560
    s_waitcnt lgkmcnt(10)
    v_mfma_f32_16x16x32_bf16 v[200:203], v[60:63], v[32:35], v[200:203]
    ds_read_b64_tr_b16 v[46:47], v4 offset:24240
    v_mfma_f32_16x16x32_bf16 v[140:143], v[60:63], v[28:31], v[140:143]
    ds_read_b64_tr_b16 v[48:49], v4 offset:16568
    v_mfma_f32_16x16x32_bf16 v[80:83], v[60:63], v[24:27], v[80:83]
    ds_read_b64_tr_b16 v[50:51], v4 offset:24248
    s_waitcnt lgkmcnt(10)
    v_mfma_f32_16x16x32_bf16 v[84:87], v[64:67], v[24:27], v[84:87]
    ds_read_b64_tr_b16 v[52:53], v4 offset:16576
    v_mfma_f32_16x16x32_bf16 v[144:147], v[64:67], v[28:31], v[144:147]
    ds_read_b64_tr_b16 v[54:55], v4 offset:24256
    v_mfma_f32_16x16x32_bf16 v[204:207], v[64:67], v[32:35], v[204:207]
    ds_read_b64_tr_b16 v[56:57], v4 offset:16704
    v_mfma_f32_16x16x32_bf16 v[208:211], v[68:71], v[32:35], v[208:211]
    ds_read_b64_tr_b16 v[58:59], v4 offset:24384
    v_mfma_f32_16x16x32_bf16 v[148:151], v[68:71], v[28:31], v[148:151]
    ds_read_b64_tr_b16 v[60:61], v4 offset:16712
    v_mfma_f32_16x16x32_bf16 v[88:91], v[68:71], v[24:27], v[88:91]
    ds_read_b64_tr_b16 v[62:63], v4 offset:24392
    s_waitcnt lgkmcnt(10)
    v_mfma_f32_16x16x32_bf16 v[92:95], v[72:75], v[24:27], v[92:95]
    ds_read_b64_tr_b16 v[64:65], v4 offset:16720
    v_mfma_f32_16x16x32_bf16 v[152:155], v[72:75], v[28:31], v[152:155]
    ds_read_b64_tr_b16 v[66:67], v4 offset:24400
    v_mfma_f32_16x16x32_bf16 v[212:215], v[72:75], v[32:35], v[212:215]
    ds_read_b64_tr_b16 v[68:69], v4 offset:16728
    v_mfma_f32_16x16x32_bf16 v[216:219], v[36:39], v[32:35], v[216:219]
    ds_read_b64_tr_b16 v[70:71], v4 offset:24408
    v_mfma_f32_16x16x32_bf16 v[156:159], v[36:39], v[28:31], v[156:159]
    ds_read_b64_tr_b16 v[72:73], v4 offset:16736
    v_mfma_f32_16x16x32_bf16 v[96:99], v[36:39], v[24:27], v[96:99]
    ds_read_b64_tr_b16 v[74:75], v4 offset:24416
    v_mfma_f32_16x16x32_bf16 v[100:103], v[40:43], v[24:27], v[100:103]
    v_mfma_f32_16x16x32_bf16 v[160:163], v[40:43], v[28:31], v[160:163]
    s_add_u32 s63, s63, 1
    s_cmp_eq_u32 s63, 3
    v_mfma_f32_16x16x32_bf16 v[220:223], v[40:43], v[32:35], v[220:223]
    s_cselect_b32 s61, 0xffff4000, s55
    s_cselect_b32 s63, 0, s63
    s_waitcnt lgkmcnt(7)
    v_mfma_f32_16x16x32_bf16 v[224:227], v[44:47], v[32:35], v[224:227]
    v_add_u32 v2, s61, v2
    v_add_u32 v3, s61, v3
    v_mfma_f32_16x16x32_bf16 v[164:167], v[44:47], v[28:31], v[164:167]
    v_add_u32 v4, s62, v4
    s_sub_u32 s62, 0, s62
    v_mfma_f32_16x16x32_bf16 v[104:107], v[44:47], v[24:27], v[104:107]
    v_mfma_f32_16x16x32_bf16 v[108:111], v[48:51], v[24:27], v[108:111]
    s_add_u32 s60, s60, 1
    s_cmp_lg_u32 s60, s65
    v_mfma_f32_16x16x32_bf16 v[168:171], v[48:51], v[28:31], v[168:171]
    v_mfma_f32_16x16x32_bf16 v[228:231], v[48:51], v[32:35], v[228:231]
    v_mfma_f32_16x16x32_bf16 v[232:235], v[52:55], v[32:35], v[232:235]
    v_mfma_f32_16x16x32_bf16 v[172:175], v[52:55], v[28:31], v[172:175]
    v_mfma_f32_16x16x32_bf16 v[112:115], v[52:55], v[24:27], v[112:115]
    s_waitcnt lgkmcnt(0)
    s_barrier
    v_mfma_f32_16x16x32_bf16 v[116:119], v[56:59], v[24:27], v[116:119]
    ds_read_b128 v[12:15], v2 offset:0
    v_mfma_f32_16x16x32_bf16 v[176:179], v[56:59], v[28:31], v[176:179]
    ds_read_b128 v[16:19], v2 offset:2048
    v_mfma_f32_16x16x32_bf16 v[236:239], v[56:59], v[32:35], v[236:239]
    ds_read_b128 v[20:23], v2 offset:4096
    v_mfma_f32_16x16x32_bf16 v[240:243], v[60:63], v[32:35], v[240:243]
    ds_read_b64_tr_b16 v[36:37], v4 offset:0
    v_mfma_f32_16x16x32_bf16 v[180:183], v[60:63], v[28:31], v[180:183]
    ds_read_b64_tr_b16 v[38:39], v4 offset:7680
    v_mfma_f32_16x16x32_bf16 v[120:123], v[60:63], v[24:27], v[120:123]
    ds_read_b64_tr_b16 v[40:41], v4 offset:8
    v_mfma_f32_16x16x32_bf16 v[124:127], v[64:67], v[24:27], v[124:127]
    ds_read_b64_tr_b16 v[42:43], v4 offset:7688
    v_mfma_f32_16x16x32_bf16 v[184:187], v[64:67], v[28:31], v[184:187]
    ds_read_b64_tr_b16 v[44:45], v4 offset:16
    v_mfma_f32_16x16x32_bf16 v[244:247], v[64:67], v[32:35], v[244:247]
    ds_read_b64_tr_b16 v[46:47], v4 offset:7696
    v_mfma_f32_16x16x32_bf16 v[248:251], v[68:71], v[32:35], v[248:251]
    ds_read_b64_tr_b16 v[48:49], v4 offset:24
    v_mfma_f32_16x16x32_bf16 v[188:191], v[68:71], v[28:31], v[188:191]
    ds_read_b64_tr_b16 v[50:51], v4 offset:7704
    v_mfma_f32_16x16x32_bf16 v[128:131], v[68:71], v[24:27], v[128:131]
    ds_read_b64_tr_b16 v[52:53], v4 offset:32
    v_mfma_f32_16x16x32_bf16 v[132:135], v[72:75], v[24:27], v[132:135]
    ds_read_b64_tr_b16 v[54:55], v4 offset:7712
    v_mfma_f32_16x16x32_bf16 v[192:195], v[72:75], v[28:31], v[192:195]
    ds_read_b64_tr_b16 v[56:57], v4 offset:160
    v_mfma_f32_16x16x32_bf16 v[252:255], v[72:75], v[32:35], v[252:255]
    ds_read_b64_tr_b16 v[58:59], v4 offset:7840
    s_cbranch_scc1 L_qkv_loop_69
    s_cmp_eq_u32 s60, 9
    s_cbranch_scc1 L_lout_70
    s_waitcnt vmcnt(0)
    v_cmp_eq_u32 vcc, 0, v1
    v_mov_b32 v7, 0x40000000
    v_mov_b32 v6, 0
    v_cndmask_b32 v6, v7, v6, vcc
    v_mov_b32 v7, 1
    s_lshr_b32 s54, s2, 3
    s_lshl2_add_u32 s54, s54, 128
    buffer_atomic_add v7, v6, s[32:35], s54 offen sc1
    s_mov_b32 s65, 9
    s_branch L_qkv_loop_69
L_lout_70:
    s_waitcnt lgkmcnt(10)
    v_mfma_f32_16x16x32_bf16 v[76:79], v[36:39], v[12:15], v[76:79]
    ds_read_b64_tr_b16 v[60:61], v4 offset:168
    v_mfma_f32_16x16x32_bf16 v[136:139], v[36:39], v[16:19], v[136:139]
    ds_read_b64_tr_b16 v[62:63], v4 offset:7848
    v_mfma_f32_16x16x32_bf16 v[196:199], v[36:39], v[20:23], v[196:199]
    ds_read_b64_tr_b16 v[64:65], v4 offset:176
    s_waitcnt lgkmcnt(10)
    v_mfma_f32_16x16x32_bf16 v[200:203], v[40:43], v[20:23], v[200:203]
    ds_read_b64_tr_b16 v[66:67], v4 offset:7856
    v_mfma_f32_16x16x32_bf16 v[140:143], v[40:43], v[16:19], v[140:143]
    ds_read_b64_tr_b16 v[68:69], v4 offset:184
    v_mfma_f32_16x16x32_bf16 v[80:83], v[40:43], v[12:15], v[80:83]
    ds_read_b64_tr_b16 v[70:71], v4 offset:7864
    s_waitcnt lgkmcnt(10)
    v_mfma_f32_16x16x32_bf16 v[84:87], v[44:47], v[12:15], v[84:87]
    ds_read_b64_tr_b16 v[72:73], v4 offset:192
    v_mfma_f32_16x16x32_bf16 v[144:147], v[44:47], v[16:19], v[144:147]
    ds_read_b64_tr_b16 v[74:75], v4 offset:7872
    v_mfma_f32_16x16x32_bf16 v[204:207], v[44:47], v[20:23], v[204:207]
    ds_read_b64_tr_b16 v[36:37], v4 offset:320
    v_mfma_f32_16x16x32_bf16 v[208:211], v[48:51], v[20:23], v[208:211]
    ds_read_b64_tr_b16 v[38:39], v4 offset:8000
    v_mfma_f32_16x16x32_bf16 v[148:151], v[48:51], v[16:19], v[148:151]
    ds_read_b64_tr_b16 v[40:41], v4 offset:328
    v_mfma_f32_16x16x32_bf16 v[88:91], v[48:51], v[12:15], v[88:91]
    ds_read_b64_tr_b16 v[42:43], v4 offset:8008
    s_waitcnt lgkmcnt(10)
    v_mfma_f32_16x16x32_bf16 v[92:95], v[52:55], v[12:15], v[92:95]
    ds_read_b64_tr_b16 v[44:45], v4 offset:336
    v_mfma_f32_16x16x32_bf16 v[152:155], v[52:55], v[16:19], v[152:155]
    ds_read_b64_tr_b16 v[46:47], v4 offset:8016
    v_mfma_f32_16x16x32_bf16 v[212:215], v[52:55], v[20:23], v[212:215]
    ds_read_b64_tr_b16 v[48:49], v4 offset:344
    v_mfma_f32_16x16x32_bf16 v[216:219], v[56:59], v[20:23], v[216:219]
    ds_read_b64_tr_b16 v[50:51], v4 offset:8024
    v_mfma_f32_16x16x32_bf16 v[156:159], v[56:59], v[16:19], v[156:159]
    ds_read_b64_tr_b16 v[52:53], v4 offset:352
    v_mfma_f32_16x16x32_bf16 v[96:99], v[56:59], v[12:15], v[96:99]
    ds_read_b64_tr_b16 v[54:55], v4 offset:8032
    v_mfma_f32_16x16x32_bf16 v[100:103], v[60:63], v[12:15], v[100:103]
    v_mfma_f32_16x16x32_bf16 v[160:163], v[60:63], v[16:19], v[160:163]
    v_mfma_f32_16x16x32_bf16 v[220:223], v[60:63], v[20:23], v[220:223]
    s_waitcnt lgkmcnt(7)
    v_mfma_f32_16x16x32_bf16 v[224:227], v[64:67], v[20:23], v[224:227]
    v_mfma_f32_16x16x32_bf16 v[164:167], v[64:67], v[16:19], v[164:167]
    v_mfma_f32_16x16x32_bf16 v[104:107], v[64:67], v[12:15], v[104:107]
    v_mfma_f32_16x16x32_bf16 v[108:111], v[68:71], v[12:15], v[108:111]
    v_mfma_f32_16x16x32_bf16 v[168:171], v[68:71], v[16:19], v[168:171]
    v_mfma_f32_16x16x32_bf16 v[228:231], v[68:71], v[20:23], v[228:231]
    v_mfma_f32_16x16x32_bf16 v[232:235], v[72:75], v[20:23], v[232:235]
    v_mfma_f32_16x16x32_bf16 v[172:175], v[72:75], v[16:19], v[172:175]
    v_mfma_f32_16x16x32_bf16 v[112:115], v[72:75], v[12:15], v[112:115]
    v_mfma_f32_16x16x32_bf16 v[116:119], v[36:39], v[12:15], v[116:119]
    ds_read_b128 v[24:27], v3 offset:0
    v_mfma_f32_16x16x32_bf16 v[176:179], v[36:39], v[16:19], v[176:179]
    ds_read_b128 v[28:31], v3 offset:2048
    v_mfma_f32_16x16x32_bf16 v[236:239], v[36:39], v[20:23], v[236:239]
    ds_read_b128 v[32:35], v3 offset:4096
    s_waitcnt lgkmcnt(3)
    v_mfma_f32_16x16x32_bf16 v[240:243], v[40:43], v[20:23], v[240:243]
    ds_read_b64_tr_b16 v[56:57], v4 offset:16384
    v_mfma_f32_16x16x32_bf16 v[180:183], v[40:43], v[16:19], v[180:183]
    ds_read_b64_tr_b16 v[58:59], v4 offset:24064
    v_mfma_f32_16x16x32_bf16 v[120:123], v[40:43], v[12:15], v[120:123]
    ds_read_b64_tr_b16 v[60:61], v4 offset:16392
    v_mfma_f32_16x16x32_bf16 v[124:127], v[44:47], v[12:15], v[124:127]
    ds_read_b64_tr_b16 v[62:63], v4 offset:24072
    v_mfma_f32_16x16x32_bf16 v[184:187], v[44:47], v[16:19], v[184:187]
    ds_read_b64_tr_b16 v[64:65], v4 offset:16400
    v_mfma_f32_16x16x32_bf16 v[244:247], v[44:47], v[20:23], v[244:247]
    ds_read_b64_tr_b16 v[66:67], v4 offset:24080
    v_mfma_f32_16x16x32_bf16 v[248:251], v[48:51], v[20:23], v[248:251]
    ds_read_b64_tr_b16 v[68:69], v4 offset:16408
    v_mfma_f32_16x16x32_bf16 v[188:191], v[48:51], v[16:19], v[188:191]
    ds_read_b64_tr_b16 v[70:71], v4 offset:24088
    v_mfma_f32_16x16x32_bf16 v[128:131], v[48:51], v[12:15], v[128:131]
    ds_read_b64_tr_b16 v[72:73], v4 offset:16416
    v_mfma_f32_16x16x32_bf16 v[132:135], v[52:55], v[12:15], v[132:135]
    ds_read_b64_tr_b16 v[74:75], v4 offset:24096
    v_mfma_f32_16x16x32_bf16 v[192:195], v[52:55], v[16:19], v[192:195]
    ds_read_b64_tr_b16 v[36:37], v4 offset:16544
    v_mfma_f32_16x16x32_bf16 v[252:255], v[52:55], v[20:23], v[252:255]
    ds_read_b64_tr_b16 v[38:39], v4 offset:24224
    s_waitcnt lgkmcnt(10)
    v_mfma_f32_16x16x32_bf16 v[76:79], v[56:59], v[24:27], v[76:79]
    ds_read_b64_tr_b16 v[40:41], v4 offset:16552
    v_mfma_f32_16x16x32_bf16 v[136:139], v[56:59], v[28:31], v[136:139]
    ds_read_b64_tr_b16 v[42:43], v4 offset:24232
    v_mfma_f32_16x16x32_bf16 v[196:199], v[56:59], v[32:35], v[196:199]
    ds_read_b64_tr_b16 v[44:45], v4 offset:16560
    s_waitcnt lgkmcnt(10)
    v_mfma_f32_16x16x32_bf16 v[200:203], v[60:63], v[32:35], v[200:203]
    ds_read_b64_tr_b16 v[46:47], v4 offset:24240
    v_mfma_f32_16x16x32_bf16 v[140:143], v[60:63], v[28:31], v[140:143]
    ds_read_b64_tr_b16 v[48:49], v4 offset:16568
    v_mfma_f32_16x16x32_bf16 v[80:83], v[60:63], v[24:27], v[80:83]
    ds_read_b64_tr_b16 v[50:51], v4 offset:24248
    s_waitcnt lgkmcnt(10)
    v_mfma_f32_16x16x32_bf16 v[84:87], v[64:67], v[24:27], v[84:87]
    ds_read_b64_tr_b16 v[52:53], v4 offset:16576
    v_mfma_f32_16x16x32_bf16 v[144:147], v[64:67], v[28:31], v[144:147]
    ds_read_b64_tr_b16 v[54:55], v4 offset:24256
    v_mfma_f32_16x16x32_bf16 v[204:207], v[64:67], v[32:35], v[204:207]
    ds_read_b64_tr_b16 v[56:57], v4 offset:16704
    v_mfma_f32_16x16x32_bf16 v[208:211], v[68:71], v[32:35], v[208:211]
    ds_read_b64_tr_b16 v[58:59], v4 offset:24384
    v_mfma_f32_16x16x32_bf16 v[148:151], v[68:71], v[28:31], v[148:151]
    ds_read_b64_tr_b16 v[60:61], v4 offset:16712
    v_mfma_f32_16x16x32_bf16 v[88:91], v[68:71], v[24:27], v[88:91]
    ds_read_b64_tr_b16 v[62:63], v4 offset:24392
    s_waitcnt lgkmcnt(10)
    v_mfma_f32_16x16x32_bf16 v[92:95], v[72:75], v[24:27], v[92:95]
    ds_read_b64_tr_b16 v[64:65], v4 offset:16720
    v_mfma_f32_16x16x32_bf16 v[152:155], v[72:75], v[28:31], v[152:155]
    ds_read_b64_tr_b16 v[66:67], v4 offset:24400
    v_mfma_f32_16x16x32_bf16 v[212:215], v[72:75], v[32:35], v[212:215]
    ds_read_b64_tr_b16 v[68:69], v4 offset:16728
    v_mfma_f32_16x16x32_bf16 v[216:219], v[36:39], v[32:35], v[216:219]
    ds_read_b64_tr_b16 v[70:71], v4 offset:24408
    v_mfma_f32_16x16x32_bf16 v[156:159], v[36:39], v[28:31], v[156:159]
    ds_read_b64_tr_b16 v[72:73], v4 offset:16736
    v_mfma_f32_16x16x32_bf16 v[96:99], v[36:39], v[24:27], v[96:99]
    ds_read_b64_tr_b16 v[74:75], v4 offset:24416
    v_mfma_f32_16x16x32_bf16 v[100:103], v[40:43], v[24:27], v[100:103]
    v_mfma_f32_16x16x32_bf16 v[160:163], v[40:43], v[28:31], v[160:163]
    v_mfma_f32_16x16x32_bf16 v[220:223], v[40:43], v[32:35], v[220:223]
    s_waitcnt lgkmcnt(7)
    v_mfma_f32_16x16x32_bf16 v[224:227], v[44:47], v[32:35], v[224:227]
    v_mfma_f32_16x16x32_bf16 v[164:167], v[44:47], v[28:31], v[164:167]
    v_mfma_f32_16x16x32_bf16 v[104:107], v[44:47], v[24:27], v[104:107]
    v_mfma_f32_16x16x32_bf16 v[108:111], v[48:51], v[24:27], v[108:111]
    v_mfma_f32_16x16x32_bf16 v[168:171], v[48:51], v[28:31], v[168:171]
    v_mfma_f32_16x16x32_bf16 v[228:231], v[48:51], v[32:35], v[228:231]
    v_mfma_f32_16x16x32_bf16 v[232:235], v[52:55], v[32:35], v[232:235]
    v_mfma_f32_16x16x32_bf16 v[172:175], v[52:55], v[28:31], v[172:175]
    v_mfma_f32_16x16x32_bf16 v[112:115], v[52:55], v[24:27], v[112:115]
    v_mov_b32 v6, 0x26c10
    v_mov_b32 v7, 1
    s_mov_b64 exec, 1
    ds_add_u32 v6, v7
    s_mov_b64 exec, -1
    ds_read_b96 v[2:4], v5
    ds_read_b64 v[6:7], v11 offset:0
    ds_read_b64 v[8:9], v11 offset:16
    ds_read_b64 v[10:11], v11 offset:32
    ds_read_b128 v[12:15], v0 offset:640
    ds_read_b128 v[16:19], v0 offset:656
    ds_read_b128 v[20:23], v0 offset:672
    v_mfma_f32_16x16x32_bf16 v[116:119], v[56:59], v[24:27], v[116:119]
    v_mfma_f32_16x16x32_bf16 v[176:179], v[56:59], v[28:31], v[176:179]
    v_mfma_f32_16x16x32_bf16 v[236:239], v[56:59], v[32:35], v[236:239]
    s_waitcnt lgkmcnt(8)
    v_mfma_f32_16x16x32_bf16 v[240:243], v[60:63], v[32:35], v[240:243]
    v_mfma_f32_16x16x32_bf16 v[180:183], v[60:63], v[28:31], v[180:183]
    v_mfma_f32_16x16x32_bf16 v[120:123], v[60:63], v[24:27], v[120:123]
    v_mfma_f32_16x16x32_bf16 v[124:127], v[64:67], v[24:27], v[124:127]
    v_mfma_f32_16x16x32_bf16 v[184:187], v[64:67], v[28:31], v[184:187]
    v_mfma_f32_16x16x32_bf16 v[244:247], v[64:67], v[32:35], v[244:247]
    v_mfma_f32_16x16x32_bf16 v[248:251], v[68:71], v[32:35], v[248:251]
    v_mfma_f32_16x16x32_bf16 v[188:191], v[68:71], v[28:31], v[188:191]
    v_mfma_f32_16x16x32_bf16 v[128:131], v[68:71], v[24:27], v[128:131]
    v_mfma_f32_16x16x32_bf16 v[132:135], v[72:75], v[24:27], v[132:135]
    v_mfma_f32_16x16x32_bf16 v[192:195], v[72:75], v[28:31], v[192:195]
    v_mfma_f32_16x16x32_bf16 v[252:255], v[72:75], v[32:35], v[252:255]
    s_setprio 3
    ds_read_b128 v[24:27], v0 offset:688
    ds_read_b128 v[28:31], v0 offset:704
    ds_read_b128 v[32:35], v0 offset:320
    ds_read_b128 v[36:39], v0 offset:336
    ds_read_b128 v[40:43], v0 offset:352
    ds_read_b128 v[44:47], v0 offset:368
    ds_read_b128 v[48:51], v0 offset:384
    ds_read_b128 v[52:55], v0 offset:0
    ds_read_b128 v[56:59], v0 offset:16
    ds_read_b128 v[60:63], v0 offset:32
    ds_read_b128 v[64:67], v0 offset:48
    ds_read_b128 v[68:71], v0 offset:64
    v_mov_b32 v74, 0x26c10
    ds_read_b32 v75, v74
    s_waitcnt lgkmcnt(11)
    v_pk_fma_f32 v[116:117], v[12:13], v[6:7], v[116:117] op_sel_hi:[1,0,1]
    v_pk_fma_f32 v[118:119], v[14:15], v[6:7], v[118:119] op_sel_hi:[1,0,1]
    v_pk_fma_f32 v[120:121], v[16:17], v[6:7], v[120:121] op_sel_hi:[1,0,1]
    v_pk_fma_f32 v[122:123], v[18:19], v[6:7], v[122:123] op_sel_hi:[1,0,1]
    v_pk_fma_f32 v[124:125], v[20:21], v[6:7], v[124:125] op_sel_hi:[1,0,1]
    v_pk_fma_f32 v[126:127], v[22:23], v[6:7], v[126:127] op_sel_hi:[1,0,1]
    v_pk_fma_f32 v[128:129], v[24:25], v[6:7], v[128:129] op_sel_hi:[1,0,1]
    v_pk_fma_f32 v[130:131], v[26:27], v[6:7], v[130:131] op_sel_hi:[1,0,1]
    v_pk_fma_f32 v[132:133], v[28:29], v[6:7], v[132:133] op_sel_hi:[1,0,1]
    v_pk_fma_f32 v[134:135], v[30:31], v[6:7], v[134:135] op_sel_hi:[1,0,1]
    v_pk_mul_f32 v[116:117], v[116:117], v[6:7] op_sel:[0,1] op_sel_hi:[1,1]
    v_pk_mul_f32 v[118:119], v[118:119], v[6:7] op_sel:[0,1] op_sel_hi:[1,1]
    ds_write_b128 v3, v[116:119] offset:40160
    v_pk_mul_f32 v[120:121], v[120:121], v[6:7] op_sel:[0,1] op_sel_hi:[1,1]
    v_pk_mul_f32 v[122:123], v[122:123], v[6:7] op_sel:[0,1] op_sel_hi:[1,1]
    ds_write_b128 v4, v[120:123] offset:224
    v_pk_mul_f32 v[124:125], v[124:125], v[6:7] op_sel:[0,1] op_sel_hi:[1,1]
    v_pk_mul_f32 v[126:127], v[126:127], v[6:7] op_sel:[0,1] op_sel_hi:[1,1]
    ds_write_b128 v4, v[124:127] offset:13536
    v_pk_mul_f32 v[128:129], v[128:129], v[6:7] op_sel:[0,1] op_sel_hi:[1,1]
    v_pk_mul_f32 v[130:131], v[130:131], v[6:7] op_sel:[0,1] op_sel_hi:[1,1]
    ds_write_b128 v4, v[128:131] offset:26848
    v_pk_mul_f32 v[132:133], v[132:133], v[6:7] op_sel:[0,1] op_sel_hi:[1,1]
    v_pk_mul_f32 v[134:135], v[134:135], v[6:7] op_sel:[0,1] op_sel_hi:[1,1]
    ds_write_b128 v4, v[132:135] offset:40160
    v_pk_fma_f32 v[176:177], v[12:13], v[8:9], v[176:177] op_sel_hi:[1,0,1]
    v_pk_fma_f32 v[178:179], v[14:15], v[8:9], v[178:179] op_sel_hi:[1,0,1]
    v_pk_fma_f32 v[180:181], v[16:17], v[8:9], v[180:181] op_sel_hi:[1,0,1]
    v_pk_fma_f32 v[182:183], v[18:19], v[8:9], v[182:183] op_sel_hi:[1,0,1]
    v_pk_fma_f32 v[184:185], v[20:21], v[8:9], v[184:185] op_sel_hi:[1,0,1]
    v_pk_fma_f32 v[186:187], v[22:23], v[8:9], v[186:187] op_sel_hi:[1,0,1]
    v_pk_fma_f32 v[188:189], v[24:25], v[8:9], v[188:189] op_sel_hi:[1,0,1]
    v_pk_fma_f32 v[190:191], v[26:27], v[8:9], v[190:191] op_sel_hi:[1,0,1]
    v_pk_fma_f32 v[192:193], v[28:29], v[8:9], v[192:193] op_sel_hi:[1,0,1]
    v_pk_fma_f32 v[194:195], v[30:31], v[8:9], v[194:195] op_sel_hi:[1,0,1]
    v_pk_mul_f32 v[176:177], v[176:177], v[8:9] op_sel:[0,1] op_sel_hi:[1,1]
    v_pk_mul_f32 v[178:179], v[178:179], v[8:9] op_sel:[0,1] op_sel_hi:[1,1]
    ds_write_b128 v3, v[176:179] offset:40192
    v_pk_mul_f32 v[180:181], v[180:181], v[8:9] op_sel:[0,1] op_sel_hi:[1,1]
    v_pk_mul_f32 v[182:183], v[182:183], v[8:9] op_sel:[0,1] op_sel_hi:[1,1]
    ds_write_b128 v4, v[180:183] offset:256
    v_pk_mul_f32 v[184:185], v[184:185], v[8:9] op_sel:[0,1] op_sel_hi:[1,1]
    v_pk_mul_f32 v[186:187], v[186:187], v[8:9] op_sel:[0,1] op_sel_hi:[1,1]
    ds_write_b128 v4, v[184:187] offset:13568
    v_pk_mul_f32 v[188:189], v[188:189], v[8:9] op_sel:[0,1] op_sel_hi:[1,1]
    v_pk_mul_f32 v[190:191], v[190:191], v[8:9] op_sel:[0,1] op_sel_hi:[1,1]
    ds_write_b128 v4, v[188:191] offset:26880
    v_pk_mul_f32 v[192:193], v[192:193], v[8:9] op_sel:[0,1] op_sel_hi:[1,1]
    v_pk_mul_f32 v[194:195], v[194:195], v[8:9] op_sel:[0,1] op_sel_hi:[1,1]
    ds_write_b128 v4, v[192:195] offset:40192
    v_pk_fma_f32 v[236:237], v[12:13], v[10:11], v[236:237] op_sel_hi:[1,0,1]
    v_pk_fma_f32 v[238:239], v[14:15], v[10:11], v[238:239] op_sel_hi:[1,0,1]
    v_pk_fma_f32 v[240:241], v[16:17], v[10:11], v[240:241] op_sel_hi:[1,0,1]
    v_pk_fma_f32 v[242:243], v[18:19], v[10:11], v[242:243] op_sel_hi:[1,0,1]
    v_pk_fma_f32 v[244:245], v[20:21], v[10:11], v[244:245] op_sel_hi:[1,0,1]
    v_pk_fma_f32 v[246:247], v[22:23], v[10:11], v[246:247] op_sel_hi:[1,0,1]
    v_pk_fma_f32 v[248:249], v[24:25], v[10:11], v[248:249] op_sel_hi:[1,0,1]
    v_pk_fma_f32 v[250:251], v[26:27], v[10:11], v[250:251] op_sel_hi:[1,0,1]
    v_pk_fma_f32 v[252:253], v[28:29], v[10:11], v[252:253] op_sel_hi:[1,0,1]
    v_pk_fma_f32 v[254:255], v[30:31], v[10:11], v[254:255] op_sel_hi:[1,0,1]
    v_pk_mul_f32 v[236:237], v[236:237], v[10:11] op_sel:[0,1] op_sel_hi:[1,1]
    v_pk_mul_f32 v[238:239], v[238:239], v[10:11] op_sel:[0,1] op_sel_hi:[1,1]
    ds_write_b128 v3, v[236:239] offset:40224
    v_pk_mul_f32 v[240:241], v[240:241], v[10:11] op_sel:[0,1] op_sel_hi:[1,1]
    v_pk_mul_f32 v[242:243], v[242:243], v[10:11] op_sel:[0,1] op_sel_hi:[1,1]
    ds_write_b128 v4, v[240:243] offset:288
    v_pk_mul_f32 v[244:245], v[244:245], v[10:11] op_sel:[0,1] op_sel_hi:[1,1]
    v_pk_mul_f32 v[246:247], v[246:247], v[10:11] op_sel:[0,1] op_sel_hi:[1,1]
    ds_write_b128 v4, v[244:247] offset:13600
    v_pk_mul_f32 v[248:249], v[248:249], v[10:11] op_sel:[0,1] op_sel_hi:[1,1]
    v_pk_mul_f32 v[250:251], v[250:251], v[10:11] op_sel:[0,1] op_sel_hi:[1,1]
    ds_write_b128 v4, v[248:251] offset:26912
    v_pk_mul_f32 v[252:253], v[252:253], v[10:11] op_sel:[0,1] op_sel_hi:[1,1]
    v_pk_mul_f32 v[254:255], v[254:255], v[10:11] op_sel:[0,1] op_sel_hi:[1,1]
    ds_write_b128 v4, v[252:255] offset:40224
    s_waitcnt lgkmcnt(15)
    v_readfirstlane_b32 s3, v75
    s_nop 1
    s_cmp_ge_u32 s3, 4
    s_cbranch_scc1 L_rd_71
    s_mov_b32 s100, 0x400000
L_lw_72:
    ds_read_b32 v75, v74
    s_sub_u32 s100, s100, 1
    s_cbranch_scc1 L_lx_73
    s_waitcnt lgkmcnt(0)
    v_readfirstlane_b32 s3, v75
    s_nop 1
    s_cmp_lt_u32 s3, 4
    s_cbranch_scc1 L_lw_72
L_lx_73:
L_rd_71:
    s_or_b32 s53, s49, s48
    s_cbranch_scc1 L_nz_74
    v_lshrrev_b32 v72, 4, v1
    v_mul_u32_u24 v73, 3328, v72
    v_and_b32 v74, 15, v1
    v_lshl_add_u32 v73, v74, 4, v73
    v_add_u32 v72, 53248, v73
    v_mov_b64 v[74:75], 0
    ds_write_b64 v73, v[74:75] offset:0
    ds_write_b64 v73, v[74:75] offset:8
    ds_write_b64 v73, v[74:75] offset:13312
    ds_write_b64 v73, v[74:75] offset:13320
    ds_write_b64 v73, v[74:75] offset:26624
    ds_write_b64 v73, v[74:75] offset:26632
    ds_write_b64 v73, v[74:75] offset:39936
    ds_write_b64 v73, v[74:75] offset:39944
    ds_write_b64 v72, v[74:75] offset:0
    ds_write_b64 v72, v[74:75] offset:8
    ds_write_b64 v72, v[74:75] offset:13312
    ds_write_b64 v72, v[74:75] offset:13320
    ds_write_b64 v72, v[74:75] offset:26624
    ds_write_b64 v72, v[74:75] offset:26632
    ds_write_b64 v72, v[74:75] offset:39936
    ds_write_b64 v72, v[74:75] offset:39944
L_nz_74:
    v_pk_fma_f32 v[96:97], v[32:33], v[6:7], v[96:97] op_sel_hi:[1,0,1]
    v_pk_fma_f32 v[98:99], v[34:35], v[6:7], v[98:99] op_sel_hi:[1,0,1]
    v_pk_fma_f32 v[100:101], v[36:37], v[6:7], v[100:101] op_sel_hi:[1,0,1]
    v_pk_fma_f32 v[102:103], v[38:39], v[6:7], v[102:103] op_sel_hi:[1,0,1]
    v_pk_fma_f32 v[104:105], v[40:41], v[6:7], v[104:105] op_sel_hi:[1,0,1]
    v_pk_fma_f32 v[106:107], v[42:43], v[6:7], v[106:107] op_sel_hi:[1,0,1]
    v_pk_fma_f32 v[108:109], v[44:45], v[6:7], v[108:109] op_sel_hi:[1,0,1]
    v_pk_fma_f32 v[110:111], v[46:47], v[6:7], v[110:111] op_sel_hi:[1,0,1]
    v_pk_fma_f32 v[112:113], v[48:49], v[6:7], v[112:113] op_sel_hi:[1,0,1]
    v_pk_fma_f32 v[114:115], v[50:51], v[6:7], v[114:115] op_sel_hi:[1,0,1]
    v_pk_mul_f32 v[96:97], v[96:97], v[6:7] op_sel:[0,1] op_sel_hi:[1,1]
    v_pk_mul_f32 v[98:99], v[98:99], v[6:7] op_sel:[0,1] op_sel_hi:[1,1]
    v_pk_mul_f32 v[100:101], v[100:101], v[6:7] op_sel:[0,1] op_sel_hi:[1,1]
    v_pk_mul_f32 v[102:103], v[102:103], v[6:7] op_sel:[0,1] op_sel_hi:[1,1]
    v_pk_mul_f32 v[104:105], v[104:105], v[6:7] op_sel:[0,1] op_sel_hi:[1,1]
    v_pk_mul_f32 v[106:107], v[106:107], v[6:7] op_sel:[0,1] op_sel_hi:[1,1]
    v_pk_mul_f32 v[108:109], v[108:109], v[6:7] op_sel:[0,1] op_sel_hi:[1,1]
    v_pk_mul_f32 v[110:111], v[110:111], v[6:7] op_sel:[0,1] op_sel_hi:[1,1]
    v_pk_mul_f32 v[112:113], v[112:113], v[6:7] op_sel:[0,1] op_sel_hi:[1,1]
    v_pk_mul_f32 v[114:115], v[114:115], v[6:7] op_sel:[0,1] op_sel_hi:[1,1]
    v_cvt_pk_bf16_f32 v96, v96, v97
    v_cvt_pk_bf16_f32 v97, v98, v99
    v_cvt_pk_bf16_f32 v98, v100, v101
    v_cvt_pk_bf16_f32 v99, v102, v103
    v_cvt_pk_bf16_f32 v100, v104, v105
    v_cvt_pk_bf16_f32 v101, v106, v107
    v_cvt_pk_bf16_f32 v102, v108, v109
    v_cvt_pk_bf16_f32 v103, v110, v111
    v_cvt_pk_bf16_f32 v104, v112, v113
    v_cvt_pk_bf16_f32 v105, v114, v115
    ds_write_b128 v3, v[96:99] offset:224
    ds_write_b128 v3, v[100:103] offset:13536
    ds_write_b64 v3, v[104:105] offset:26848
    v_pk_fma_f32 v[156:157], v[32:33], v[8:9], v[156:157] op_sel_hi:[1,0,1]
    v_pk_fma_f32 v[158:159], v[34:35], v[8:9], v[158:159] op_sel_hi:[1,0,1]
    v_pk_fma_f32 v[160:161], v[36:37], v[8:9], v[160:161] op_sel_hi:[1,0,1]
    v_pk_fma_f32 v[162:163], v[38:39], v[8:9], v[162:163] op_sel_hi:[1,0,1]
    v_pk_fma_f32 v[164:165], v[40:41], v[8:9], v[164:165] op_sel_hi:[1,0,1]
    v_pk_fma_f32 v[166:167], v[42:43], v[8:9], v[166:167] op_sel_hi:[1,0,1]
    v_pk_fma_f32 v[168:169], v[44:45], v[8:9], v[168:169] op_sel_hi:[1,0,1]
    v_pk_fma_f32 v[170:171], v[46:47], v[8:9], v[170:171] op_sel_hi:[1,0,1]
    v_pk_fma_f32 v[172:173], v[48:49], v[8:9], v[172:173] op_sel_hi:[1,0,1]
    v_pk_fma_f32 v[174:175], v[50:51], v[8:9], v[174:175] op_sel_hi:[1,0,1]
    v_pk_mul_f32 v[156:157], v[156:157], v[8:9] op_sel:[0,1] op_sel_hi:[1,1]
    v_pk_mul_f32 v[158:159], v[158:159], v[8:9] op_sel:[0,1] op_sel_hi:[1,1]
    v_pk_mul_f32 v[160:161], v[160:161], v[8:9] op_sel:[0,1] op_sel_hi:[1,1]
    v_pk_mul_f32 v[162:163], v[162:163], v[8:9] op_sel:[0,1] op_sel_hi:[1,1]
    v_pk_mul_f32 v[164:165], v[164:165], v[8:9] op_sel:[0,1] op_sel_hi:[1,1]
    v_pk_mul_f32 v[166:167], v[166:167], v[8:9] op_sel:[0,1] op_sel_hi:[1,1]
    v_pk_mul_f32 v[168:169], v[168:169], v[8:9] op_sel:[0,1] op_sel_hi:[1,1]
    v_pk_mul_f32 v[170:171], v[170:171], v[8:9] op_sel:[0,1] op_sel_hi:[1,1]
    v_pk_mul_f32 v[172:173], v[172:173], v[8:9] op_sel:[0,1] op_sel_hi:[1,1]
    v_pk_mul_f32 v[174:175], v[174:175], v[8:9] op_sel:[0,1] op_sel_hi:[1,1]
    v_cvt_pk_bf16_f32 v156, v156, v157
    v_cvt_pk_bf16_f32 v157, v158, v159
    v_cvt_pk_bf16_f32 v158, v160, v161
    v_cvt_pk_bf16_f32 v159, v162, v163
    v_cvt_pk_bf16_f32 v160, v164, v165
    v_cvt_pk_bf16_f32 v161, v166, v167
    v_cvt_pk_bf16_f32 v162, v168, v169
    v_cvt_pk_bf16_f32 v163, v170, v171
    v_cvt_pk_bf16_f32 v164, v172, v173
    v_cvt_pk_bf16_f32 v165, v174, v175
    ds_write_b128 v3, v[156:159] offset:256
    ds_write_b128 v3, v[160:163] offset:13568
    ds_write_b64 v3, v[164:165] offset:26880
    v_pk_fma_f32 v[216:217], v[32:33], v[10:11], v[216:217] op_sel_hi:[1,0,1]
    v_pk_fma_f32 v[218:219], v[34:35], v[10:11], v[218:219] op_sel_hi:[1,0,1]
    v_pk_fma_f32 v[220:221], v[36:37], v[10:11], v[220:221] op_sel_hi:[1,0,1]
    v_pk_fma_f32 v[222:223], v[38:39], v[10:11], v[222:223] op_sel_hi:[1,0,1]
    v_pk_fma_f32 v[224:225], v[40:41], v[10:11], v[224:225] op_sel_hi:[1,0,1]
    v_pk_fma_f32 v[226:227], v[42:43], v[10:11], v[226:227] op_sel_hi:[1,0,1]
    v_pk_fma_f32 v[228:229], v[44:45], v[10:11], v[228:229] op_sel_hi:[1,0,1]
    v_pk_fma_f32 v[230:231], v[46:47], v[10:11], v[230:231] op_sel_hi:[1,0,1]
    v_pk_fma_f32 v[232:233], v[48:49], v[10:11], v[232:233] op_sel_hi:[1,0,1]
    v_pk_fma_f32 v[234:235], v[50:51], v[10:11], v[234:235] op_sel_hi:[1,0,1]
    v_pk_mul_f32 v[216:217], v[216:217], v[10:11] op_sel:[0,1] op_sel_hi:[1,1]
    v_pk_mul_f32 v[218:219], v[218:219], v[10:11] op_sel:[0,1] op_sel_hi:[1,1]
    v_pk_mul_f32 v[220:221], v[220:221], v[10:11] op_sel:[0,1] op_sel_hi:[1,1]
    v_pk_mul_f32 v[222:223], v[222:223], v[10:11] op_sel:[0,1] op_sel_hi:[1,1]
    v_pk_mul_f32 v[224:225], v[224:225], v[10:11] op_sel:[0,1] op_sel_hi:[1,1]
    v_pk_mul_f32 v[226:227], v[226:227], v[10:11] op_sel:[0,1] op_sel_hi:[1,1]
    v_pk_mul_f32 v[228:229], v[228:229], v[10:11] op_sel:[0,1] op_sel_hi:[1,1]
    v_pk_mul_f32 v[230:231], v[230:231], v[10:11] op_sel:[0,1] op_sel_hi:[1,1]
    v_pk_mul_f32 v[232:233], v[232:233], v[10:11] op_sel:[0,1] op_sel_hi:[1,1]
    v_pk_mul_f32 v[234:235], v[234:235], v[10:11] op_sel:[0,1] op_sel_hi:[1,1]
    v_cvt_pk_bf16_f32 v216, v216, v217
    v_cvt_pk_bf16_f32 v217, v218, v219
    v_cvt_pk_bf16_f32 v218, v220, v221
    v_cvt_pk_bf16_f32 v219, v222, v223
    v_cvt_pk_bf16_f32 v220, v224, v225
    v_cvt_pk_bf16_f32 v221, v226, v227
    v_cvt_pk_bf16_f32 v222, v228, v229
    v_cvt_pk_bf16_f32 v223, v230, v231
    v_cvt_pk_bf16_f32 v224, v232, v233
    v_cvt_pk_bf16_f32 v225, v234, v235
    ds_write_b128 v3, v[216:219] offset:288
    ds_write_b128 v3, v[220:223] offset:13600
    ds_write_b64 v3, v[224:225] offset:26912
    v_mov_b32 v72, 0x26c04
    v_mov_b32 v73, 1
    s_mov_b64 exec, 1
    ds_add_u32 v72, v73
    s_mov_b64 exec, -1
    v_pk_fma_f32 v[76:77], v[52:53], v[6:7], v[76:77] op_sel_hi:[1,0,1]
    v_pk_fma_f32 v[78:79], v[54:55], v[6:7], v[78:79] op_sel_hi:[1,0,1]
    v_pk_fma_f32 v[80:81], v[56:57], v[6:7], v[80:81] op_sel_hi:[1,0,1]
    v_pk_fma_f32 v[82:83], v[58:59], v[6:7], v[82:83] op_sel_hi:[1,0,1]
    v_pk_fma_f32 v[84:85], v[60:61], v[6:7], v[84:85] op_sel_hi:[1,0,1]
    v_pk_fma_f32 v[86:87], v[62:63], v[6:7], v[86:87] op_sel_hi:[1,0,1]
    v_pk_fma_f32 v[88:89], v[64:65], v[6:7], v[88:89] op_sel_hi:[1,0,1]
    v_pk_fma_f32 v[90:91], v[66:67], v[6:7], v[90:91] op_sel_hi:[1,0,1]
    v_pk_fma_f32 v[92:93], v[68:69], v[6:7], v[92:93] op_sel_hi:[1,0,1]
    v_pk_fma_f32 v[94:95], v[70:71], v[6:7], v[94:95] op_sel_hi:[1,0,1]
    v_cvt_pk_bf16_f32 v76, v76, v77
    v_cvt_pk_bf16_f32 v77, v78, v79
    v_cvt_pk_bf16_f32 v78, v80, v81
    v_cvt_pk_bf16_f32 v79, v82, v83
    v_cvt_pk_bf16_f32 v80, v84, v85
    v_cvt_pk_bf16_f32 v81, v86, v87
    v_cvt_pk_bf16_f32 v82, v88, v89
    v_cvt_pk_bf16_f32 v83, v90, v91
    v_cvt_pk_bf16_f32 v84, v92, v93
    v_cvt_pk_bf16_f32 v85, v94, v95
    v_mul_f32 v94, 0x3ea52b5c, v7
    v_pk_fma_f32 v[136:137], v[52:53], v[8:9], v[136:137] op_sel_hi:[1,0,1]
    v_pk_fma_f32 v[138:139], v[54:55], v[8:9], v[138:139] op_sel_hi:[1,0,1]
    v_pk_fma_f32 v[140:141], v[56:57], v[8:9], v[140:141] op_sel_hi:[1,0,1]
    v_pk_fma_f32 v[142:143], v[58:59], v[8:9], v[142:143] op_sel_hi:[1,0,1]
    v_pk_fma_f32 v[144:145], v[60:61], v[8:9], v[144:145] op_sel_hi:[1,0,1]
    v_pk_fma_f32 v[146:147], v[62:63], v[8:9], v[146:147] op_sel_hi:[1,0,1]
    v_pk_fma_f32 v[148:149], v[64:65], v[8:9], v[148:149] op_sel_hi:[1,0,1]
    v_pk_fma_f32 v[150:151], v[66:67], v[8:9], v[150:151] op_sel_hi:[1,0,1]
    v_pk_fma_f32 v[152:153], v[68:69], v[8:9], v[152:153] op_sel_hi:[1,0,1]
    v_pk_fma_f32 v[154:155], v[70:71], v[8:9], v[154:155] op_sel_hi:[1,0,1]
    v_cvt_pk_bf16_f32 v136, v136, v137
    v_cvt_pk_bf16_f32 v137, v138, v139
    v_cvt_pk_bf16_f32 v138, v140, v141
    v_cvt_pk_bf16_f32 v139, v142, v143
    v_cvt_pk_bf16_f32 v140, v144, v145
    v_cvt_pk_bf16_f32 v141, v146, v147
    v_cvt_pk_bf16_f32 v142, v148, v149
    v_cvt_pk_bf16_f32 v143, v150, v151
    v_cvt_pk_bf16_f32 v144, v152, v153
    v_cvt_pk_bf16_f32 v145, v154, v155
    v_mul_f32 v154, 0x3ea52b5c, v9
    v_pk_fma_f32 v[196:197], v[52:53], v[10:11], v[196:197] op_sel_hi:[1,0,1]
    v_pk_fma_f32 v[198:199], v[54:55], v[10:11], v[198:199] op_sel_hi:[1,0,1]
    v_pk_fma_f32 v[200:201], v[56:57], v[10:11], v[200:201] op_sel_hi:[1,0,1]
    v_pk_fma_f32 v[202:203], v[58:59], v[10:11], v[202:203] op_sel_hi:[1,0,1]
    v_pk_fma_f32 v[204:205], v[60:61], v[10:11], v[204:205] op_sel_hi:[1,0,1]
    v_pk_fma_f32 v[206:207], v[62:63], v[10:11], v[206:207] op_sel_hi:[1,0,1]
    v_pk_fma_f32 v[208:209], v[64:65], v[10:11], v[208:209] op_sel_hi:[1,0,1]
    v_pk_fma_f32 v[210:211], v[66:67], v[10:11], v[210:211] op_sel_hi:[1,0,1]
    v_pk_fma_f32 v[212:213], v[68:69], v[10:11], v[212:213] op_sel_hi:[1,0,1]
    v_pk_fma_f32 v[214:215], v[70:71], v[10:11], v[214:215] op_sel_hi:[1,0,1]
    v_cvt_pk_bf16_f32 v196, v196, v197
    v_cvt_pk_bf16_f32 v197, v198, v199
    v_cvt_pk_bf16_f32 v198, v200, v201
    v_cvt_pk_bf16_f32 v199, v202, v203
    v_cvt_pk_bf16_f32 v200, v204, v205
    v_cvt_pk_bf16_f32 v201, v206, v207
    v_cvt_pk_bf16_f32 v202, v208, v209
    v_cvt_pk_bf16_f32 v203, v210, v211
    v_cvt_pk_bf16_f32 v204, v212, v213
    v_cvt_pk_bf16_f32 v205, v214, v215
    v_mul_f32 v214, 0x3ea52b5c, v11
    s_mov_b32 s100, 0x400000
L_lw_75:
    ds_read_b32 v73, v72
    s_sub_u32 s100, s100, 1
    s_cbranch_scc1 L_lx_76
    s_waitcnt lgkmcnt(0)
    v_readfirstlane_b32 s3, v73
    s_nop 1
    s_cmp_lt_u32 s3, 4
    s_cbranch_scc1 L_lw_75
L_lx_76:
    ds_read_b128 v[66:69], v3 offset:192
    ds_read_b128 v[70:73], v3 offset:13504
    ds_read_b64 v[74:75], v3 offset:26816
    ds_read_b128 v[56:59], v3 offset:160
    ds_read_b128 v[60:63], v3 offset:13472
    ds_read_b64 v[64:65], v3 offset:26784
    ds_read_b128 v[46:49], v3 offset:128
    ds_read_b128 v[50:53], v3 offset:13440
    ds_read_b64 v[54:55], v3 offset:26752
    ds_read_b128 v[36:39], v3 offset:96
    ds_read_b128 v[40:43], v3 offset:13408
    ds_read_b64 v[44:45], v3 offset:26720
    ds_read_b128 v[26:29], v3 offset:64
    ds_read_b128 v[30:33], v3 offset:13376
    ds_read_b64 v[34:35], v3 offset:26688
    ds_read_b128 v[16:19], v3 offset:32
    ds_read_b128 v[20:23], v3 offset:13344
    ds_read_b64 v[24:25], v3 offset:26656
    ds_read_b128 v[6:9], v3 offset:0
    ds_read_b128 v[10:13], v3 offset:13312
    ds_read_b64 v[14:15], v3 offset:26624
    v_dot2_f32_bf16 v206, v196, v216, 0
    s_nop 2
    v_dot2c_f32_bf16 v206, v197, v217
    v_dot2c_f32_bf16 v206, v198, v218
    v_dot2c_f32_bf16 v206, v199, v219
    v_dot2c_f32_bf16 v206, v200, v220
    v_dot2c_f32_bf16 v206, v201, v221
    v_dot2c_f32_bf16 v206, v202, v222
    v_dot2c_f32_bf16 v206, v203, v223
    v_dot2c_f32_bf16 v206, v204, v224
    v_dot2c_f32_bf16 v206, v205, v225
    v_dot2_f32_bf16 v146, v136, v156, 0
    v_dot2_f32_bf16 v207, v196, v156, 0
    s_nop 1
    v_dot2c_f32_bf16 v146, v137, v157
    v_dot2c_f32_bf16 v207, v197, v157
    v_dot2c_f32_bf16 v146, v138, v158
    v_dot2c_f32_bf16 v207, v198, v158
    v_dot2c_f32_bf16 v146, v139, v159
    v_dot2c_f32_bf16 v207, v199, v159
    v_dot2c_f32_bf16 v146, v140, v160
    v_dot2c_f32_bf16 v207, v200, v160
    v_dot2c_f32_bf16 v146, v141, v161
    v_dot2c_f32_bf16 v207, v201, v161
    v_dot2c_f32_bf16 v146, v142, v162
    v_dot2c_f32_bf16 v207, v202, v162
    v_dot2c_f32_bf16 v146, v143, v163
    v_dot2c_f32_bf16 v207, v203, v163
    v_dot2c_f32_bf16 v146, v144, v164
    v_dot2c_f32_bf16 v207, v204, v164
    v_dot2c_f32_bf16 v146, v145, v165
    v_dot2c_f32_bf16 v207, v205, v165
    v_dot2_f32_bf16 v86, v76, v96, 0
    v_dot2_f32_bf16 v147, v136, v96, 0
    v_dot2_f32_bf16 v208, v196, v96, 0
    s_nop 0
    v_dot2c_f32_bf16 v86, v77, v97
    v_dot2c_f32_bf16 v147, v137, v97
    v_dot2c_f32_bf16 v208, v197, v97
    v_dot2c_f32_bf16 v86, v78, v98
    v_dot2c_f32_bf16 v147, v138, v98
    v_dot2c_f32_bf16 v208, v198, v98
    v_dot2c_f32_bf16 v86, v79, v99
    v_dot2c_f32_bf16 v147, v139, v99
    v_dot2c_f32_bf16 v208, v199, v99
    v_dot2c_f32_bf16 v86, v80, v100
    v_dot2c_f32_bf16 v147, v140, v100
    v_dot2c_f32_bf16 v208, v200, v100
    v_dot2c_f32_bf16 v86, v81, v101
    v_dot2c_f32_bf16 v147, v141, v101
    v_dot2c_f32_bf16 v208, v201, v101
    v_dot2c_f32_bf16 v86, v82, v102
    v_dot2c_f32_bf16 v147, v142, v102
    v_dot2c_f32_bf16 v208, v202, v102
    v_dot2c_f32_bf16 v86, v83, v103
    v_dot2c_f32_bf16 v147, v143, v103
    v_dot2c_f32_bf16 v208, v203, v103
    v_dot2c_f32_bf16 v86, v84, v104
    v_dot2c_f32_bf16 v147, v144, v104
    v_dot2c_f32_bf16 v208, v204, v104
    v_dot2c_f32_bf16 v86, v85, v105
    v_dot2c_f32_bf16 v147, v145, v105
    v_dot2c_f32_bf16 v208, v205, v105
    s_waitcnt lgkmcnt(15)
    v_dot2_f32_bf16 v87, v76, v66, 0
    v_dot2_f32_bf16 v148, v136, v66, 0
    v_dot2_f32_bf16 v209, v196, v66, 0
    s_nop 0
    v_dot2c_f32_bf16 v87, v77, v67
    v_dot2c_f32_bf16 v148, v137, v67
    v_dot2c_f32_bf16 v209, v197, v67
    v_dot2c_f32_bf16 v87, v78, v68
    v_dot2c_f32_bf16 v148, v138, v68
    v_dot2c_f32_bf16 v209, v198, v68
    v_dot2c_f32_bf16 v87, v79, v69
    v_dot2c_f32_bf16 v148, v139, v69
    v_dot2c_f32_bf16 v209, v199, v69
    v_dot2c_f32_bf16 v87, v80, v70
    v_dot2c_f32_bf16 v148, v140, v70
    v_dot2c_f32_bf16 v209, v200, v70
    v_dot2c_f32_bf16 v87, v81, v71
    v_dot2c_f32_bf16 v148, v141, v71
    v_dot2c_f32_bf16 v209, v201, v71
    v_dot2c_f32_bf16 v87, v82, v72
    v_dot2c_f32_bf16 v148, v142, v72
    v_dot2c_f32_bf16 v209, v202, v72
    v_dot2c_f32_bf16 v87, v83, v73
    v_dot2c_f32_bf16 v148, v143, v73
    v_dot2c_f32_bf16 v209, v203, v73
    v_dot2c_f32_bf16 v87, v84, v74
    v_dot2c_f32_bf16 v148, v144, v74
    v_dot2c_f32_bf16 v209, v204, v74
    v_dot2c_f32_bf16 v87, v85, v75
    v_dot2c_f32_bf16 v148, v145, v75
    v_dot2c_f32_bf16 v209, v205, v75
    s_waitcnt lgkmcnt(15)
    v_dot2_f32_bf16 v88, v76, v56, 0
    v_dot2_f32_bf16 v149, v136, v56, 0
    v_dot2_f32_bf16 v210, v196, v56, 0
    s_nop 0
    v_dot2c_f32_bf16 v88, v77, v57
    v_dot2c_f32_bf16 v149, v137, v57
    v_dot2c_f32_bf16 v210, v197, v57
    v_dot2c_f32_bf16 v88, v78, v58
    v_dot2c_f32_bf16 v149, v138, v58
    v_dot2c_f32_bf16 v210, v198, v58
    v_dot2c_f32_bf16 v88, v79, v59
    v_dot2c_f32_bf16 v149, v139, v59
    v_dot2c_f32_bf16 v210, v199, v59
    v_dot2c_f32_bf16 v88, v80, v60
    v_dot2c_f32_bf16 v149, v140, v60
    v_dot2c_f32_bf16 v210, v200, v60
    v_dot2c_f32_bf16 v88, v81, v61
    v_dot2c_f32_bf16 v149, v141, v61
    v_dot2c_f32_bf16 v210, v201, v61
    v_dot2c_f32_bf16 v88, v82, v62
    v_dot2c_f32_bf16 v149, v142, v62
    v_dot2c_f32_bf16 v210, v202, v62
    v_dot2c_f32_bf16 v88, v83, v63
    v_dot2c_f32_bf16 v149, v143, v63
    v_dot2c_f32_bf16 v210, v203, v63
    v_dot2c_f32_bf16 v88, v84, v64
    v_dot2c_f32_bf16 v149, v144, v64
    v_dot2c_f32_bf16 v210, v204, v64
    v_dot2c_f32_bf16 v88, v85, v65
    v_dot2c_f32_bf16 v149, v145, v65
    v_dot2c_f32_bf16 v210, v205, v65
    s_waitcnt lgkmcnt(12)
    v_dot2_f32_bf16 v89, v76, v46, 0
    v_dot2_f32_bf16 v150, v136, v46, 0
    v_dot2_f32_bf16 v211, v196, v46, 0
    s_nop 0
    v_dot2c_f32_bf16 v89, v77, v47
    v_dot2c_f32_bf16 v150, v137, v47
    v_dot2c_f32_bf16 v211, v197, v47
    v_dot2c_f32_bf16 v89, v78, v48
    v_dot2c_f32_bf16 v150, v138, v48
    v_dot2c_f32_bf16 v211, v198, v48
    v_dot2c_f32_bf16 v89, v79, v49
    v_dot2c_f32_bf16 v150, v139, v49
    v_dot2c_f32_bf16 v211, v199, v49
    v_dot2c_f32_bf16 v89, v80, v50
    v_dot2c_f32_bf16 v150, v140, v50
    v_dot2c_f32_bf16 v211, v200, v50
    v_dot2c_f32_bf16 v89, v81, v51
    v_dot2c_f32_bf16 v150, v141, v51
    v_dot2c_f32_bf16 v211, v201, v51
    v_dot2c_f32_bf16 v89, v82, v52
    v_dot2c_f32_bf16 v150, v142, v52
    v_dot2c_f32_bf16 v211, v202, v52
    v_dot2c_f32_bf16 v89, v83, v53
    v_dot2c_f32_bf16 v150, v143, v53
    v_dot2c_f32_bf16 v211, v203, v53
    v_dot2c_f32_bf16 v89, v84, v54
    v_dot2c_f32_bf16 v150, v144, v54
    v_dot2c_f32_bf16 v211, v204, v54
    v_dot2c_f32_bf16 v89, v85, v55
    v_dot2c_f32_bf16 v150, v145, v55
    v_dot2c_f32_bf16 v211, v205, v55
    s_waitcnt lgkmcnt(9)
    v_dot2_f32_bf16 v90, v76, v36, 0
    v_dot2_f32_bf16 v151, v136, v36, 0
    v_dot2_f32_bf16 v212, v196, v36, 0
    s_nop 0
    v_dot2c_f32_bf16 v90, v77, v37
    v_dot2c_f32_bf16 v151, v137, v37
    v_dot2c_f32_bf16 v212, v197, v37
    v_dot2c_f32_bf16 v90, v78, v38
    v_dot2c_f32_bf16 v151, v138, v38
    v_dot2c_f32_bf16 v212, v198, v38
    v_dot2c_f32_bf16 v90, v79, v39
    v_dot2c_f32_bf16 v151, v139, v39
    v_dot2c_f32_bf16 v212, v199, v39
    v_dot2c_f32_bf16 v90, v80, v40
    v_dot2c_f32_bf16 v151, v140, v40
    v_dot2c_f32_bf16 v212, v200, v40
    v_dot2c_f32_bf16 v90, v81, v41
    v_dot2c_f32_bf16 v151, v141, v41
    v_dot2c_f32_bf16 v212, v201, v41
    v_dot2c_f32_bf16 v90, v82, v42
    v_dot2c_f32_bf16 v151, v142, v42
    v_dot2c_f32_bf16 v212, v202, v42
    v_dot2c_f32_bf16 v90, v83, v43
    v_dot2c_f32_bf16 v151, v143, v43
    v_dot2c_f32_bf16 v212, v203, v43
    v_dot2c_f32_bf16 v90, v84, v44
    v_dot2c_f32_bf16 v151, v144, v44
    v_dot2c_f32_bf16 v212, v204, v44
    v_dot2c_f32_bf16 v90, v85, v45
    v_dot2c_f32_bf16 v151, v145, v45
    v_dot2c_f32_bf16 v212, v205, v45
    s_waitcnt lgkmcnt(6)
    v_dot2_f32_bf16 v91, v76, v26, 0
    v_dot2_f32_bf16 v152, v136, v26, 0
    v_dot2_f32_bf16 v213, v196, v26, 0
    s_nop 0
    v_dot2c_f32_bf16 v91, v77, v27
    v_dot2c_f32_bf16 v152, v137, v27
    v_dot2c_f32_bf16 v213, v197, v27
    v_dot2c_f32_bf16 v91, v78, v28
    v_dot2c_f32_bf16 v152, v138, v28
    v_dot2c_f32_bf16 v213, v198, v28
    v_dot2c_f32_bf16 v91, v79, v29
    v_dot2c_f32_bf16 v152, v139, v29
    v_dot2c_f32_bf16 v213, v199, v29
    v_dot2c_f32_bf16 v91, v80, v30
    v_dot2c_f32_bf16 v152, v140, v30
    v_dot2c_f32_bf16 v213, v200, v30
    v_dot2c_f32_bf16 v91, v81, v31
    v_dot2c_f32_bf16 v152, v141, v31
    v_dot2c_f32_bf16 v213, v201, v31
    v_dot2c_f32_bf16 v91, v82, v32
    v_dot2c_f32_bf16 v152, v142, v32
    v_dot2c_f32_bf16 v213, v202, v32
    v_dot2c_f32_bf16 v91, v83, v33
    v_dot2c_f32_bf16 v152, v143, v33
    v_dot2c_f32_bf16 v213, v203, v33
    v_dot2c_f32_bf16 v91, v84, v34
    v_dot2c_f32_bf16 v152, v144, v34
    v_dot2c_f32_bf16 v213, v204, v34
    v_dot2c_f32_bf16 v91, v85, v35
    v_dot2c_f32_bf16 v152, v145, v35
    v_dot2c_f32_bf16 v213, v205, v35
    s_waitcnt lgkmcnt(3)
    v_dot2_f32_bf16 v92, v76, v16, 0
    v_dot2_f32_bf16 v153, v136, v16, 0
    s_nop 1
    v_dot2c_f32_bf16 v92, v77, v17
    v_dot2c_f32_bf16 v153, v137, v17
    v_dot2c_f32_bf16 v92, v78, v18
    v_dot2c_f32_bf16 v153, v138, v18
    v_dot2c_f32_bf16 v92, v79, v19
    v_dot2c_f32_bf16 v153, v139, v19
    v_dot2c_f32_bf16 v92, v80, v20
    v_dot2c_f32_bf16 v153, v140, v20
    v_dot2c_f32_bf16 v92, v81, v21
    v_dot2c_f32_bf16 v153, v141, v21
    v_dot2c_f32_bf16 v92, v82, v22
    v_dot2c_f32_bf16 v153, v142, v22
    v_dot2c_f32_bf16 v92, v83, v23
    v_dot2c_f32_bf16 v153, v143, v23
    v_dot2c_f32_bf16 v92, v84, v24
    v_dot2c_f32_bf16 v153, v144, v24
    v_dot2c_f32_bf16 v92, v85, v25
    v_dot2c_f32_bf16 v153, v145, v25
    s_waitcnt lgkmcnt(0)
    v_dot2_f32_bf16 v93, v76, v6, 0
    s_nop 2
    v_dot2c_f32_bf16 v93, v77, v7
    v_dot2c_f32_bf16 v93, v78, v8
    v_dot2c_f32_bf16 v93, v79, v9
    v_dot2c_f32_bf16 v93, v80, v10
    v_dot2c_f32_bf16 v93, v81, v11
    v_dot2c_f32_bf16 v93, v82, v12
    v_dot2c_f32_bf16 v93, v83, v13
    v_dot2c_f32_bf16 v93, v84, v14
    v_dot2c_f32_bf16 v93, v85, v15
    ds_read_b128 v[6:9], v3 offset:40128
    ds_read_b128 v[10:13], v4 offset:192
    ds_read_b128 v[14:17], v4 offset:13504
    ds_read_b128 v[18:21], v4 offset:26816
    ds_read_b128 v[22:25], v4 offset:40128
    ds_read_b128 v[26:29], v3 offset:40096
    ds_read_b128 v[30:33], v4 offset:160
    ds_read_b128 v[34:37], v4 offset:13472
    ds_read_b128 v[38:41], v4 offset:26784
    ds_read_b128 v[42:45], v4 offset:40096
    ds_read_b128 v[46:49], v3 offset:40064
    ds_read_b128 v[50:53], v4 offset:128
    ds_read_b128 v[54:57], v4 offset:13440
    ds_read_b128 v[58:61], v4 offset:26752
    ds_read_b128 v[62:65], v4 offset:40064
    s_cmp_lg_u32 s49, 0
    s_cbranch_scc1 L_nomask_77
    v_mov_b32 v70, 0xf149f2ca
    v_cmp_le_u32 vcc, 2, v2
    s_nop 1
    v_cndmask_b32 v87, v70, v87, vcc
    v_cmp_le_u32 vcc, 4, v2
    s_nop 1
    v_cndmask_b32 v88, v70, v88, vcc
    v_cmp_le_u32 vcc, 6, v2
    s_nop 1
    v_cndmask_b32 v89, v70, v89, vcc
    v_cmp_le_u32 vcc, 8, v2
    s_nop 1
    v_cndmask_b32 v90, v70, v90, vcc
    v_cmp_le_u32 vcc, 10, v2
    s_nop 1
    v_cndmask_b32 v91, v70, v91, vcc
    v_cmp_le_u32 vcc, 12, v2
    s_nop 1
    v_cndmask_b32 v92, v70, v92, vcc
    v_cmp_le_u32 vcc, 14, v2
    s_nop 1
    v_cndmask_b32 v93, v70, v93, vcc
    v_cmp_le_u32 vcc, 2, v2
    s_nop 1
    v_cndmask_b32 v148, v70, v148, vcc
    v_cmp_le_u32 vcc, 4, v2
    s_nop 1
    v_cndmask_b32 v149, v70, v149, vcc
    v_cmp_le_u32 vcc, 6, v2
    s_nop 1
    v_cndmask_b32 v150, v70, v150, vcc
    v_cmp_le_u32 vcc, 8, v2
    s_nop 1
    v_cndmask_b32 v151, v70, v151, vcc
    v_cmp_le_u32 vcc, 10, v2
    s_nop 1
    v_cndmask_b32 v152, v70, v152, vcc
    v_cmp_le_u32 vcc, 12, v2
    s_nop 1
    v_cndmask_b32 v153, v70, v153, vcc
    v_cmp_le_u32 vcc, 2, v2
    s_nop 1
    v_cndmask_b32 v209, v70, v209, vcc
    v_cmp_le_u32 vcc, 4, v2
    s_nop 1
    v_cndmask_b32 v210, v70, v210, vcc
    v_cmp_le_u32 vcc, 6, v2
    s_nop 1
    v_cndmask_b32 v211, v70, v211, vcc
    v_cmp_le_u32 vcc, 8, v2
    s_nop 1
    v_cndmask_b32 v212, v70, v212, vcc
    v_cmp_le_u32 vcc, 10, v2
    s_nop 1
    v_cndmask_b32 v213, v70, v213, vcc
L_nomask_77:
    v_max3_f32 v66, v86, v87, v88
    v_max3_f32 v68, v146, v147, v148
    v_max3_f32 v70, v206, v207, v208
    v_max3_f32 v66, v66, v89, v90
    v_max3_f32 v68, v68, v149, v150
    v_max3_f32 v70, v70, v209, v210
    v_max3_f32 v66, v66, v91, v92
    v_max3_f32 v68, v68, v151, v152
    v_max3_f32 v70, v70, v211, v212
    v_max_f32 v66, v66, v93
    v_max_f32 v68, v68, v153
    v_max_f32 v70, v70, v213
    v_mul_f32 v66, v94, v66
    v_mul_f32 v68, v154, v68
    v_mul_f32 v70, v214, v70
    v_pk_fma_f32 v[86:87], v[86:87], v[94:95], v[66:67] op_sel_hi:[1,0,0] neg_lo:[0,0,1] neg_hi:[0,0,1]
    v_pk_fma_f32 v[88:89], v[88:89], v[94:95], v[66:67] op_sel_hi:[1,0,0] neg_lo:[0,0,1] neg_hi:[0,0,1]
    v_pk_fma_f32 v[90:91], v[90:91], v[94:95], v[66:67] op_sel_hi:[1,0,0] neg_lo:[0,0,1] neg_hi:[0,0,1]
    v_pk_fma_f32 v[92:93], v[92:93], v[94:95], v[66:67] op_sel_hi:[1,0,0] neg_lo:[0,0,1] neg_hi:[0,0,1]
    v_pk_fma_f32 v[146:147], v[146:147], v[154:155], v[68:69] op_sel_hi:[1,0,0] neg_lo:[0,0,1] neg_hi:[0,0,1]
    v_pk_fma_f32 v[148:149], v[148:149], v[154:155], v[68:69] op_sel_hi:[1,0,0] neg_lo:[0,0,1] neg_hi:[0,0,1]
    v_pk_fma_f32 v[150:151], v[150:151], v[154:155], v[68:69] op_sel_hi:[1,0,0] neg_lo:[0,0,1] neg_hi:[0,0,1]
    v_pk_fma_f32 v[152:153], v[152:153], v[154:155], v[68:69] op_sel_hi:[1,0,0] neg_lo:[0,0,1] neg_hi:[0,0,1]
    v_pk_fma_f32 v[206:207], v[206:207], v[214:215], v[70:71] op_sel_hi:[1,0,0] neg_lo:[0,0,1] neg_hi:[0,0,1]
    v_pk_fma_f32 v[208:209], v[208:209], v[214:215], v[70:71] op_sel_hi:[1,0,0] neg_lo:[0,0,1] neg_hi:[0,0,1]
    v_pk_fma_f32 v[210:211], v[210:211], v[214:215], v[70:71] op_sel_hi:[1,0,0] neg_lo:[0,0,1] neg_hi:[0,0,1]
    v_pk_fma_f32 v[212:213], v[212:213], v[214:215], v[70:71] op_sel_hi:[1,0,0] neg_lo:[0,0,1] neg_hi:[0,0,1]
    v_exp_f32 v86, v86
    v_exp_f32 v87, v87
    v_exp_f32 v88, v88
    v_exp_f32 v89, v89
    v_exp_f32 v90, v90
    v_exp_f32 v91, v91
    v_exp_f32 v92, v92
    v_exp_f32 v93, v93
    v_exp_f32 v146, v146
    v_exp_f32 v147, v147
    v_exp_f32 v148, v148
    v_exp_f32 v149, v149
    v_exp_f32 v150, v150
    v_exp_f32 v151, v151
    v_exp_f32 v152, v152
    v_exp_f32 v153, v153
    v_exp_f32 v206, v206
    v_exp_f32 v207, v207
    v_exp_f32 v208, v208
    v_exp_f32 v209, v209
    v_exp_f32 v210, v210
    v_exp_f32 v211, v211
    v_exp_f32 v212, v212
    v_exp_f32 v213, v213
    v_pk_add_f32 v[66:67], v[86:87], v[88:89]
    v_pk_add_f32 v[68:69], v[146:147], v[148:149]
    v_pk_add_f32 v[70:71], v[206:207], v[208:209]
    v_pk_add_f32 v[66:67], v[66:67], v[90:91]
    v_pk_add_f32 v[68:69], v[68:69], v[150:151]
    v_pk_add_f32 v[70:71], v[70:71], v[210:211]
    v_pk_add_f32 v[66:67], v[66:67], v[92:93]
    v_pk_add_f32 v[68:69], v[68:69], v[152:153]
    v_pk_add_f32 v[70:71], v[70:71], v[212:213]
    v_add_f32 v66, v66, v67
    v_add_f32 v68, v68, v69
    v_add_f32 v70, v70, v71
    v_rcp_f32 v66, v66
    v_rcp_f32 v68, v68
    v_rcp_f32 v70, v70
    s_nop 0
    v_pk_mul_f32 v[86:87], v[86:87], v[66:67] op_sel_hi:[1,0]
    v_pk_mul_f32 v[88:89], v[88:89], v[66:67] op_sel_hi:[1,0]
    v_pk_mul_f32 v[90:91], v[90:91], v[66:67] op_sel_hi:[1,0]
    v_pk_mul_f32 v[92:93], v[92:93], v[66:67] op_sel_hi:[1,0]
    v_pk_mul_f32 v[146:147], v[146:147], v[68:69] op_sel_hi:[1,0]
    v_pk_mul_f32 v[148:149], v[148:149], v[68:69] op_sel_hi:[1,0]
    v_pk_mul_f32 v[150:151], v[150:151], v[68:69] op_sel_hi:[1,0]
    v_pk_mul_f32 v[152:153], v[152:153], v[68:69] op_sel_hi:[1,0]
    v_pk_mul_f32 v[206:207], v[206:207], v[70:71] op_sel_hi:[1,0]
    v_pk_mul_f32 v[208:209], v[208:209], v[70:71] op_sel_hi:[1,0]
    v_pk_mul_f32 v[210:211], v[210:211], v[70:71] op_sel_hi:[1,0]
    v_pk_mul_f32 v[212:213], v[212:213], v[70:71] op_sel_hi:[1,0]
    v_pk_mul_f32 v[216:217], v[236:237], v[206:207] op_sel:[0,0] op_sel_hi:[1,0]
    v_pk_mul_f32 v[218:219], v[238:239], v[206:207] op_sel:[0,0] op_sel_hi:[1,0]
    v_pk_mul_f32 v[220:221], v[240:241], v[206:207] op_sel:[0,0] op_sel_hi:[1,0]
    v_pk_mul_f32 v[222:223], v[242:243], v[206:207] op_sel:[0,0] op_sel_hi:[1,0]
    v_pk_mul_f32 v[224:225], v[244:245], v[206:207] op_sel:[0,0] op_sel_hi:[1,0]
    v_pk_mul_f32 v[226:227], v[246:247], v[206:207] op_sel:[0,0] op_sel_hi:[1,0]
    v_pk_mul_f32 v[228:229], v[248:249], v[206:207] op_sel:[0,0] op_sel_hi:[1,0]
    v_pk_mul_f32 v[230:231], v[250:251], v[206:207] op_sel:[0,0] op_sel_hi:[1,0]
    v_pk_mul_f32 v[232:233], v[252:253], v[206:207] op_sel:[0,0] op_sel_hi:[1,0]
    v_pk_mul_f32 v[234:235], v[254:255], v[206:207] op_sel:[0,0] op_sel_hi:[1,0]
    v_pk_mul_f32 v[156:157], v[176:177], v[146:147] op_sel:[0,0] op_sel_hi:[1,0]
    v_pk_mul_f32 v[158:159], v[178:179], v[146:147] op_sel:[0,0] op_sel_hi:[1,0]
    v_pk_mul_f32 v[160:161], v[180:181], v[146:147] op_sel:[0,0] op_sel_hi:[1,0]
    v_pk_mul_f32 v[162:163], v[182:183], v[146:147] op_sel:[0,0] op_sel_hi:[1,0]
    v_pk_mul_f32 v[164:165], v[184:185], v[146:147] op_sel:[0,0] op_sel_hi:[1,0]
    v_pk_mul_f32 v[166:167], v[186:187], v[146:147] op_sel:[0,0] op_sel_hi:[1,0]
    v_pk_mul_f32 v[168:169], v[188:189], v[146:147] op_sel:[0,0] op_sel_hi:[1,0]
    v_pk_mul_f32 v[170:171], v[190:191], v[146:147] op_sel:[0,0] op_sel_hi:[1,0]
    v_pk_mul_f32 v[172:173], v[192:193], v[146:147] op_sel:[0,0] op_sel_hi:[1,0]
    v_pk_mul_f32 v[174:175], v[194:195], v[146:147] op_sel:[0,0] op_sel_hi:[1,0]
    v_pk_fma_f32 v[216:217], v[176:177], v[206:207], v[216:217] op_sel:[0,1,0] op_sel_hi:[1,1,1]
    v_pk_fma_f32 v[218:219], v[178:179], v[206:207], v[218:219] op_sel:[0,1,0] op_sel_hi:[1,1,1]
    v_pk_fma_f32 v[220:221], v[180:181], v[206:207], v[220:221] op_sel:[0,1,0] op_sel_hi:[1,1,1]
    v_pk_fma_f32 v[222:223], v[182:183], v[206:207], v[222:223] op_sel:[0,1,0] op_sel_hi:[1,1,1]
    v_pk_fma_f32 v[224:225], v[184:185], v[206:207], v[224:225] op_sel:[0,1,0] op_sel_hi:[1,1,1]
    v_pk_fma_f32 v[226:227], v[186:187], v[206:207], v[226:227] op_sel:[0,1,0] op_sel_hi:[1,1,1]
    v_pk_fma_f32 v[228:229], v[188:189], v[206:207], v[228:229] op_sel:[0,1,0] op_sel_hi:[1,1,1]
    v_pk_fma_f32 v[230:231], v[190:191], v[206:207], v[230:231] op_sel:[0,1,0] op_sel_hi:[1,1,1]
    v_pk_fma_f32 v[232:233], v[192:193], v[206:207], v[232:233] op_sel:[0,1,0] op_sel_hi:[1,1,1]
    v_pk_fma_f32 v[234:235], v[194:195], v[206:207], v[234:235] op_sel:[0,1,0] op_sel_hi:[1,1,1]
    v_pk_mul_f32 v[96:97], v[116:117], v[86:87] op_sel:[0,0] op_sel_hi:[1,0]
    v_pk_mul_f32 v[98:99], v[118:119], v[86:87] op_sel:[0,0] op_sel_hi:[1,0]
    v_pk_mul_f32 v[100:101], v[120:121], v[86:87] op_sel:[0,0] op_sel_hi:[1,0]
    v_pk_mul_f32 v[102:103], v[122:123], v[86:87] op_sel:[0,0] op_sel_hi:[1,0]
    v_pk_mul_f32 v[104:105], v[124:125], v[86:87] op_sel:[0,0] op_sel_hi:[1,0]
    v_pk_mul_f32 v[106:107], v[126:127], v[86:87] op_sel:[0,0] op_sel_hi:[1,0]
    v_pk_mul_f32 v[108:109], v[128:129], v[86:87] op_sel:[0,0] op_sel_hi:[1,0]
    v_pk_mul_f32 v[110:111], v[130:131], v[86:87] op_sel:[0,0] op_sel_hi:[1,0]
    v_pk_mul_f32 v[112:113], v[132:133], v[86:87] op_sel:[0,0] op_sel_hi:[1,0]
    v_pk_mul_f32 v[114:115], v[134:135], v[86:87] op_sel:[0,0] op_sel_hi:[1,0]
    v_pk_fma_f32 v[156:157], v[116:117], v[146:147], v[156:157] op_sel:[0,1,0] op_sel_hi:[1,1,1]
    v_pk_fma_f32 v[158:159], v[118:119], v[146:147], v[158:159] op_sel:[0,1,0] op_sel_hi:[1,1,1]
    v_pk_fma_f32 v[160:161], v[120:121], v[146:147], v[160:161] op_sel:[0,1,0] op_sel_hi:[1,1,1]
    v_pk_fma_f32 v[162:163], v[122:123], v[146:147], v[162:163] op_sel:[0,1,0] op_sel_hi:[1,1,1]
    v_pk_fma_f32 v[164:165], v[124:125], v[146:147], v[164:165] op_sel:[0,1,0] op_sel_hi:[1,1,1]
    v_pk_fma_f32 v[166:167], v[126:127], v[146:147], v[166:167] op_sel:[0,1,0] op_sel_hi:[1,1,1]
    v_pk_fma_f32 v[168:169], v[128:129], v[146:147], v[168:169] op_sel:[0,1,0] op_sel_hi:[1,1,1]
    v_pk_fma_f32 v[170:171], v[130:131], v[146:147], v[170:171] op_sel:[0,1,0] op_sel_hi:[1,1,1]
    v_pk_fma_f32 v[172:173], v[132:133], v[146:147], v[172:173] op_sel:[0,1,0] op_sel_hi:[1,1,1]
    v_pk_fma_f32 v[174:175], v[134:135], v[146:147], v[174:175] op_sel:[0,1,0] op_sel_hi:[1,1,1]
    v_pk_fma_f32 v[216:217], v[116:117], v[208:209], v[216:217] op_sel:[0,0,0] op_sel_hi:[1,0,1]
    v_pk_fma_f32 v[218:219], v[118:119], v[208:209], v[218:219] op_sel:[0,0,0] op_sel_hi:[1,0,1]
    v_pk_fma_f32 v[220:221], v[120:121], v[208:209], v[220:221] op_sel:[0,0,0] op_sel_hi:[1,0,1]
    v_pk_fma_f32 v[222:223], v[122:123], v[208:209], v[222:223] op_sel:[0,0,0] op_sel_hi:[1,0,1]
    v_pk_fma_f32 v[224:225], v[124:125], v[208:209], v[224:225] op_sel:[0,0,0] op_sel_hi:[1,0,1]
    v_pk_fma_f32 v[226:227], v[126:127], v[208:209], v[226:227] op_sel:[0,0,0] op_sel_hi:[1,0,1]
    v_pk_fma_f32 v[228:229], v[128:129], v[208:209], v[228:229] op_sel:[0,0,0] op_sel_hi:[1,0,1]
    v_pk_fma_f32 v[230:231], v[130:131], v[208:209], v[230:231] op_sel:[0,0,0] op_sel_hi:[1,0,1]
    v_pk_fma_f32 v[232:233], v[132:133], v[208:209], v[232:233] op_sel:[0,0,0] op_sel_hi:[1,0,1]
    v_pk_fma_f32 v[234:235], v[134:135], v[208:209], v[234:235] op_sel:[0,0,0] op_sel_hi:[1,0,1]
    ds_read_b128 v[116:119], v3 offset:40032
    ds_read_b128 v[120:123], v4 offset:96
    ds_read_b128 v[124:127], v4 offset:13408
    ds_read_b128 v[128:131], v4 offset:26720
    ds_read_b128 v[132:135], v4 offset:40032
    ds_read_b128 v[176:179], v3 offset:40000
    ds_read_b128 v[180:183], v4 offset:64
    ds_read_b128 v[184:187], v4 offset:13376
    ds_read_b128 v[188:191], v4 offset:26688
    ds_read_b128 v[192:195], v4 offset:40000
    ds_read_b128 v[236:239], v3 offset:39968
    ds_read_b128 v[240:243], v4 offset:32
    ds_read_b128 v[244:247], v4 offset:13344
    ds_read_b128 v[248:251], v4 offset:26656
    ds_read_b128 v[252:255], v4 offset:39968
    ds_read_b128 v[66:69], v5 offset:1024
    ds_read_b128 v[70:73], v5 offset:2048
    s_mul_i32 s53, s50, 5
    s_add_u32 s53, s53, 112
    s_lshl_b32 s53, s53, 10
    s_add_u32 s54, s53, 4096
    s_waitcnt lgkmcnt(15)
    v_pk_fma_f32 v[96:97], v[6:7], v[86:87], v[96:97] op_sel:[0,1,0] op_sel_hi:[1,1,1]
    v_pk_fma_f32 v[98:99], v[8:9], v[86:87], v[98:99] op_sel:[0,1,0] op_sel_hi:[1,1,1]
    v_pk_fma_f32 v[100:101], v[10:11], v[86:87], v[100:101] op_sel:[0,1,0] op_sel_hi:[1,1,1]
    v_pk_fma_f32 v[102:103], v[12:13], v[86:87], v[102:103] op_sel:[0,1,0] op_sel_hi:[1,1,1]
    v_pk_fma_f32 v[104:105], v[14:15], v[86:87], v[104:105] op_sel:[0,1,0] op_sel_hi:[1,1,1]
    v_pk_fma_f32 v[106:107], v[16:17], v[86:87], v[106:107] op_sel:[0,1,0] op_sel_hi:[1,1,1]
    v_pk_fma_f32 v[108:109], v[18:19], v[86:87], v[108:109] op_sel:[0,1,0] op_sel_hi:[1,1,1]
    v_pk_fma_f32 v[110:111], v[20:21], v[86:87], v[110:111] op_sel:[0,1,0] op_sel_hi:[1,1,1]
    v_pk_fma_f32 v[112:113], v[22:23], v[86:87], v[112:113] op_sel:[0,1,0] op_sel_hi:[1,1,1]
    v_pk_fma_f32 v[114:115], v[24:25], v[86:87], v[114:115] op_sel:[0,1,0] op_sel_hi:[1,1,1]
    v_pk_fma_f32 v[156:157], v[6:7], v[148:149], v[156:157] op_sel:[0,0,0] op_sel_hi:[1,0,1]
    v_pk_fma_f32 v[158:159], v[8:9], v[148:149], v[158:159] op_sel:[0,0,0] op_sel_hi:[1,0,1]
    v_pk_fma_f32 v[160:161], v[10:11], v[148:149], v[160:161] op_sel:[0,0,0] op_sel_hi:[1,0,1]
    v_pk_fma_f32 v[162:163], v[12:13], v[148:149], v[162:163] op_sel:[0,0,0] op_sel_hi:[1,0,1]
    v_pk_fma_f32 v[164:165], v[14:15], v[148:149], v[164:165] op_sel:[0,0,0] op_sel_hi:[1,0,1]
    v_pk_fma_f32 v[166:167], v[16:17], v[148:149], v[166:167] op_sel:[0,0,0] op_sel_hi:[1,0,1]
    v_pk_fma_f32 v[168:169], v[18:19], v[148:149], v[168:169] op_sel:[0,0,0] op_sel_hi:[1,0,1]
    v_pk_fma_f32 v[170:171], v[20:21], v[148:149], v[170:171] op_sel:[0,0,0] op_sel_hi:[1,0,1]
    v_pk_fma_f32 v[172:173], v[22:23], v[148:149], v[172:173] op_sel:[0,0,0] op_sel_hi:[1,0,1]
    v_pk_fma_f32 v[174:175], v[24:25], v[148:149], v[174:175] op_sel:[0,0,0] op_sel_hi:[1,0,1]
    v_pk_fma_f32 v[216:217], v[6:7], v[208:209], v[216:217] op_sel:[0,1,0] op_sel_hi:[1,1,1]
    v_pk_fma_f32 v[218:219], v[8:9], v[208:209], v[218:219] op_sel:[0,1,0] op_sel_hi:[1,1,1]
    v_pk_fma_f32 v[220:221], v[10:11], v[208:209], v[220:221] op_sel:[0,1,0] op_sel_hi:[1,1,1]
    v_pk_fma_f32 v[222:223], v[12:13], v[208:209], v[222:223] op_sel:[0,1,0] op_sel_hi:[1,1,1]
    v_pk_fma_f32 v[224:225], v[14:15], v[208:209], v[224:225] op_sel:[0,1,0] op_sel_hi:[1,1,1]
    v_pk_fma_f32 v[226:227], v[16:17], v[208:209], v[226:227] op_sel:[0,1,0] op_sel_hi:[1,1,1]
    v_pk_fma_f32 v[228:229], v[18:19], v[208:209], v[228:229] op_sel:[0,1,0] op_sel_hi:[1,1,1]
    v_pk_fma_f32 v[230:231], v[20:21], v[208:209], v[230:231] op_sel:[0,1,0] op_sel_hi:[1,1,1]
    v_pk_fma_f32 v[232:233], v[22:23], v[208:209], v[232:233] op_sel:[0,1,0] op_sel_hi:[1,1,1]
    v_pk_fma_f32 v[234:235], v[24:25], v[208:209], v[234:235] op_sel:[0,1,0] op_sel_hi:[1,1,1]
    ds_read_b128 v[6:9], v3 offset:39936
    ds_read_b128 v[10:13], v4 offset:0
    ds_read_b128 v[14:17], v4 offset:13312
    ds_read_b128 v[18:21], v4 offset:26624
    ds_read_b128 v[22:25], v4 offset:39936
    v_pk_fma_f32 v[96:97], v[26:27], v[88:89], v[96:97] op_sel:[0,0,0] op_sel_hi:[1,0,1]
    v_pk_fma_f32 v[98:99], v[28:29], v[88:89], v[98:99] op_sel:[0,0,0] op_sel_hi:[1,0,1]
    v_pk_fma_f32 v[100:101], v[30:31], v[88:89], v[100:101] op_sel:[0,0,0] op_sel_hi:[1,0,1]
    v_pk_fma_f32 v[102:103], v[32:33], v[88:89], v[102:103] op_sel:[0,0,0] op_sel_hi:[1,0,1]
    v_pk_fma_f32 v[104:105], v[34:35], v[88:89], v[104:105] op_sel:[0,0,0] op_sel_hi:[1,0,1]
    v_pk_fma_f32 v[106:107], v[36:37], v[88:89], v[106:107] op_sel:[0,0,0] op_sel_hi:[1,0,1]
    v_pk_fma_f32 v[108:109], v[38:39], v[88:89], v[108:109] op_sel:[0,0,0] op_sel_hi:[1,0,1]
    v_pk_fma_f32 v[110:111], v[40:41], v[88:89], v[110:111] op_sel:[0,0,0] op_sel_hi:[1,0,1]
    v_pk_fma_f32 v[112:113], v[42:43], v[88:89], v[112:113] op_sel:[0,0,0] op_sel_hi:[1,0,1]
    v_pk_fma_f32 v[114:115], v[44:45], v[88:89], v[114:115] op_sel:[0,0,0] op_sel_hi:[1,0,1]
    v_pk_fma_f32 v[156:157], v[26:27], v[148:149], v[156:157] op_sel:[0,1,0] op_sel_hi:[1,1,1]
    v_pk_fma_f32 v[158:159], v[28:29], v[148:149], v[158:159] op_sel:[0,1,0] op_sel_hi:[1,1,1]
    v_pk_fma_f32 v[160:161], v[30:31], v[148:149], v[160:161] op_sel:[0,1,0] op_sel_hi:[1,1,1]
    v_pk_fma_f32 v[162:163], v[32:33], v[148:149], v[162:163] op_sel:[0,1,0] op_sel_hi:[1,1,1]
    v_pk_fma_f32 v[164:165], v[34:35], v[148:149], v[164:165] op_sel:[0,1,0] op_sel_hi:[1,1,1]
    v_pk_fma_f32 v[166:167], v[36:37], v[148:149], v[166:167] op_sel:[0,1,0] op_sel_hi:[1,1,1]
    v_pk_fma_f32 v[168:169], v[38:39], v[148:149], v[168:169] op_sel:[0,1,0] op_sel_hi:[1,1,1]
    v_pk_fma_f32 v[170:171], v[40:41], v[148:149], v[170:171] op_sel:[0,1,0] op_sel_hi:[1,1,1]
    v_pk_fma_f32 v[172:173], v[42:43], v[148:149], v[172:173] op_sel:[0,1,0] op_sel_hi:[1,1,1]
    v_pk_fma_f32 v[174:175], v[44:45], v[148:149], v[174:175] op_sel:[0,1,0] op_sel_hi:[1,1,1]
    v_pk_fma_f32 v[216:217], v[26:27], v[210:211], v[216:217] op_sel:[0,0,0] op_sel_hi:[1,0,1]
    v_pk_fma_f32 v[218:219], v[28:29], v[210:211], v[218:219] op_sel:[0,0,0] op_sel_hi:[1,0,1]
    v_pk_fma_f32 v[220:221], v[30:31], v[210:211], v[220:221] op_sel:[0,0,0] op_sel_hi:[1,0,1]
    v_pk_fma_f32 v[222:223], v[32:33], v[210:211], v[222:223] op_sel:[0,0,0] op_sel_hi:[1,0,1]
    v_pk_fma_f32 v[224:225], v[34:35], v[210:211], v[224:225] op_sel:[0,0,0] op_sel_hi:[1,0,1]
    v_pk_fma_f32 v[226:227], v[36:37], v[210:211], v[226:227] op_sel:[0,0,0] op_sel_hi:[1,0,1]
    v_pk_fma_f32 v[228:229], v[38:39], v[210:211], v[228:229] op_sel:[0,0,0] op_sel_hi:[1,0,1]
    v_pk_fma_f32 v[230:231], v[40:41], v[210:211], v[230:231] op_sel:[0,0,0] op_sel_hi:[1,0,1]
    v_pk_fma_f32 v[232:233], v[42:43], v[210:211], v[232:233] op_sel:[0,0,0] op_sel_hi:[1,0,1]
    v_pk_fma_f32 v[234:235], v[44:45], v[210:211], v[234:235] op_sel:[0,0,0] op_sel_hi:[1,0,1]
    v_pk_fma_f32 v[96:97], v[46:47], v[88:89], v[96:97] op_sel:[0,1,0] op_sel_hi:[1,1,1]
    v_pk_fma_f32 v[98:99], v[48:49], v[88:89], v[98:99] op_sel:[0,1,0] op_sel_hi:[1,1,1]
    v_pk_fma_f32 v[100:101], v[50:51], v[88:89], v[100:101] op_sel:[0,1,0] op_sel_hi:[1,1,1]
    v_pk_fma_f32 v[102:103], v[52:53], v[88:89], v[102:103] op_sel:[0,1,0] op_sel_hi:[1,1,1]
    v_pk_fma_f32 v[104:105], v[54:55], v[88:89], v[104:105] op_sel:[0,1,0] op_sel_hi:[1,1,1]
    v_pk_fma_f32 v[106:107], v[56:57], v[88:89], v[106:107] op_sel:[0,1,0] op_sel_hi:[1,1,1]
    v_pk_fma_f32 v[108:109], v[58:59], v[88:89], v[108:109] op_sel:[0,1,0] op_sel_hi:[1,1,1]
    v_pk_fma_f32 v[110:111], v[60:61], v[88:89], v[110:111] op_sel:[0,1,0] op_sel_hi:[1,1,1]
    v_pk_fma_f32 v[112:113], v[62:63], v[88:89], v[112:113] op_sel:[0,1,0] op_sel_hi:[1,1,1]
    v_pk_fma_f32 v[114:115], v[64:65], v[88:89], v[114:115] op_sel:[0,1,0] op_sel_hi:[1,1,1]
    v_pk_fma_f32 v[156:157], v[46:47], v[150:151], v[156:157] op_sel:[0,0,0] op_sel_hi:[1,0,1]
    v_pk_fma_f32 v[158:159], v[48:49], v[150:151], v[158:159] op_sel:[0,0,0] op_sel_hi:[1,0,1]
    v_pk_fma_f32 v[160:161], v[50:51], v[150:151], v[160:161] op_sel:[0,0,0] op_sel_hi:[1,0,1]
    v_pk_fma_f32 v[162:163], v[52:53], v[150:151], v[162:163] op_sel:[0,0,0] op_sel_hi:[1,0,1]
    v_pk_fma_f32 v[164:165], v[54:55], v[150:151], v[164:165] op_sel:[0,0,0] op_sel_hi:[1,0,1]
    v_pk_fma_f32 v[166:167], v[56:57], v[150:151], v[166:167] op_sel:[0,0,0] op_sel_hi:[1,0,1]
    v_pk_fma_f32 v[168:169], v[58:59], v[150:151], v[168:169] op_sel:[0,0,0] op_sel_hi:[1,0,1]
    v_pk_fma_f32 v[170:171], v[60:61], v[150:151], v[170:171] op_sel:[0,0,0] op_sel_hi:[1,0,1]
    v_pk_fma_f32 v[172:173], v[62:63], v[150:151], v[172:173] op_sel:[0,0,0] op_sel_hi:[1,0,1]
    v_pk_fma_f32 v[174:175], v[64:65], v[150:151], v[174:175] op_sel:[0,0,0] op_sel_hi:[1,0,1]
    v_pk_fma_f32 v[216:217], v[46:47], v[210:211], v[216:217] op_sel:[0,1,0] op_sel_hi:[1,1,1]
    v_pk_fma_f32 v[218:219], v[48:49], v[210:211], v[218:219] op_sel:[0,1,0] op_sel_hi:[1,1,1]
    v_pk_fma_f32 v[220:221], v[50:51], v[210:211], v[220:221] op_sel:[0,1,0] op_sel_hi:[1,1,1]
    v_pk_fma_f32 v[222:223], v[52:53], v[210:211], v[222:223] op_sel:[0,1,0] op_sel_hi:[1,1,1]
    v_pk_fma_f32 v[224:225], v[54:55], v[210:211], v[224:225] op_sel:[0,1,0] op_sel_hi:[1,1,1]
    v_pk_fma_f32 v[226:227], v[56:57], v[210:211], v[226:227] op_sel:[0,1,0] op_sel_hi:[1,1,1]
    v_pk_fma_f32 v[228:229], v[58:59], v[210:211], v[228:229] op_sel:[0,1,0] op_sel_hi:[1,1,1]
    v_pk_fma_f32 v[230:231], v[60:61], v[210:211], v[230:231] op_sel:[0,1,0] op_sel_hi:[1,1,1]
    v_pk_fma_f32 v[232:233], v[62:63], v[210:211], v[232:233] op_sel:[0,1,0] op_sel_hi:[1,1,1]
    v_pk_fma_f32 v[234:235], v[64:65], v[210:211], v[234:235] op_sel:[0,1,0] op_sel_hi:[1,1,1]
    s_waitcnt lgkmcnt(5)
    v_pk_fma_f32 v[96:97], v[116:117], v[90:91], v[96:97] op_sel:[0,0,0] op_sel_hi:[1,0,1]
    v_pk_fma_f32 v[98:99], v[118:119], v[90:91], v[98:99] op_sel:[0,0,0] op_sel_hi:[1,0,1]
    v_pk_fma_f32 v[100:101], v[120:121], v[90:91], v[100:101] op_sel:[0,0,0] op_sel_hi:[1,0,1]
    v_pk_fma_f32 v[102:103], v[122:123], v[90:91], v[102:103] op_sel:[0,0,0] op_sel_hi:[1,0,1]
    v_pk_fma_f32 v[104:105], v[124:125], v[90:91], v[104:105] op_sel:[0,0,0] op_sel_hi:[1,0,1]
    v_pk_fma_f32 v[106:107], v[126:127], v[90:91], v[106:107] op_sel:[0,0,0] op_sel_hi:[1,0,1]
    v_pk_fma_f32 v[108:109], v[128:129], v[90:91], v[108:109] op_sel:[0,0,0] op_sel_hi:[1,0,1]
    v_pk_fma_f32 v[110:111], v[130:131], v[90:91], v[110:111] op_sel:[0,0,0] op_sel_hi:[1,0,1]
    v_pk_fma_f32 v[112:113], v[132:133], v[90:91], v[112:113] op_sel:[0,0,0] op_sel_hi:[1,0,1]
    v_pk_fma_f32 v[114:115], v[134:135], v[90:91], v[114:115] op_sel:[0,0,0] op_sel_hi:[1,0,1]
    v_pk_fma_f32 v[156:157], v[116:117], v[150:151], v[156:157] op_sel:[0,1,0] op_sel_hi:[1,1,1]
    v_pk_fma_f32 v[158:159], v[118:119], v[150:151], v[158:159] op_sel:[0,1,0] op_sel_hi:[1,1,1]
    v_pk_fma_f32 v[160:161], v[120:121], v[150:151], v[160:161] op_sel:[0,1,0] op_sel_hi:[1,1,1]
    v_pk_fma_f32 v[162:163], v[122:123], v[150:151], v[162:163] op_sel:[0,1,0] op_sel_hi:[1,1,1]
    v_pk_fma_f32 v[164:165], v[124:125], v[150:151], v[164:165] op_sel:[0,1,0] op_sel_hi:[1,1,1]
    v_pk_fma_f32 v[166:167], v[126:127], v[150:151], v[166:167] op_sel:[0,1,0] op_sel_hi:[1,1,1]
    v_pk_fma_f32 v[168:169], v[128:129], v[150:151], v[168:169] op_sel:[0,1,0] op_sel_hi:[1,1,1]
    v_pk_fma_f32 v[170:171], v[130:131], v[150:151], v[170:171] op_sel:[0,1,0] op_sel_hi:[1,1,1]
    v_pk_fma_f32 v[172:173], v[132:133], v[150:151], v[172:173] op_sel:[0,1,0] op_sel_hi:[1,1,1]
    v_pk_fma_f32 v[174:175], v[134:135], v[150:151], v[174:175] op_sel:[0,1,0] op_sel_hi:[1,1,1]
    v_pk_fma_f32 v[216:217], v[116:117], v[212:213], v[216:217] op_sel:[0,0,0] op_sel_hi:[1,0,1]
    v_pk_fma_f32 v[218:219], v[118:119], v[212:213], v[218:219] op_sel:[0,0,0] op_sel_hi:[1,0,1]
    v_pk_fma_f32 v[220:221], v[120:121], v[212:213], v[220:221] op_sel:[0,0,0] op_sel_hi:[1,0,1]
    v_pk_fma_f32 v[222:223], v[122:123], v[212:213], v[222:223] op_sel:[0,0,0] op_sel_hi:[1,0,1]
    v_pk_fma_f32 v[224:225], v[124:125], v[212:213], v[224:225] op_sel:[0,0,0] op_sel_hi:[1,0,1]
    v_pk_fma_f32 v[226:227], v[126:127], v[212:213], v[226:227] op_sel:[0,0,0] op_sel_hi:[1,0,1]
    v_pk_fma_f32 v[228:229], v[128:129], v[212:213], v[228:229] op_sel:[0,0,0] op_sel_hi:[1,0,1]
    v_pk_fma_f32 v[230:231], v[130:131], v[212:213], v[230:231] op_sel:[0,0,0] op_sel_hi:[1,0,1]
    v_pk_fma_f32 v[232:233], v[132:133], v[212:213], v[232:233] op_sel:[0,0,0] op_sel_hi:[1,0,1]
    v_pk_fma_f32 v[234:235], v[134:135], v[212:213], v[234:235] op_sel:[0,0,0] op_sel_hi:[1,0,1]
    v_pk_fma_f32 v[96:97], v[176:177], v[90:91], v[96:97] op_sel:[0,1,0] op_sel_hi:[1,1,1]
    v_pk_fma_f32 v[98:99], v[178:179], v[90:91], v[98:99] op_sel:[0,1,0] op_sel_hi:[1,1,1]
    v_pk_fma_f32 v[100:101], v[180:181], v[90:91], v[100:101] op_sel:[0,1,0] op_sel_hi:[1,1,1]
    v_pk_fma_f32 v[102:103], v[182:183], v[90:91], v[102:103] op_sel:[0,1,0] op_sel_hi:[1,1,1]
    v_pk_fma_f32 v[104:105], v[184:185], v[90:91], v[104:105] op_sel:[0,1,0] op_sel_hi:[1,1,1]
    v_pk_fma_f32 v[106:107], v[186:187], v[90:91], v[106:107] op_sel:[0,1,0] op_sel_hi:[1,1,1]
    v_pk_fma_f32 v[108:109], v[188:189], v[90:91], v[108:109] op_sel:[0,1,0] op_sel_hi:[1,1,1]
    v_pk_fma_f32 v[110:111], v[190:191], v[90:91], v[110:111] op_sel:[0,1,0] op_sel_hi:[1,1,1]
    v_pk_fma_f32 v[112:113], v[192:193], v[90:91], v[112:113] op_sel:[0,1,0] op_sel_hi:[1,1,1]
    v_pk_fma_f32 v[114:115], v[194:195], v[90:91], v[114:115] op_sel:[0,1,0] op_sel_hi:[1,1,1]
    v_pk_fma_f32 v[156:157], v[176:177], v[152:153], v[156:157] op_sel:[0,0,0] op_sel_hi:[1,0,1]
    v_pk_fma_f32 v[158:159], v[178:179], v[152:153], v[158:159] op_sel:[0,0,0] op_sel_hi:[1,0,1]
    v_pk_fma_f32 v[160:161], v[180:181], v[152:153], v[160:161] op_sel:[0,0,0] op_sel_hi:[1,0,1]
    v_pk_fma_f32 v[162:163], v[182:183], v[152:153], v[162:163] op_sel:[0,0,0] op_sel_hi:[1,0,1]
    v_pk_fma_f32 v[164:165], v[184:185], v[152:153], v[164:165] op_sel:[0,0,0] op_sel_hi:[1,0,1]
    v_pk_fma_f32 v[166:167], v[186:187], v[152:153], v[166:167] op_sel:[0,0,0] op_sel_hi:[1,0,1]
    v_pk_fma_f32 v[168:169], v[188:189], v[152:153], v[168:169] op_sel:[0,0,0] op_sel_hi:[1,0,1]
    v_pk_fma_f32 v[170:171], v[190:191], v[152:153], v[170:171] op_sel:[0,0,0] op_sel_hi:[1,0,1]
    v_pk_fma_f32 v[172:173], v[192:193], v[152:153], v[172:173] op_sel:[0,0,0] op_sel_hi:[1,0,1]
    v_pk_fma_f32 v[174:175], v[194:195], v[152:153], v[174:175] op_sel:[0,0,0] op_sel_hi:[1,0,1]
    v_pk_fma_f32 v[216:217], v[176:177], v[212:213], v[216:217] op_sel:[0,1,0] op_sel_hi:[1,1,1]
    v_pk_fma_f32 v[218:219], v[178:179], v[212:213], v[218:219] op_sel:[0,1,0] op_sel_hi:[1,1,1]
    v_pk_fma_f32 v[220:221], v[180:181], v[212:213], v[220:221] op_sel:[0,1,0] op_sel_hi:[1,1,1]
    v_pk_fma_f32 v[222:223], v[182:183], v[212:213], v[222:223] op_sel:[0,1,0] op_sel_hi:[1,1,1]
    v_pk_fma_f32 v[224:225], v[184:185], v[212:213], v[224:225] op_sel:[0,1,0] op_sel_hi:[1,1,1]
    v_pk_fma_f32 v[226:227], v[186:187], v[212:213], v[226:227] op_sel:[0,1,0] op_sel_hi:[1,1,1]
    v_pk_fma_f32 v[228:229], v[188:189], v[212:213], v[228:229] op_sel:[0,1,0] op_sel_hi:[1,1,1]
    v_pk_fma_f32 v[230:231], v[190:191], v[212:213], v[230:231] op_sel:[0,1,0] op_sel_hi:[1,1,1]
    v_pk_fma_f32 v[232:233], v[192:193], v[212:213], v[232:233] op_sel:[0,1,0] op_sel_hi:[1,1,1]
    v_pk_fma_f32 v[234:235], v[194:195], v[212:213], v[234:235] op_sel:[0,1,0] op_sel_hi:[1,1,1]
    v_cvt_pk_bf16_f32 v196, v216, v217
    v_cvt_pk_bf16_f32 v197, v218, v219
    v_cvt_pk_bf16_f32 v198, v224, v225
    v_cvt_pk_bf16_f32 v199, v226, v227
    v_cvt_pk_bf16_f32 v200, v220, v221
    v_cvt_pk_bf16_f32 v201, v222, v223
    v_cvt_pk_bf16_f32 v202, v228, v229
    v_cvt_pk_bf16_f32 v203, v230, v231
    v_cvt_pk_bf16_f32 v204, v232, v233
    v_cvt_pk_bf16_f32 v205, v234, v235
    ds_write_b128 v66, v[196:199] offset:64
    ds_write_b128 v66, v[200:203] offset:832
    ds_write_b64 v67, v[204:205] offset:64
    v_pk_fma_f32 v[96:97], v[236:237], v[92:93], v[96:97] op_sel:[0,0,0] op_sel_hi:[1,0,1]
    v_pk_fma_f32 v[98:99], v[238:239], v[92:93], v[98:99] op_sel:[0,0,0] op_sel_hi:[1,0,1]
    v_pk_fma_f32 v[100:101], v[240:241], v[92:93], v[100:101] op_sel:[0,0,0] op_sel_hi:[1,0,1]
    v_pk_fma_f32 v[102:103], v[242:243], v[92:93], v[102:103] op_sel:[0,0,0] op_sel_hi:[1,0,1]
    v_pk_fma_f32 v[104:105], v[244:245], v[92:93], v[104:105] op_sel:[0,0,0] op_sel_hi:[1,0,1]
    v_pk_fma_f32 v[106:107], v[246:247], v[92:93], v[106:107] op_sel:[0,0,0] op_sel_hi:[1,0,1]
    v_pk_fma_f32 v[108:109], v[248:249], v[92:93], v[108:109] op_sel:[0,0,0] op_sel_hi:[1,0,1]
    v_pk_fma_f32 v[110:111], v[250:251], v[92:93], v[110:111] op_sel:[0,0,0] op_sel_hi:[1,0,1]
    v_pk_fma_f32 v[112:113], v[252:253], v[92:93], v[112:113] op_sel:[0,0,0] op_sel_hi:[1,0,1]
    v_pk_fma_f32 v[114:115], v[254:255], v[92:93], v[114:115] op_sel:[0,0,0] op_sel_hi:[1,0,1]
    v_pk_fma_f32 v[156:157], v[236:237], v[152:153], v[156:157] op_sel:[0,1,0] op_sel_hi:[1,1,1]
    v_pk_fma_f32 v[158:159], v[238:239], v[152:153], v[158:159] op_sel:[0,1,0] op_sel_hi:[1,1,1]
    v_pk_fma_f32 v[160:161], v[240:241], v[152:153], v[160:161] op_sel:[0,1,0] op_sel_hi:[1,1,1]
    v_pk_fma_f32 v[162:163], v[242:243], v[152:153], v[162:163] op_sel:[0,1,0] op_sel_hi:[1,1,1]
    v_pk_fma_f32 v[164:165], v[244:245], v[152:153], v[164:165] op_sel:[0,1,0] op_sel_hi:[1,1,1]
    v_pk_fma_f32 v[166:167], v[246:247], v[152:153], v[166:167] op_sel:[0,1,0] op_sel_hi:[1,1,1]
    v_pk_fma_f32 v[168:169], v[248:249], v[152:153], v[168:169] op_sel:[0,1,0] op_sel_hi:[1,1,1]
    v_pk_fma_f32 v[170:171], v[250:251], v[152:153], v[170:171] op_sel:[0,1,0] op_sel_hi:[1,1,1]
    v_pk_fma_f32 v[172:173], v[252:253], v[152:153], v[172:173] op_sel:[0,1,0] op_sel_hi:[1,1,1]
    v_pk_fma_f32 v[174:175], v[254:255], v[152:153], v[174:175] op_sel:[0,1,0] op_sel_hi:[1,1,1]
    v_cvt_pk_bf16_f32 v136, v156, v157
    v_cvt_pk_bf16_f32 v137, v158, v159
    v_cvt_pk_bf16_f32 v138, v164, v165
    v_cvt_pk_bf16_f32 v139, v166, v167
    v_cvt_pk_bf16_f32 v140, v160, v161
    v_cvt_pk_bf16_f32 v141, v162, v163
    v_cvt_pk_bf16_f32 v142, v168, v169
    v_cvt_pk_bf16_f32 v143, v170, v171
    v_cvt_pk_bf16_f32 v144, v172, v173
    v_cvt_pk_bf16_f32 v145, v174, v175
    ds_write_b128 v66, v[136:139] offset:32
    ds_write_b128 v66, v[140:143] offset:800
    ds_write_b64 v67, v[144:145] offset:32
    s_waitcnt lgkmcnt(6)
    v_pk_fma_f32 v[96:97], v[6:7], v[92:93], v[96:97] op_sel:[0,1,0] op_sel_hi:[1,1,1]
    v_pk_fma_f32 v[98:99], v[8:9], v[92:93], v[98:99] op_sel:[0,1,0] op_sel_hi:[1,1,1]
    v_pk_fma_f32 v[100:101], v[10:11], v[92:93], v[100:101] op_sel:[0,1,0] op_sel_hi:[1,1,1]
    v_pk_fma_f32 v[102:103], v[12:13], v[92:93], v[102:103] op_sel:[0,1,0] op_sel_hi:[1,1,1]
    v_pk_fma_f32 v[104:105], v[14:15], v[92:93], v[104:105] op_sel:[0,1,0] op_sel_hi:[1,1,1]
    v_pk_fma_f32 v[106:107], v[16:17], v[92:93], v[106:107] op_sel:[0,1,0] op_sel_hi:[1,1,1]
    v_pk_fma_f32 v[108:109], v[18:19], v[92:93], v[108:109] op_sel:[0,1,0] op_sel_hi:[1,1,1]
    v_pk_fma_f32 v[110:111], v[20:21], v[92:93], v[110:111] op_sel:[0,1,0] op_sel_hi:[1,1,1]
    v_pk_fma_f32 v[112:113], v[22:23], v[92:93], v[112:113] op_sel:[0,1,0] op_sel_hi:[1,1,1]
    v_pk_fma_f32 v[114:115], v[24:25], v[92:93], v[114:115] op_sel:[0,1,0] op_sel_hi:[1,1,1]
    v_cvt_pk_bf16_f32 v76, v96, v97
    v_cvt_pk_bf16_f32 v77, v98, v99
    v_cvt_pk_bf16_f32 v78, v104, v105
    v_cvt_pk_bf16_f32 v79, v106, v107
    v_cvt_pk_bf16_f32 v80, v100, v101
    v_cvt_pk_bf16_f32 v81, v102, v103
    v_cvt_pk_bf16_f32 v82, v108, v109
    v_cvt_pk_bf16_f32 v83, v110, v111
    v_cvt_pk_bf16_f32 v84, v112, v113
    v_cvt_pk_bf16_f32 v85, v114, v115
    ds_write_b128 v66, v[76:79] offset:0
    ds_write_b128 v66, v[80:83] offset:768
    ds_write_b64 v67, v[84:85] offset:0
    s_waitcnt lgkmcnt(0)
    ds_read_b128 v[6:9], v68 offset:0
    ds_read_b128 v[10:13], v68 offset:1024
    ds_read_b128 v[14:17], v68 offset:2048
    ds_read_b128 v[18:21], v68 offset:3072
    ds_read_b128 v[22:25], v68 offset:4096
    ds_read_b128 v[26:29], v68 offset:5120
    ds_read_b128 v[30:33], v68 offset:6144
    ds_read_b128 v[34:37], v68 offset:7168
    s_waitcnt lgkmcnt(7)
    buffer_store_dwordx4 v[6:9], v70, s[28:31], s53 offen offset:0 sc1
    s_waitcnt lgkmcnt(6)
    buffer_store_dwordx4 v[10:13], v71, s[28:31], s53 offen offset:0 sc1
    s_waitcnt lgkmcnt(5)
    buffer_store_dwordx4 v[14:17], v72, s[28:31], s53 offen offset:0 sc1
    s_waitcnt lgkmcnt(4)
    buffer_store_dwordx4 v[18:21], v70, s[28:31], s53 offen offset:2048 sc1
    s_waitcnt lgkmcnt(3)
    buffer_store_dwordx4 v[22:25], v71, s[28:31], s53 offen offset:2048 sc1
    s_waitcnt lgkmcnt(2)
    buffer_store_dwordx4 v[26:29], v72, s[28:31], s53 offen offset:2048 sc1
    s_waitcnt lgkmcnt(1)
    buffer_store_dwordx4 v[30:33], v70, s[28:31], s54 offen offset:0 sc1
    s_waitcnt lgkmcnt(0)
    buffer_store_dwordx4 v[34:37], v73, s[28:31], s54 offen offset:0 sc1
    s_branch L_p3
L_spare:
    s_waitcnt lgkmcnt(0)
    s_mov_b32 s24, s4
    s_and_b32 s25, s5, 0xffff
    s_mov_b32 s26, 0x280000
    s_mov_b32 s27, 0x20000
    s_mov_b32 s32, s20
    s_and_b32 s33, s21, 0xffff
    s_mov_b32 s34, 0x100
    s_mov_b32 s35, 0x20000
    s_mov_b32 s28, s22
    s_and_b32 s29, s23, 0xffff
    s_mov_b32 s30, 0xf20000
    s_mov_b32 s31, 0x20000
    s_cmp_lt_u32 s48, 4
    s_cbranch_scc1 L_sp_78
    v_cmp_gt_u32 vcc, 32, v1
    v_lshlrev_b32 v12, 2, v1
    v_mov_b32 v13, 0x40000000
    v_cndmask_b32 v12, v13, v12, vcc
    s_mul_i32 s75, s2, 4352
    s_add_u32 s75, s75, 0xe00000
    s_lshl_b32 s54, s51, 7
    s_add_u32 s54, s54, s75
    v_mov_b32 v13, 0
    buffer_store_dword v13, v12, s[28:31], s54 offen sc1
    s_add_u32 s75, s75, 128
    v_mov_b32 v17, 0
    v_lshlrev_b32 v12, 2, v1
    v_add_u32 v12, 0x26c00, v12
    ds_write_b32 v12, v17
    s_waitcnt vmcnt(0) lgkmcnt(0)
    s_barrier
    s_cmp_lg_u32 s48, 4
    s_cbranch_scc1 L_sp_80
    s_mov_b32 s3, 0x40000
L_ssp_82:
    buffer_load_dword v16, v17, s[28:31], s75 offen sc1
    s_waitcnt vmcnt(0)
L_sck_83:
    v_cmp_gt_u32 vcc, 1, v16
    s_nop 1
    s_cmp_eq_u64 vcc, 0
    s_cbranch_scc1 L_sok_81
    s_sleep 16
    s_sub_u32 s3, s3, 1
    s_cbranch_scc0 L_ssp_82
L_sok_81:
L_sp_80:
    s_barrier
    s_branch L_spare_lnext
L_sp_78:
    s_cmp_eq_u32 s50, 14
    s_cselect_b32 s52, s49, 5
    s_cmp_ge_u32 s52, 3
    s_cselect_b32 s53, 3, 0
    s_cselect_b32 s69, 57, 30
    s_sub_u32 s52, s52, s53
    s_mul_i32 s52, s52, 10
    s_add_u32 s52, s52, 9
    s_min_u32 s52, s52, 26
    s_add_u32 s69, s69, s52
    s_waitcnt lgkmcnt(0)
    s_cmp_lt_u32 s69, 57
    s_cselect_b64 s[44:45], s[12:13], s[14:15]
    s_cselect_b32 s52, 30, 57
    s_mov_b32 s46, 2211840
    s_movk_i32 s53, 3456
    s_cmp_lt_u32 s69, 30
    s_cselect_b64 s[44:45], s[6:7], s[44:45]
    s_cselect_b32 s52, 0, s52
    s_cselect_b32 s46, 2457600, s46
    s_cselect_b32 s53, 3840, s53
    s_and_b32 s45, s45, 0xffff
    s_mov_b32 s47, 0x20000
    s_sub_u32 s52, s69, s52
    s_lshl_b32 s52, s52, 7
    s_cmp_lt_u32 s69, 84
    s_cselect_b32 s52, s52, 0x40000000
    v_lshrrev_b32 v8, 3, v0
    v_mul_u32_u24 v8, s53, v8
    v_and_b32 v9, 7, v1
    v_lshl_add_u32 v8, v9, 4, v8
    v_add_u32 v10, s52, v8
    s_lshl_b32 s53, s53, 5
    s_mov_b32 s52, 0
    buffer_load_dwordx4 v[80:83], v10, s[44:47], s52 offen
    s_add_u32 s52, s52, s53
    buffer_load_dwordx4 v[84:87], v10, s[44:47], s52 offen
    s_add_u32 s52, s52, s53
    buffer_load_dwordx4 v[88:91], v10, s[44:47], s52 offen
    s_add_u32 s52, s52, s53
    buffer_load_dwordx4 v[92:95], v10, s[44:47], s52 offen
    s_add_u32 s52, s52, s53
    buffer_load_dwordx4 v[96:99], v10, s[44:47], s52 offen
    s_add_u32 s52, s52, s53
    buffer_load_dwordx4 v[100:103], v10, s[44:47], s52 offen
    s_add_u32 s52, s52, s53
    buffer_load_dwordx4 v[104:107], v10, s[44:47], s52 offen
    s_add_u32 s52, s52, s53
    buffer_load_dwordx4 v[108:111], v10, s[44:47], s52 offen
    s_add_u32 s52, s52, s53
    buffer_load_dwordx4 v[112:115], v10, s[44:47], s52 offen
    s_add_u32 s52, s52, s53
    buffer_load_dwordx4 v[116:119], v10, s[44:47], s52 offen
    s_add_u32 s52, s52, s53
    buffer_load_dwordx4 v[120:123], v10, s[44:47], s52 offen
    s_add_u32 s52, s52, s53
    buffer_load_dwordx4 v[124:127], v10, s[44:47], s52 offen
    s_add_u32 s52, s52, s53
    buffer_load_dwordx4 v[128:131], v10, s[44:47], s52 offen
    s_add_u32 s52, s52, s53
    buffer_load_dwordx4 v[132:135], v10, s[44:47], s52 offen
    s_add_u32 s52, s52, s53
    buffer_load_dwordx4 v[136:139], v10, s[44:47], s52 offen
    s_add_u32 s52, s52, s53
    buffer_load_dwordx4 v[140:143], v10, s[44:47], s52 offen
    s_add_u32 s52, s52, s53
    buffer_load_dwordx4 v[144:147], v10, s[44:47], s52 offen
    s_add_u32 s52, s52, s53
    buffer_load_dwordx4 v[148:151], v10, s[44:47], s52 offen
    s_add_u32 s52, s52, s53
    buffer_load_dwordx4 v[152:155], v10, s[44:47], s52 offen
    s_add_u32 s52, s52, s53
    buffer_load_dwordx4 v[156:159], v10, s[44:47], s52 offen
    s_add_u32 s52, s52, s53
    s_waitcnt vmcnt(19)
    v_lshlrev_b32 v40, 16, v80
    v_and_b32 v41, 0xffff0000, v80
    v_lshlrev_b32 v42, 16, v81
    v_and_b32 v43, 0xffff0000, v81
    v_lshlrev_b32 v44, 16, v82
    v_and_b32 v45, 0xffff0000, v82
    v_lshlrev_b32 v46, 16, v83
    v_and_b32 v47, 0xffff0000, v83
    v_mov_b64 v[80:81], 0
    v_mov_b64 v[82:83], 0
    s_waitcnt vmcnt(18)
    v_lshlrev_b32 v48, 16, v84
    v_and_b32 v49, 0xffff0000, v84
    v_lshlrev_b32 v50, 16, v85
    v_and_b32 v51, 0xffff0000, v85
    v_lshlrev_b32 v52, 16, v86
    v_and_b32 v53, 0xffff0000, v86
    v_lshlrev_b32 v54, 16, v87
    v_and_b32 v55, 0xffff0000, v87
    v_pk_add_f32 v[40:41], v[40:41], v[48:49]
    v_pk_add_f32 v[42:43], v[42:43], v[50:51]
    v_pk_add_f32 v[44:45], v[44:45], v[52:53]
    v_pk_add_f32 v[46:47], v[46:47], v[54:55]
    v_mov_b64 v[84:85], 0
    v_mov_b64 v[86:87], 0
    s_waitcnt vmcnt(17)
    v_lshlrev_b32 v48, 16, v88
    v_and_b32 v49, 0xffff0000, v88
    v_lshlrev_b32 v50, 16, v89
    v_and_b32 v51, 0xffff0000, v89
    v_lshlrev_b32 v52, 16, v90
    v_and_b32 v53, 0xffff0000, v90
    v_lshlrev_b32 v54, 16, v91
    v_and_b32 v55, 0xffff0000, v91
    v_pk_add_f32 v[40:41], v[40:41], v[48:49]
    v_pk_add_f32 v[42:43], v[42:43], v[50:51]
    v_pk_add_f32 v[44:45], v[44:45], v[52:53]
    v_pk_add_f32 v[46:47], v[46:47], v[54:55]
    v_mov_b64 v[88:89], 0
    v_mov_b64 v[90:91], 0
    s_waitcnt vmcnt(16)
    v_lshlrev_b32 v48, 16, v92
    v_and_b32 v49, 0xffff0000, v92
    v_lshlrev_b32 v50, 16, v93
    v_and_b32 v51, 0xffff0000, v93
    v_lshlrev_b32 v52, 16, v94
    v_and_b32 v53, 0xffff0000, v94
    v_lshlrev_b32 v54, 16, v95
    v_and_b32 v55, 0xffff0000, v95
    v_pk_add_f32 v[40:41], v[40:41], v[48:49]
    v_pk_add_f32 v[42:43], v[42:43], v[50:51]
    v_pk_add_f32 v[44:45], v[44:45], v[52:53]
    v_pk_add_f32 v[46:47], v[46:47], v[54:55]
    v_mov_b64 v[92:93], 0
    v_mov_b64 v[94:95], 0
    s_waitcnt vmcnt(15)
    v_lshlrev_b32 v48, 16, v96
    v_and_b32 v49, 0xffff0000, v96
    v_lshlrev_b32 v50, 16, v97
    v_and_b32 v51, 0xffff0000, v97
    v_lshlrev_b32 v52, 16, v98
    v_and_b32 v53, 0xffff0000, v98
    v_lshlrev_b32 v54, 16, v99
    v_and_b32 v55, 0xffff0000, v99
    v_pk_add_f32 v[40:41], v[40:41], v[48:49]
    v_pk_add_f32 v[42:43], v[42:43], v[50:51]
    v_pk_add_f32 v[44:45], v[44:45], v[52:53]
    v_pk_add_f32 v[46:47], v[46:47], v[54:55]
    v_mov_b64 v[96:97], 0
    v_mov_b64 v[98:99], 0
    s_waitcnt vmcnt(14)
    v_lshlrev_b32 v48, 16, v100
    v_and_b32 v49, 0xffff0000, v100
    v_lshlrev_b32 v50, 16, v101
    v_and_b32 v51, 0xffff0000, v101
    v_lshlrev_b32 v52, 16, v102
    v_and_b32 v53, 0xffff0000, v102
    v_lshlrev_b32 v54, 16, v103
    v_and_b32 v55, 0xffff0000, v103
    v_pk_add_f32 v[40:41], v[40:41], v[48:49]
    v_pk_add_f32 v[42:43], v[42:43], v[50:51]
    v_pk_add_f32 v[44:45], v[44:45], v[52:53]
    v_pk_add_f32 v[46:47], v[46:47], v[54:55]
    v_mov_b64 v[100:101], 0
    v_mov_b64 v[102:103], 0
    s_waitcnt vmcnt(13)
    v_lshlrev_b32 v48, 16, v104
    v_and_b32 v49, 0xffff0000, v104
    v_lshlrev_b32 v50, 16, v105
    v_and_b32 v51, 0xffff0000, v105
    v_lshlrev_b32 v52, 16, v106
    v_and_b32 v53, 0xffff0000, v106
    v_lshlrev_b32 v54, 16, v107
    v_and_b32 v55, 0xffff0000, v107
    v_pk_add_f32 v[40:41], v[40:41], v[48:49]
    v_pk_add_f32 v[42:43], v[42:43], v[50:51]
    v_pk_add_f32 v[44:45], v[44:45], v[52:53]
    v_pk_add_f32 v[46:47], v[46:47], v[54:55]
    v_mov_b64 v[104:105], 0
    v_mov_b64 v[106:107], 0
    s_waitcnt vmcnt(12)
    v_lshlrev_b32 v48, 16, v108
    v_and_b32 v49, 0xffff0000, v108
    v_lshlrev_b32 v50, 16, v109
    v_and_b32 v51, 0xffff0000, v109
    v_lshlrev_b32 v52, 16, v110
    v_and_b32 v53, 0xffff0000, v110
    v_lshlrev_b32 v54, 16, v111
    v_and_b32 v55, 0xffff0000, v111
    v_pk_add_f32 v[40:41], v[40:41], v[48:49]
    v_pk_add_f32 v[42:43], v[42:43], v[50:51]
    v_pk_add_f32 v[44:45], v[44:45], v[52:53]
    v_pk_add_f32 v[46:47], v[46:47], v[54:55]
    v_mov_b64 v[108:109], 0
    v_mov_b64 v[110:111], 0
    s_waitcnt vmcnt(11)
    v_lshlrev_b32 v48, 16, v112
    v_and_b32 v49, 0xffff0000, v112
    v_lshlrev_b32 v50, 16, v113
    v_and_b32 v51, 0xffff0000, v113
    v_lshlrev_b32 v52, 16, v114
    v_and_b32 v53, 0xffff0000, v114
    v_lshlrev_b32 v54, 16, v115
    v_and_b32 v55, 0xffff0000, v115
    v_pk_add_f32 v[40:41], v[40:41], v[48:49]
    v_pk_add_f32 v[42:43], v[42:43], v[50:51]
    v_pk_add_f32 v[44:45], v[44:45], v[52:53]
    v_pk_add_f32 v[46:47], v[46:47], v[54:55]
    v_mov_b64 v[112:113], 0
    v_mov_b64 v[114:115], 0
    s_waitcnt vmcnt(10)
    v_lshlrev_b32 v48, 16, v116
    v_and_b32 v49, 0xffff0000, v116
    v_lshlrev_b32 v50, 16, v117
    v_and_b32 v51, 0xffff0000, v117
    v_lshlrev_b32 v52, 16, v118
    v_and_b32 v53, 0xffff0000, v118
    v_lshlrev_b32 v54, 16, v119
    v_and_b32 v55, 0xffff0000, v119
    v_pk_add_f32 v[40:41], v[40:41], v[48:49]
    v_pk_add_f32 v[42:43], v[42:43], v[50:51]
    v_pk_add_f32 v[44:45], v[44:45], v[52:53]
    v_pk_add_f32 v[46:47], v[46:47], v[54:55]
    v_mov_b64 v[116:117], 0
    v_mov_b64 v[118:119], 0
    s_waitcnt vmcnt(9)
    v_lshlrev_b32 v48, 16, v120
    v_and_b32 v49, 0xffff0000, v120
    v_lshlrev_b32 v50, 16, v121
    v_and_b32 v51, 0xffff0000, v121
    v_lshlrev_b32 v52, 16, v122
    v_and_b32 v53, 0xffff0000, v122
    v_lshlrev_b32 v54, 16, v123
    v_and_b32 v55, 0xffff0000, v123
    v_pk_add_f32 v[40:41], v[40:41], v[48:49]
    v_pk_add_f32 v[42:43], v[42:43], v[50:51]
    v_pk_add_f32 v[44:45], v[44:45], v[52:53]
    v_pk_add_f32 v[46:47], v[46:47], v[54:55]
    v_mov_b64 v[120:121], 0
    v_mov_b64 v[122:123], 0
    s_waitcnt vmcnt(8)
    v_lshlrev_b32 v48, 16, v124
    v_and_b32 v49, 0xffff0000, v124
    v_lshlrev_b32 v50, 16, v125
    v_and_b32 v51, 0xffff0000, v125
    v_lshlrev_b32 v52, 16, v126
    v_and_b32 v53, 0xffff0000, v126
    v_lshlrev_b32 v54, 16, v127
    v_and_b32 v55, 0xffff0000, v127
    v_pk_add_f32 v[40:41], v[40:41], v[48:49]
    v_pk_add_f32 v[42:43], v[42:43], v[50:51]
    v_pk_add_f32 v[44:45], v[44:45], v[52:53]
    v_pk_add_f32 v[46:47], v[46:47], v[54:55]
    v_mov_b64 v[124:125], 0
    v_mov_b64 v[126:127], 0
    s_waitcnt vmcnt(7)
    v_lshlrev_b32 v48, 16, v128
    v_and_b32 v49, 0xffff0000, v128
    v_lshlrev_b32 v50, 16, v129
    v_and_b32 v51, 0xffff0000, v129
    v_lshlrev_b32 v52, 16, v130
    v_and_b32 v53, 0xffff0000, v130
    v_lshlrev_b32 v54, 16, v131
    v_and_b32 v55, 0xffff0000, v131
    v_pk_add_f32 v[40:41], v[40:41], v[48:49]
    v_pk_add_f32 v[42:43], v[42:43], v[50:51]
    v_pk_add_f32 v[44:45], v[44:45], v[52:53]
    v_pk_add_f32 v[46:47], v[46:47], v[54:55]
    v_mov_b64 v[128:129], 0
    v_mov_b64 v[130:131], 0
    s_waitcnt vmcnt(6)
    v_lshlrev_b32 v48, 16, v132
    v_and_b32 v49, 0xffff0000, v132
    v_lshlrev_b32 v50, 16, v133
    v_and_b32 v51, 0xffff0000, v133
    v_lshlrev_b32 v52, 16, v134
    v_and_b32 v53, 0xffff0000, v134
    v_lshlrev_b32 v54, 16, v135
    v_and_b32 v55, 0xffff0000, v135
    v_pk_add_f32 v[40:41], v[40:41], v[48:49]
    v_pk_add_f32 v[42:43], v[42:43], v[50:51]
    v_pk_add_f32 v[44:45], v[44:45], v[52:53]
    v_pk_add_f32 v[46:47], v[46:47], v[54:55]
    v_mov_b64 v[132:133], 0
    v_mov_b64 v[134:135], 0
    s_waitcnt vmcnt(5)
    v_lshlrev_b32 v48, 16, v136
    v_and_b32 v49, 0xffff0000, v136
    v_lshlrev_b32 v50, 16, v137
    v_and_b32 v51, 0xffff0000, v137
    v_lshlrev_b32 v52, 16, v138
    v_and_b32 v53, 0xffff0000, v138
    v_lshlrev_b32 v54, 16, v139
    v_and_b32 v55, 0xffff0000, v139
    v_pk_add_f32 v[40:41], v[40:41], v[48:49]
    v_pk_add_f32 v[42:43], v[42:43], v[50:51]
    v_pk_add_f32 v[44:45], v[44:45], v[52:53]
    v_pk_add_f32 v[46:47], v[46:47], v[54:55]
    v_mov_b64 v[136:137], 0
    v_mov_b64 v[138:139], 0
    s_waitcnt vmcnt(4)
    v_lshlrev_b32 v48, 16, v140
    v_and_b32 v49, 0xffff0000, v140
    v_lshlrev_b32 v50, 16, v141
    v_and_b32 v51, 0xffff0000, v141
    v_lshlrev_b32 v52, 16, v142
    v_and_b32 v53, 0xffff0000, v142
    v_lshlrev_b32 v54, 16, v143
    v_and_b32 v55, 0xffff0000, v143
    v_pk_add_f32 v[40:41], v[40:41], v[48:49]
    v_pk_add_f32 v[42:43], v[42:43], v[50:51]
    v_pk_add_f32 v[44:45], v[44:45], v[52:53]
    v_pk_add_f32 v[46:47], v[46:47], v[54:55]
    v_mov_b64 v[140:141], 0
    v_mov_b64 v[142:143], 0
    s_waitcnt vmcnt(3)
    v_lshlrev_b32 v48, 16, v144
    v_and_b32 v49, 0xffff0000, v144
    v_lshlrev_b32 v50, 16, v145
    v_and_b32 v51, 0xffff0000, v145
    v_lshlrev_b32 v52, 16, v146
    v_and_b32 v53, 0xffff0000, v146
    v_lshlrev_b32 v54, 16, v147
    v_and_b32 v55, 0xffff0000, v147
    v_pk_add_f32 v[40:41], v[40:41], v[48:49]
    v_pk_add_f32 v[42:43], v[42:43], v[50:51]
    v_pk_add_f32 v[44:45], v[44:45], v[52:53]
    v_pk_add_f32 v[46:47], v[46:47], v[54:55]
    v_mov_b64 v[144:145], 0
    v_mov_b64 v[146:147], 0
    s_waitcnt vmcnt(2)
    v_lshlrev_b32 v48, 16, v148
    v_and_b32 v49, 0xffff0000, v148
    v_lshlrev_b32 v50, 16, v149
    v_and_b32 v51, 0xffff0000, v149
    v_lshlrev_b32 v52, 16, v150
    v_and_b32 v53, 0xffff0000, v150
    v_lshlrev_b32 v54, 16, v151
    v_and_b32 v55, 0xffff0000, v151
    v_pk_add_f32 v[40:41], v[40:41], v[48:49]
    v_pk_add_f32 v[42:43], v[42:43], v[50:51]
    v_pk_add_f32 v[44:45], v[44:45], v[52:53]
    v_pk_add_f32 v[46:47], v[46:47], v[54:55]
    v_mov_b64 v[148:149], 0
    v_mov_b64 v[150:151], 0
    s_waitcnt vmcnt(1)
    v_lshlrev_b32 v48, 16, v152
    v_and_b32 v49, 0xffff0000, v152
    v_lshlrev_b32 v50, 16, v153
    v_and_b32 v51, 0xffff0000, v153
    v_lshlrev_b32 v52, 16, v154
    v_and_b32 v53, 0xffff0000, v154
    v_lshlrev_b32 v54, 16, v155
    v_and_b32 v55, 0xffff0000, v155
    v_pk_add_f32 v[40:41], v[40:41], v[48:49]
    v_pk_add_f32 v[42:43], v[42:43], v[50:51]
    v_pk_add_f32 v[44:45], v[44:45], v[52:53]
    v_pk_add_f32 v[46:47], v[46:47], v[54:55]
    v_mov_b64 v[152:153], 0
    v_mov_b64 v[154:155], 0
    s_waitcnt vmcnt(0)
    v_lshlrev_b32 v48, 16, v156
    v_and_b32 v49, 0xffff0000, v156
    v_lshlrev_b32 v50, 16, v157
    v_and_b32 v51, 0xffff0000, v157
    v_lshlrev_b32 v52, 16, v158
    v_and_b32 v53, 0xffff0000, v158
    v_lshlrev_b32 v54, 16, v159
    v_and_b32 v55, 0xffff0000, v159
    v_pk_add_f32 v[40:41], v[40:41], v[48:49]
    v_pk_add_f32 v[42:43], v[42:43], v[50:51]
    v_pk_add_f32 v[44:45], v[44:45], v[52:53]
    v_pk_add_f32 v[46:47], v[46:47], v[54:55]
    v_mov_b64 v[156:157], 0
    v_mov_b64 v[158:159], 0
    v_permlane32_swap_b32 v40, v44
    v_permlane32_swap_b32 v41, v45
    v_permlane32_swap_b32 v42, v46
    v_permlane32_swap_b32 v43, v47
    s_nop 0
    v_pk_add_f32 v[40:41], v[40:41], v[44:45]
    v_pk_add_f32 v[42:43], v[42:43], v[46:47]
    s_nop 1
    v_permlane16_swap_b32 v40, v42
    v_permlane16_swap_b32 v41, v43
    s_nop 0
    v_pk_add_f32 v[40:41], v[40:41], v[42:43]
    v_and_b32 v8, 7, v1
    v_lshlrev_b32 v8, 5, v8
    v_lshrrev_b32 v9, 4, v1
    v_lshl_add_u32 v8, v9, 3, v8
    v_add_f32_dpp v40, v40, v40 row_ror:8 row_mask:0xf bank_mask:0xf
    v_add_f32_dpp v41, v41, v41 row_ror:8 row_mask:0xf bank_mask:0xf
    s_mul_i32 s53, s48, 21504
    s_lshl_b32 s54, s69, 8
    s_add_u32 s53, s53, s54
    s_add_u32 s53, s53, 0xa10000
    buffer_store_dwordx2 v[40:41], v8, s[28:31], s53 offen sc1
    s_waitcnt vmcnt(0)
    s_barrier
    s_cmp_lg_u32 s48, 3
    s_cbranch_scc1 L_sp_79
    s_waitcnt vmcnt(0)
    v_cmp_eq_u32 vcc, 0, v1
    v_mov_b32 v13, 0x40000000
    v_mov_b32 v12, 0
    v_cndmask_b32 v12, v13, v12, vcc
    v_mov_b32 v13, 1
    s_lshr_b32 s54, s2, 3
    s_lshl2_add_u32 s54, s54, 128
    buffer_atomic_add v13, v12, s[32:35], s54 offen sc1
    s_cmp_lg_u32 s2, 255
    s_cbranch_scc1 L_sp_79
    v_lshlrev_b32 v9, 2, v1
    v_or_b32 v9, 0x80, v9
    s_mov_b32 s3, 0x40000
L_ssp_85:
    buffer_load_dword v8, v9, s[32:35], 0 offen sc1
    s_waitcnt vmcnt(0)
L_sck_86:
    v_cmp_gt_u32 vcc, 8, v8
    s_nop 1
    s_cmp_eq_u64 vcc, 0
    s_cbranch_scc1 L_sok_84
    s_sleep 6
    s_sub_u32 s3, s3, 1
    s_cbranch_scc0 L_ssp_85
L_sok_84:
    v_mul_u32_u24 v9, 4352, v1
    v_mov_b32 v8, 1
    s_mov_b32 s52, 0xe00080
    buffer_store_dword v8, v9, s[28:31], s52 offen sc1
    s_mov_b32 s52, 0xe44080
    buffer_store_dword v8, v9, s[28:31], s52 offen sc1
    s_mov_b32 s52, 0xe88080
    buffer_store_dword v8, v9, s[28:31], s52 offen sc1
    s_mov_b32 s52, 0xecc080
    buffer_store_dword v8, v9, s[28:31], s52 offen sc1
L_sp_79:
    s_barrier
    s_branch L_p3
L_exit:
    s_endpgm
L_text_end:
.section .rodata,"a"
.p2align 6
.amdhsa_kernel recurrent_scan__sliding_local_dilated__swiglu_ffn__prompt_kernel
  .amdhsa_next_free_vgpr 256
  .amdhsa_next_free_sgpr 102
  .amdhsa_accum_offset 256
  .amdhsa_group_segment_fixed_size 0
  .amdhsa_kernarg_size 80
  .amdhsa_user_sgpr_count 2
  .amdhsa_user_sgpr_kernarg_segment_ptr 1
  .amdhsa_system_sgpr_workgroup_id_x 1
  .amdhsa_float_denorm_mode_32 3
.end_amdhsa_kernel
```
